```python
import torch

def _softmax(x, axis=-1):
    return torch.softmax(x, dim=axis)
def _gelu(x):
    return torch.nn.functional.gelu(x, approximate="tanh")
def _silu(x):
    return torch.nn.functional.silu(x)
def _sigmoid(x):
    return torch.sigmoid(x)
def _layernorm(x, axis=-1, eps=1e-5):
    m = x.mean(dim=axis, keepdim=True)
    v = x.var(dim=axis, keepdim=True, unbiased=False)
    return (x - m) / torch.sqrt(v + eps)
def _scatter_add(tgt, idx, src, axis=0):
    return tgt.clone().index_add_(axis, idx, src)
def _segment_sum(src, seg, n):
    out = torch.zeros((n,) + src.shape[1:], dtype=src.dtype)
    return out.index_add_(0, seg, src)
def _pad(x, pw):
    flat = tuple(v for pair in reversed(pw) for v in pair)
    return torch.nn.functional.pad(x, flat)

kernel_name = 'parallel_sum__linear_kernel_hedgehog__glu_gated_reglu__prompt'

def setup_inputs():

    _w = (lambda a: (lambda t: t.to(torch.bfloat16) if t.is_floating_point() else t)(torch.as_tensor(a)))
    def _A_setup():
        B, S, D, H = 1, 2048, 640, 32
        Dh = D // H
        return {
            "x": _w((lambda *s: torch.randn(*s, dtype=torch.bfloat16) * 0.05)(B, S, D)),
            "wqkv": _w((lambda *s: torch.randn(*s, dtype=torch.bfloat16) * 0.2)(D, 3 * D)),
            "w_phi": _w((lambda *s: torch.randn(*s, dtype=torch.bfloat16) * 0.2)(H, Dh, Dh) * (Dh ** -0.5)),
            "wo": _w((lambda *s: torch.randn(*s, dtype=torch.bfloat16) * 0.05)(D, D)),
        }
    _A_in = _A_setup()

    def _B_setup():
        B, S, D, F = 1, 2048, 640, 1728
        return {
            "x": _w((lambda *s: torch.randn(*s, dtype=torch.bfloat16) * 0.05)(B, S, D)),
            "W_gate": _w((lambda *s: torch.randn(*s, dtype=torch.bfloat16) * 0.4)(D, F) * (2.0 / D) ** 0.5),
            "W_up": _w((lambda *s: torch.randn(*s, dtype=torch.bfloat16) * 0.4)(D, F) * (2.0 / D) ** 0.5),
            "W_down": _w((lambda *s: torch.randn(*s, dtype=torch.bfloat16) * 0.4)(F, D) * (1.0 / F) ** 0.5),
        }
    _B_in = _B_setup()

    return {
        "A_x": _A_in["x"],
        "A_wqkv": _A_in["wqkv"],
        "A_w_phi": _A_in["w_phi"],
        "A_wo": _A_in["wo"],
        "B_x": _B_in["x"],
        "B_W_gate": _B_in["W_gate"],
        "B_W_up": _B_in["W_up"],
        "B_W_down": _B_in["W_down"],
    }

def reference(A_x, A_wqkv, A_w_phi, A_wo, B_x, B_W_gate, B_W_up, B_W_down):
    def _A_ref(x, wqkv, w_phi, wo):
        B, S, D = x.shape
        H = 32; Dh = D // H
        qkv = (lambda x, *d: x.permute(*d))((x @ wqkv).reshape(B, S, 3, H, Dh), 2, 0, 3, 1, 4)
        q, k, v = qkv[0], qkv[1], qkv[2]
        pq = torch.einsum("bhsd,hdf->bhsf", q, w_phi)
        pk = torch.einsum("bhsd,hdf->bhsf", k, w_phi)
        phi_q = torch.concatenate([_softmax(pq, axis=-1), _softmax(-pq, axis=-1)], axis=-1)
        phi_k = torch.concatenate([_softmax(pk, axis=-1), _softmax(-pk, axis=-1)], axis=-1)
        kv = torch.einsum("bhsf,bhsd->bhfd", phi_k, v)
        z  = torch.einsum("bhsf->bhf", phi_k)
        num = torch.einsum("bhqf,bhfd->bhqd", phi_q, kv)
        den = torch.einsum("bhqf,bhf->bhq", phi_q, z)[..., None] + 1e-6
        o = num / den
        return (lambda x, *d: x.permute(*d))(o, 0, 2, 1, 3).reshape(B, S, D) @ wo

    def _B_ref(x, W_gate, W_up, W_down):
        gate = torch.einsum("bsd,df->bsf", x, W_gate)
        up = torch.einsum("bsd,df->bsf", x, W_up)
        gate = gate * (lambda x, dt: x.to(dt))(gate > 0, gate.dtype)
        h = gate * up
        return torch.einsum("bsf,fd->bsd", h, W_down)

    x = A_x
    xn = _layernorm(x, axis=-1)
    return x + _A_ref(xn, A_wqkv, A_w_phi, A_wo) + _B_ref(xn, B_W_gate, B_W_up, B_W_down)
```

```asm
; @launch grid=(256,1,1) block=(256,1,1) lds=163840
.amdgcn_target "amdgcn-amd-amdhsa--gfx950"
.text
.globl parallel_sum__linear_kernel_hedgehog__glu_gated_reglu__prompt_kernel
.p2align 8
.type parallel_sum__linear_kernel_hedgehog__glu_gated_reglu__prompt_kernel,@function
parallel_sum__linear_kernel_hedgehog__glu_gated_reglu__prompt_kernel:
  s_cmp_ge_u32 s2, 256
  s_cbranch_scc1 L_km_end
  s_load_dwordx4 s[4:7], s[0:1], 0
  s_load_dwordx4 s[8:11], s[0:1], 16
  s_load_dwordx4 s[12:15], s[0:1], 40
  s_load_dwordx2 s[16:17], s[0:1], 56
  s_load_dwordx4 s[20:23], s[0:1], 72
  s_and_b32 s77, s2, 7
  s_lshr_b32 s76, s2, 3
  s_mul_i32 s3, s77, 18
  s_add_u32 s3, s3, s76
  s_sub_u32 s3, s3, 13
  s_cmp_eq_u32 s76, 31
  s_cselect_b32 s84, 0, -1
  s_mov_b32 s85, s84
  s_mov_b32 s65, s77
  s_and_b32 s66, s76, s84
  v_lshrrev_b32 v1, 6, v0
  s_nop 0
  v_readfirstlane_b32 s64, v1
  v_and_b32 v1, 63, v0
  s_cmp_eq_u32 s2, 248
  s_cbranch_scc1 L_km_zero
L_km_nozero:
  s_cmp_ge_u32 s66, 13
  s_cbranch_scc1 L_km_ffn
  s_mul_i32 s67, s66, 5
  s_mul_i32 s68, s67, 5
  s_lshr_b32 s68, s68, 6
  s_lshl_b32 s68, s68, 1
  s_mov_b32 s3, 0
  s_waitcnt lgkmcnt(0)
  s_add_u32 s24, s4, 0
  s_addc_u32 s25, s5, 0
  s_and_b32 s26, s84, 2621440
  s_mov_b32 s27, 0x20000
  s_add_u32 s28, s6, 0
  s_addc_u32 s29, s7, 0
  s_and_b32 s30, s84, 2457600
  s_mov_b32 s31, 0x20000
  s_mul_i32 s76, s65, 160
  s_mul_i32 s69, s68, 245760
  s_add_u32 s69, s69, s76
  s_add_u32 s70, s76, 2457600
  s_mul_i32 s76, s67, 40960
  s_lshl_b32 s71, s68, 7
  s_add_u32 s71, s71, s76
  s_add_u32 s72, s76, 1280
  v_lshrrev_b32 v96, 3, v1
  s_lshl_b32 s76, s64, 3
  v_add_u32 v96, s76, v96
  v_lshrrev_b32 v97, 1, v96
  v_xor_b32 v97, v97, v1
  v_and_b32 v97, 7, v97
  v_lshlrev_b32 v97, 4, v97
  v_mul_u32_u24 v96, 1280, v96
  v_add_u32 v2, v96, v97
  v_lshrrev_b32 v96, 5, v1
  v_add_u32 v96, 0, v96
  v_lshlrev_b32 v97, 2, v96
  v_and_b32 v98, 31, v1
  v_xor_b32 v97, v97, v98
  v_mul_u32_u24 v98, 6554, v97
  v_lshrrev_b32 v98, 16, v98
  v_mul_u32_u24 v99, 1120, v98
  v_lshl_add_u32 v99, v97, 4, v99
  s_lshl_b32 s76, s64, 2
  v_add_u32 v96, s76, v96
  v_mul_u32_u24 v96, 3840, v96
  v_add_u32 v96, v96, v99
  v_cmp_gt_u32 vcc, 30, v97
  v_mov_b32 v98, 1073741824
  s_nop 0
  v_cndmask_b32 v3, v98, v96, vcc
  v_lshrrev_b32 v96, 5, v1
  v_add_u32 v96, 2, v96
  v_lshlrev_b32 v97, 2, v96
  v_and_b32 v98, 31, v1
  v_xor_b32 v97, v97, v98
  v_mul_u32_u24 v98, 6554, v97
  v_lshrrev_b32 v98, 16, v98
  v_mul_u32_u24 v99, 1120, v98
  v_lshl_add_u32 v99, v97, 4, v99
  s_lshl_b32 s76, s64, 2
  v_add_u32 v96, s76, v96
  v_mul_u32_u24 v96, 3840, v96
  v_add_u32 v96, v96, v99
  v_subrev_u32 v96, 1024, v96
  v_cmp_gt_u32 vcc, 30, v97
  v_mov_b32 v98, 1073741824
  s_nop 0
  v_cndmask_b32 v4, v98, v96, vcc
  s_lshl_b32 s73, s64, 11
  s_lshl_b32 s74, s64, 10
  s_add_u32 m0, s74, 0
  s_add_u32 s75, s71, 0
  buffer_load_dwordx4 v2, s[24:27], s75 offen lds
  s_add_u32 m0, s74, 4096
  s_add_u32 s75, s71, 40960
  buffer_load_dwordx4 v2, s[24:27], s75 offen lds
  s_add_u32 m0, s74, 8192
  s_add_u32 s75, s71, 81920
  buffer_load_dwordx4 v2, s[24:27], s75 offen lds
  s_add_u32 m0, s74, 12288
  s_add_u32 s75, s71, 122880
  buffer_load_dwordx4 v2, s[24:27], s75 offen lds
  s_add_u32 m0, s74, 16384
  s_add_u32 s75, s71, 163840
  buffer_load_dwordx4 v2, s[24:27], s75 offen lds
  s_add_u32 m0, s73, 61440
  s_add_u32 s75, s69, 0
  buffer_load_dwordx4 v3, s[28:31], s75 offen offset:0 lds
  buffer_load_dwordx4 v4, s[28:31], s75 offen offset:1024 lds
  s_add_u32 m0, s73, 69632
  s_add_u32 s75, s69, 61440
  buffer_load_dwordx4 v3, s[28:31], s75 offen offset:0 lds
  buffer_load_dwordx4 v4, s[28:31], s75 offen offset:1024 lds
  s_add_u32 s32, s22, 0
  s_addc_u32 s33, s23, 0
  s_mov_b32 s34, 16384
  s_mov_b32 s35, 0x20000
  s_add_u32 s44, s22, 40960
  s_addc_u32 s45, s23, 0
  s_mov_b32 s46, 12288
  s_mov_b32 s47, 0x20000
  s_add_u32 s52, s4, 0
  s_addc_u32 s53, s5, 0
  s_mov_b32 s54, 2621440
  s_mov_b32 s55, 0x20000
  s_add_u32 s40, s22, 7131136
  s_addc_u32 s41, s23, 0
  s_mov_b32 s42, 10371072
  s_mov_b32 s43, 0x20000
  s_mov_b32 s48, s20
  s_mov_b32 s49, s21
  s_mov_b32 s50, 256
  s_mov_b32 s51, 0x20000
  s_lshl_b32 s76, s65, 2
  s_add_u32 s76, s76, s64
  s_add_u32 s76, s76, 36
  s_mul_i32 s76, s76, 3840
  s_add_u32 s76, s76, 17567744
  s_add_u32 s36, s22, s76
  s_addc_u32 s37, s23, 0
  s_and_b32 s38, s84, 3840
  s_mov_b32 s39, 0x20000
  v_and_b32 v106, 31, v1
  v_lshrrev_b32 v107, 1, v106
  v_lshrrev_b32 v108, 5, v1
  v_xor_b32 v107, v107, v108
  v_and_b32 v107, 7, v107
  v_lshlrev_b32 v107, 4, v107
  v_lshl_add_u32 v107, v106, 7, v107
  v_xor_b32 v5, 0, v107
  v_xor_b32 v6, 32, v107
  v_xor_b32 v7, 64, v107
  v_xor_b32 v8, 96, v107
  v_lshlrev_b32 v13, 3, v106
  v_bfe_u32 v96, v1, 4, 1
  v_and_b32 v97, 3, v1
  v_lshl_add_u32 v96, v96, 2, v97
  v_bfe_u32 v97, v1, 2, 2
  v_lshrrev_b32 v98, 5, v1
  v_lshl_add_u32 v98, v98, 3, v97
  v_lshlrev_b32 v98, 9, v98
  v_add_u32 v98, 61440, v98
  v_lshrrev_b32 v108, 1, v96
  v_and_b32 v109, 1, v96
  v_lshl_add_u32 v110, v108, 1, v109
  v_lshlrev_b32 v110, 3, v110
  v_add_u32 v110, 0, v110
  v_lshlrev_b32 v111, 3, v109
  v_add_u32 v111, 320, v111
  v_mov_b32 v99, 336
  v_cmp_gt_u32 vcc, 5, v96
  s_nop 1
  v_cndmask_b32 v99, v99, v110, vcc
  v_cmp_lt_u32 vcc, 5, v96
  s_nop 1
  v_cndmask_b32 v99, v99, v111, vcc
  s_mul_i32 s76, s64, 40
  v_add_u32 v99, s76, v99
  v_lshlrev_b32 v100, 6, v97
  v_xor_b32 v100, v100, v99
  v_add_u32 v9, v100, v98
  v_lshrrev_b32 v108, 1, v96
  v_and_b32 v109, 1, v96
  v_lshl_add_u32 v110, v108, 1, v109
  v_lshlrev_b32 v110, 3, v110
  v_add_u32 v110, 160, v110
  v_lshlrev_b32 v111, 3, v109
  v_add_u32 v111, 344, v111
  v_mov_b32 v99, 352
  v_cmp_gt_u32 vcc, 5, v96
  s_nop 1
  v_cndmask_b32 v99, v99, v110, vcc
  v_cmp_lt_u32 vcc, 5, v96
  s_nop 1
  v_cndmask_b32 v99, v99, v111, vcc
  s_mul_i32 s76, s64, 40
  v_add_u32 v99, s76, v99
  v_lshlrev_b32 v100, 6, v97
  v_xor_b32 v100, v100, v99
  v_add_u32 v10, v100, v98
  v_lshlrev_b32 v11, 4, v1
  v_lshlrev_b32 v12, 2, v1
  s_mul_i32 s76, s64, 12288
  v_and_b32 v96, 31, v1
  v_lshrrev_b32 v97, 5, v1
  v_mul_u32_u24 v16, 112, v96
  v_lshl_add_u32 v16, v97, 4, v16
  v_add_u32 v16, s76, v16
  s_add_u32 s77, s76, 3584
  v_mul_u32_u24 v98, 72, v96
  v_add_u32 v98, s77, v98
  v_lshl_add_u32 v17, v97, 3, v98
  v_mul_i32_i24 v99, -24, v97
  v_add_u32 v99, 40, v99
  v_add_u32 v18, v98, v99
  v_lshrrev_b32 v96, 4, v1
  v_lshlrev_b32 v96, 3, v96
  v_bfe_u32 v97, v1, 2, 2
  v_add_u32 v96, v96, v97
  v_and_b32 v97, 3, v1
  v_lshlrev_b32 v97, 3, v97
  v_mul_u32_u24 v19, 112, v96
  v_add3_u32 v19, v19, v97, s76
  v_mul_u32_u24 v20, 72, v96
  v_add3_u32 v20, v20, v97, s77
  s_lshl_b32 s76, s65, 2
  s_add_u32 s76, s76, s64
  s_mul_i32 s77, s76, 800
  s_add_u32 s60, s8, s77
  s_addc_u32 s61, s9, 0
  s_mov_b32 s62, 800
  s_mov_b32 s63, 0x20000
  v_and_b32 v96, 31, v1
  v_cmp_eq_u32 vcc, 0, v1
  v_cmp_eq_u32 s[76:77], 32, v1
  s_or_b64 vcc, vcc, s[76:77]
  v_cmp_eq_u32 s[76:77], 20, v96
  s_or_b64 vcc, vcc, s[76:77]
  v_mov_b32 v96, 0x3f803f80
  v_cndmask_b32 v96, 0, v96, vcc
  v_accvgpr_write_b32 a64, v96
  v_accvgpr_write_b32 a65, v96
  v_accvgpr_write_b32 a66, v96
  v_accvgpr_write_b32 a67, v96
  s_and_b32 s76, s2, 1
  s_lshl_b32 s76, s76, 2
  s_lshr_b32 s12, s2, 6
  s_add_u32 s12, s12, s76
  s_mul_i32 s13, s64, 5120
  s_lshr_b32 s76, s2, 3
  s_and_b32 s76, s76, 7
  s_lshl_b32 s76, s76, 1
  s_lshr_b32 s77, s2, 6
  s_mul_i32 s77, s77, 0
  s_add_u32 s76, s76, s77
  s_cmp_ge_u32 s76, 13
  s_cselect_b32 s77, 13, 0
  s_sub_u32 s76, s76, s77
  s_mul_i32 s14, s76, 20480
  s_lshl_b32 s15, s76, 12
  s_lshl_b32 s76, s64, 8
  s_add_u32 s76, s76, s2
  s_mul_hi_u32 s82, s76, 0x1999999a
  s_mul_i32 s83, s82, 10
  s_sub_u32 s83, s76, s83
  s_cmp_ge_u32 s82, 54
  s_cselect_b32 s56, s10, s16
  s_cselect_b32 s57, s11, s17
  s_mov_b32 s58, 2211840
  s_cselect_b32 s58, 819200, s58
  s_mov_b32 s59, 0x20000
  s_cmp_ge_u32 s76, 740
  s_cselect_b32 s58, 0, s58
  v_lshrrev_b32 v128, 3, v1
  v_and_b32 v129, 7, v1
  v_lshlrev_b32 v129, 4, v129
  s_lshl_b32 s77, s83, 7
  v_add_u32 v129, s77, v129
  v_lshrrev_b32 v130, 2, v128
  v_mul_u32_u24 v130, 20, v130
  v_bfe_u32 v131, v128, 1, 1
  v_mul_u32_u24 v131, 10, v131
  v_add_u32 v130, v130, v131
  v_and_b32 v131, 1, v128
  v_add3_u32 v130, v130, v131, 8
  s_sub_u32 s76, s82, 54
  s_lshl_b32 s76, s76, 2
  s_add_u32 s76, s76, 0
  s_mul_hi_u32 s77, s76, 0x33333334
  s_mul_i32 s78, s77, 5
  s_sub_u32 s78, s76, s78
  s_mul_i32 s77, s77, 40
  s_lshr_b32 s76, s78, 1
  s_mul_i32 s76, s76, 20
  s_add_u32 s76, s76, s77
  s_and_b32 s79, s78, 1
  s_mul_i32 s79, s79, 10
  s_add_u32 s76, s76, s79
  s_cmp_eq_u32 s78, 4
  s_cselect_b32 s76, s77, s76
  s_cselect_b64 vcc, -1, 0
  v_cndmask_b32 v132, v128, v130, vcc
  s_lshl_b32 s77, s82, 5
  s_add_u32 s77, s77, 0
  s_cmp_ge_u32 s82, 54
  s_cselect_b32 s76, s76, s77
  s_cselect_b64 vcc, -1, 0
  v_cndmask_b32 v132, v128, v132, vcc
  v_add_u32 v132, s76, v132
  v_mul_u32_u24 v132, 1280, v132
  v_add_u32 v132, v132, v129
  v_accvgpr_write_b32 a128, v132
  s_sub_u32 s76, s82, 54
  s_lshl_b32 s76, s76, 2
  s_add_u32 s76, s76, 1
  s_mul_hi_u32 s77, s76, 0x33333334
  s_mul_i32 s78, s77, 5
  s_sub_u32 s78, s76, s78
  s_mul_i32 s77, s77, 40
  s_lshr_b32 s76, s78, 1
  s_mul_i32 s76, s76, 20
  s_add_u32 s76, s76, s77
  s_and_b32 s79, s78, 1
  s_mul_i32 s79, s79, 10
  s_add_u32 s76, s76, s79
  s_cmp_eq_u32 s78, 4
  s_cselect_b32 s76, s77, s76
  s_cselect_b64 vcc, -1, 0
  v_cndmask_b32 v132, v128, v130, vcc
  s_lshl_b32 s77, s82, 5
  s_add_u32 s77, s77, 8
  s_cmp_ge_u32 s82, 54
  s_cselect_b32 s76, s76, s77
  s_cselect_b64 vcc, -1, 0
  v_cndmask_b32 v132, v128, v132, vcc
  v_add_u32 v132, s76, v132
  v_mul_u32_u24 v132, 1280, v132
  v_add_u32 v132, v132, v129
  v_accvgpr_write_b32 a129, v132
  s_sub_u32 s76, s82, 54
  s_lshl_b32 s76, s76, 2
  s_add_u32 s76, s76, 2
  s_mul_hi_u32 s77, s76, 0x33333334
  s_mul_i32 s78, s77, 5
  s_sub_u32 s78, s76, s78
  s_mul_i32 s77, s77, 40
  s_lshr_b32 s76, s78, 1
  s_mul_i32 s76, s76, 20
  s_add_u32 s76, s76, s77
  s_and_b32 s79, s78, 1
  s_mul_i32 s79, s79, 10
  s_add_u32 s76, s76, s79
  s_cmp_eq_u32 s78, 4
  s_cselect_b32 s76, s77, s76
  s_cselect_b64 vcc, -1, 0
  v_cndmask_b32 v132, v128, v130, vcc
  s_lshl_b32 s77, s82, 5
  s_add_u32 s77, s77, 16
  s_cmp_ge_u32 s82, 54
  s_cselect_b32 s76, s76, s77
  s_cselect_b64 vcc, -1, 0
  v_cndmask_b32 v132, v128, v132, vcc
  v_add_u32 v132, s76, v132
  v_mul_u32_u24 v132, 1280, v132
  v_add_u32 v132, v132, v129
  v_accvgpr_write_b32 a130, v132
  s_sub_u32 s76, s82, 54
  s_lshl_b32 s76, s76, 2
  s_add_u32 s76, s76, 3
  s_mul_hi_u32 s77, s76, 0x33333334
  s_mul_i32 s78, s77, 5
  s_sub_u32 s78, s76, s78
  s_mul_i32 s77, s77, 40
  s_lshr_b32 s76, s78, 1
  s_mul_i32 s76, s76, 20
  s_add_u32 s76, s76, s77
  s_and_b32 s79, s78, 1
  s_mul_i32 s79, s79, 10
  s_add_u32 s76, s76, s79
  s_cmp_eq_u32 s78, 4
  s_cselect_b32 s76, s77, s76
  s_cselect_b64 vcc, -1, 0
  v_cndmask_b32 v132, v128, v130, vcc
  s_lshl_b32 s77, s82, 5
  s_add_u32 s77, s77, 24
  s_cmp_ge_u32 s82, 54
  s_cselect_b32 s76, s76, s77
  s_cselect_b64 vcc, -1, 0
  v_cndmask_b32 v132, v128, v132, vcc
  v_add_u32 v132, s76, v132
  v_mul_u32_u24 v132, 1280, v132
  v_add_u32 v132, v132, v129
  v_accvgpr_write_b32 a131, v132
  v_lshrrev_b32 v14, 4, v1
  v_lshlrev_b32 v14, 3, v14
  v_bfe_u32 v128, v1, 2, 2
  v_add_u32 v14, v14, v128
  v_lshlrev_b32 v14, 7, v14
  v_and_b32 v128, 3, v1
  v_lshl_add_u32 v14, v128, 3, v14
  s_lshl_b32 s76, s64, 12
  s_add_u32 s76, s76, 126976
  v_add_u32 v14, s76, v14
  v_lshlrev_b32 v15, 4, v1
  s_lshl_b32 s76, s2, 3
  s_lshl_b32 s77, s64, 1
  s_add_u32 s76, s76, s77
  v_lshrrev_b32 v68, 5, v1
  v_add_u32 v68, s76, v68
  v_and_b32 v44, 31, v1
  v_mul_u32_u24 v45, 1280, v68
  v_lshl_add_u32 v45, v44, 4, v45
  v_add_u32 v46, 1024, v45
  v_cmp_gt_u32 vcc, 16, v44
  v_mov_b32 v47, 1073741824
  s_nop 0
  v_cndmask_b32 v46, v47, v46, vcc
  v_cndmask_b32 v69, 0, 1.0, vcc
  v_and_b32 v144, 31, v1
  v_lshrrev_b32 v145, 3, v144
  v_lshlrev_b32 v145, 2, v145
  v_and_b32 v146, 3, v144
  v_add_u32 v145, v145, v146
  v_bfe_u32 v146, v144, 2, 1
  v_mul_u32_u24 v146, 10, v146
  v_add_u32 v146, v146, v145
  v_lshlrev_b32 v146, 1, v146
  v_cmp_gt_u32 vcc, 10, v145
  v_mov_b32 v147, 1024
  s_nop 0
  v_cndmask_b32 v146, v147, v146, vcc
  v_lshrrev_b32 v144, 5, v1
  v_mul_u32_u24 v145, 160, v144
  v_add_u32 v145, v145, v146
  v_cmp_eq_u32 vcc, 0, v144
  s_nop 1
  v_cndmask_b32 v146, v147, v146, vcc
  s_lshl_b32 s76, s64, 11
  s_add_u32 s76, s76, 143360
  v_add_u32 v84, s76, v145
  v_add_u32 v85, s76, v146
  v_lshl_add_u32 v144, v1, 4, s76
  v_mov_b32 v148, 0
  v_mov_b32 v149, 0
  v_mov_b32 v150, 0
  v_mov_b32 v151, 0
  ds_write_b128 v144, v[148:151] offset:1024
  s_mov_b32 s18, -1
  s_mov_b32 s19, 0
  s_mov_b32 s16, 1
  s_mov_b32 s17, 0
  s_cmp_eq_u32 s84, 0
  s_cbranch_scc1 L_spare_att
  s_add_u32 m0, s73, 77824
  s_add_u32 s75, s69, 122880
  buffer_load_dwordx4 v3, s[28:31], s75 offen offset:0 lds
  buffer_load_dwordx4 v4, s[28:31], s75 offen offset:1024 lds
  s_waitcnt vmcnt(2)
  s_barrier
  ds_read_b128 a[216:219], v5 offset:0
  ds_read_b64_tr_b16 a[200:201], v9 offset:0
  ds_read_b64_tr_b16 a[202:203], v9 offset:2048
  ds_read_b128 a[220:223], v5 offset:4096
  ds_read_b128 a[224:227], v5 offset:8192
  ds_read_b128 a[228:231], v5 offset:12288
  ds_read_b128 a[232:235], v5 offset:16384
  ds_read_b64_tr_b16 a[204:205], v10 offset:0
  ds_read_b64_tr_b16 a[206:207], v10 offset:2048
  s_waitcnt lgkmcnt(6)
  v_mfma_f32_32x32x16_bf16 v[96:111], a[200:203], a[216:219], 0
  ds_read_b128 a[236:239], v6 offset:0
  s_add_u32 m0, s73, 86016
  s_add_u32 s75, s69, 184320
  buffer_load_dwordx4 v3, s[28:31], s75 offen offset:0 lds
  s_waitcnt lgkmcnt(6)
  v_mfma_f32_32x32x16_bf16 v[128:143], a[200:203], a[220:223], 0
  ds_read_b64_tr_b16 a[208:209], v9 offset:8192
  buffer_load_dwordx4 v4, s[28:31], s75 offen offset:1024 lds
  s_waitcnt lgkmcnt(6)
  v_mfma_f32_32x32x16_bf16 v[160:175], a[200:203], a[224:227], 0
  ds_read_b64_tr_b16 a[210:211], v9 offset:10240
  s_waitcnt lgkmcnt(6)
  v_mfma_f32_32x32x16_bf16 v[192:207], a[200:203], a[228:231], 0
  ds_read_b128 a[240:243], v6 offset:4096
  s_add_u32 s71, s71, 128
  s_cmp_ge_u32 s71, s72
  s_cselect_b32 s79, 1280, 0
  s_sub_u32 s71, s71, s79
  s_add_u32 m0, s74, 20480
  s_add_u32 s75, s71, 0
  buffer_load_dwordx4 v2, s[24:27], s75 offen lds
  s_waitcnt lgkmcnt(6)
  v_mfma_f32_32x32x16_bf16 v[224:239], a[200:203], a[232:235], 0
  ds_read_b128 a[244:247], v6 offset:8192
  v_mfma_f32_16x16x32_bf16 a[68:71], a[64:67], a[200:203], 0
  ds_read_b128 a[248:251], v6 offset:12288
  s_add_u32 m0, s74, 24576
  s_add_u32 s75, s71, 40960
  buffer_load_dwordx4 v2, s[24:27], s75 offen lds
  s_waitcnt lgkmcnt(6)
  v_mfma_f32_32x32x16_bf16 v[112:127], a[204:207], a[216:219], 0
  ds_read_b128 a[252:255], v6 offset:16384
  s_add_u32 m0, s74, 28672
  s_add_u32 s75, s71, 81920
  buffer_load_dwordx4 v2, s[24:27], s75 offen lds
  v_mfma_f32_32x32x16_bf16 v[144:159], a[204:207], a[220:223], 0
  ds_read_b64_tr_b16 a[212:213], v10 offset:8192
  v_mfma_f32_32x32x16_bf16 v[176:191], a[204:207], a[224:227], 0
  ds_read_b64_tr_b16 a[214:215], v10 offset:10240
  s_add_u32 m0, s74, 32768
  s_add_u32 s75, s71, 122880
  buffer_load_dwordx4 v2, s[24:27], s75 offen lds
  v_mfma_f32_32x32x16_bf16 v[208:223], a[204:207], a[228:231], 0
  v_mfma_f32_32x32x16_bf16 v[240:255], a[204:207], a[232:235], 0
  s_add_u32 m0, s74, 36864
  s_add_u32 s75, s71, 163840
  buffer_load_dwordx4 v2, s[24:27], s75 offen lds
  v_mfma_f32_16x16x32_bf16 a[72:75], a[64:67], a[204:207], 0
  s_add_u32 s69, s69, 245760
  s_cmp_ge_u32 s69, s70
  s_cselect_b32 s79, 2457600, 0
  s_sub_u32 s69, s69, s79
  s_add_u32 m0, s73, 94208
  s_add_u32 s75, s69, 0
  buffer_load_dwordx4 v3, s[28:31], s75 offen offset:0 lds
  s_waitcnt vmcnt(8)
  s_barrier
  s_waitcnt lgkmcnt(6)
  v_mfma_f32_32x32x16_bf16 v[96:111], a[208:211], a[236:239], v[96:111]
  ds_read_b128 a[216:219], v7 offset:0
  s_waitcnt lgkmcnt(6)
  v_mfma_f32_32x32x16_bf16 v[128:143], a[208:211], a[240:243], v[128:143]
  ds_read_b64_tr_b16 a[200:201], v9 offset:16384
  buffer_load_dwordx4 v4, s[28:31], s75 offen offset:1024 lds
  s_waitcnt lgkmcnt(6)
  v_mfma_f32_32x32x16_bf16 v[160:175], a[208:211], a[244:247], v[160:175]
  ds_read_b64_tr_b16 a[202:203], v9 offset:18432
  s_waitcnt lgkmcnt(6)
  v_mfma_f32_32x32x16_bf16 v[192:207], a[208:211], a[248:251], v[192:207]
  ds_read_b128 a[220:223], v7 offset:4096
  s_add_u32 m0, s73, 102400
  s_add_u32 s75, s69, 61440
  buffer_load_dwordx4 v3, s[28:31], s75 offen offset:0 lds
  s_waitcnt lgkmcnt(6)
  v_mfma_f32_32x32x16_bf16 v[224:239], a[208:211], a[252:255], v[224:239]
  ds_read_b128 a[224:227], v7 offset:8192
  buffer_load_dwordx4 v4, s[28:31], s75 offen offset:1024 lds
  v_mfma_f32_16x16x32_bf16 a[68:71], a[64:67], a[208:211], a[68:71]
  ds_read_b128 a[228:231], v7 offset:12288
  s_waitcnt lgkmcnt(6)
  v_mfma_f32_32x32x16_bf16 v[112:127], a[212:215], a[236:239], v[112:127]
  ds_read_b128 a[232:235], v7 offset:16384
  s_add_u32 m0, s73, 110592
  s_add_u32 s75, s69, 122880
  buffer_load_dwordx4 v3, s[28:31], s75 offen offset:0 lds
  v_mfma_f32_32x32x16_bf16 v[144:159], a[212:215], a[240:243], v[144:159]
  ds_read_b64_tr_b16 a[204:205], v10 offset:16384
  v_mfma_f32_32x32x16_bf16 v[176:191], a[212:215], a[244:247], v[176:191]
  ds_read_b64_tr_b16 a[206:207], v10 offset:18432
  buffer_load_dwordx4 v4, s[28:31], s75 offen offset:1024 lds
  v_mfma_f32_32x32x16_bf16 v[208:223], a[212:215], a[248:251], v[208:223]
  v_mfma_f32_32x32x16_bf16 v[240:255], a[212:215], a[252:255], v[240:255]
  s_add_u32 s71, s71, 128
  s_cmp_ge_u32 s71, s72
  s_cselect_b32 s79, 1280, 0
  s_sub_u32 s71, s71, s79
  s_add_u32 m0, s74, 40960
  s_add_u32 s75, s71, 0
  buffer_load_dwordx4 v2, s[24:27], s75 offen lds
  v_mfma_f32_16x16x32_bf16 a[72:75], a[64:67], a[212:215], a[72:75]
  s_waitcnt vmcnt(5)
  s_barrier
  s_waitcnt lgkmcnt(6)
  v_mfma_f32_32x32x16_bf16 v[96:111], a[200:203], a[216:219], v[96:111]
  ds_read_b128 a[236:239], v8 offset:0
  s_add_u32 m0, s74, 45056
  s_add_u32 s75, s71, 40960
  buffer_load_dwordx4 v2, s[24:27], s75 offen lds
  s_waitcnt lgkmcnt(6)
  v_mfma_f32_32x32x16_bf16 v[128:143], a[200:203], a[220:223], v[128:143]
  ds_read_b64_tr_b16 a[208:209], v9 offset:24576
  s_add_u32 m0, s74, 49152
  s_add_u32 s75, s71, 81920
  buffer_load_dwordx4 v2, s[24:27], s75 offen lds
  s_waitcnt lgkmcnt(6)
  v_mfma_f32_32x32x16_bf16 v[160:175], a[200:203], a[224:227], v[160:175]
  ds_read_b64_tr_b16 a[210:211], v9 offset:26624
  s_waitcnt lgkmcnt(6)
  v_mfma_f32_32x32x16_bf16 v[192:207], a[200:203], a[228:231], v[192:207]
  ds_read_b128 a[240:243], v8 offset:4096
  s_add_u32 m0, s74, 53248
  s_add_u32 s75, s71, 122880
  buffer_load_dwordx4 v2, s[24:27], s75 offen lds
  s_waitcnt lgkmcnt(6)
  v_mfma_f32_32x32x16_bf16 v[224:239], a[200:203], a[232:235], v[224:239]
  ds_read_b128 a[244:247], v8 offset:8192
  v_mfma_f32_16x16x32_bf16 a[68:71], a[64:67], a[200:203], a[68:71]
  ds_read_b128 a[248:251], v8 offset:12288
  s_add_u32 m0, s74, 57344
  s_add_u32 s75, s71, 163840
  buffer_load_dwordx4 v2, s[24:27], s75 offen lds
  s_waitcnt lgkmcnt(6)
  v_mfma_f32_32x32x16_bf16 v[112:127], a[204:207], a[216:219], v[112:127]
  ds_read_b128 a[252:255], v8 offset:16384
  v_mfma_f32_32x32x16_bf16 v[144:159], a[204:207], a[220:223], v[144:159]
  ds_read_b64_tr_b16 a[212:213], v10 offset:24576
  s_add_u32 m0, s73, 118784
  s_add_u32 s75, s69, 184320
  buffer_load_dwordx4 v3, s[28:31], s75 offen offset:0 lds
  v_mfma_f32_32x32x16_bf16 v[176:191], a[204:207], a[224:227], v[176:191]
  ds_read_b64_tr_b16 a[214:215], v10 offset:26624
  v_mfma_f32_32x32x16_bf16 v[208:223], a[204:207], a[228:231], v[208:223]
  buffer_load_dwordx4 v4, s[28:31], s75 offen offset:1024 lds
  s_add_u32 s69, s69, 245760
  s_cmp_ge_u32 s69, s70
  s_cselect_b32 s79, 2457600, 0
  s_sub_u32 s69, s69, s79
  s_add_u32 m0, s73, 61440
  s_add_u32 s75, s69, 0
  buffer_load_dwordx4 v3, s[28:31], s75 offen offset:0 lds
  v_mfma_f32_32x32x16_bf16 v[240:255], a[204:207], a[232:235], v[240:255]
  v_mfma_f32_16x16x32_bf16 a[72:75], a[64:67], a[204:207], a[72:75]
  buffer_load_dwordx4 v4, s[28:31], s75 offen offset:1024 lds
  s_waitcnt lgkmcnt(6)
  v_mfma_f32_32x32x16_bf16 v[96:111], a[208:211], a[236:239], v[96:111]
  ds_read_b128 a[216:219], v5 offset:20480
  s_waitcnt lgkmcnt(6)
  v_mfma_f32_32x32x16_bf16 v[128:143], a[208:211], a[240:243], v[128:143]
  ds_read_b64_tr_b16 a[200:201], v9 offset:32768
  s_waitcnt lgkmcnt(6)
  v_mfma_f32_32x32x16_bf16 v[160:175], a[208:211], a[244:247], v[160:175]
  ds_read_b64_tr_b16 a[202:203], v9 offset:34816
  s_add_u32 m0, s73, 69632
  s_add_u32 s75, s69, 61440
  buffer_load_dwordx4 v3, s[28:31], s75 offen offset:0 lds
  s_waitcnt lgkmcnt(6)
  v_mfma_f32_32x32x16_bf16 v[192:207], a[208:211], a[248:251], v[192:207]
  ds_read_b128 a[220:223], v5 offset:24576
  s_waitcnt lgkmcnt(6)
  v_mfma_f32_32x32x16_bf16 v[224:239], a[208:211], a[252:255], v[224:239]
  ds_read_b128 a[224:227], v5 offset:28672
  v_mfma_f32_16x16x32_bf16 a[68:71], a[64:67], a[208:211], a[68:71]
  ds_read_b128 a[228:231], v5 offset:32768
  buffer_load_dwordx4 v4, s[28:31], s75 offen offset:1024 lds
  s_waitcnt lgkmcnt(6)
  v_mfma_f32_32x32x16_bf16 v[112:127], a[212:215], a[236:239], v[112:127]
  ds_read_b128 a[232:235], v5 offset:36864
  v_mfma_f32_32x32x16_bf16 v[144:159], a[212:215], a[240:243], v[144:159]
  ds_read_b64_tr_b16 a[204:205], v10 offset:32768
  v_mfma_f32_32x32x16_bf16 v[176:191], a[212:215], a[244:247], v[176:191]
  ds_read_b64_tr_b16 a[206:207], v10 offset:34816
  v_mfma_f32_32x32x16_bf16 v[208:223], a[212:215], a[248:251], v[208:223]
  v_mfma_f32_32x32x16_bf16 v[240:255], a[212:215], a[252:255], v[240:255]
  v_mfma_f32_16x16x32_bf16 a[72:75], a[64:67], a[212:215], a[72:75]
  s_waitcnt vmcnt(11)
  s_barrier
  s_waitcnt lgkmcnt(6)
  v_mfma_f32_32x32x16_bf16 v[96:111], a[200:203], a[216:219], v[96:111]
  ds_read_b128 a[236:239], v6 offset:20480
  s_add_u32 m0, s73, 77824
  s_add_u32 s75, s69, 122880
  buffer_load_dwordx4 v3, s[28:31], s75 offen offset:0 lds
  s_waitcnt lgkmcnt(6)
  v_mfma_f32_32x32x16_bf16 v[128:143], a[200:203], a[220:223], v[128:143]
  ds_read_b64_tr_b16 a[208:209], v9 offset:40960
  buffer_load_dwordx4 v4, s[28:31], s75 offen offset:1024 lds
  s_waitcnt lgkmcnt(6)
  v_mfma_f32_32x32x16_bf16 v[160:175], a[200:203], a[224:227], v[160:175]
  ds_read_b64_tr_b16 a[210:211], v9 offset:43008
  s_add_u32 m0, s73, 86016
  s_add_u32 s75, s69, 184320
  buffer_load_dwordx4 v3, s[28:31], s75 offen offset:0 lds
  s_waitcnt lgkmcnt(6)
  v_mfma_f32_32x32x16_bf16 v[192:207], a[200:203], a[228:231], v[192:207]
  ds_read_b128 a[240:243], v6 offset:24576
  s_waitcnt lgkmcnt(6)
  v_mfma_f32_32x32x16_bf16 v[224:239], a[200:203], a[232:235], v[224:239]
  ds_read_b128 a[244:247], v6 offset:28672
  buffer_load_dwordx4 v4, s[28:31], s75 offen offset:1024 lds
  v_mfma_f32_16x16x32_bf16 a[68:71], a[64:67], a[200:203], a[68:71]
  ds_read_b128 a[248:251], v6 offset:32768
  s_add_u32 s71, s71, 128
  s_cmp_ge_u32 s71, s72
  s_cselect_b32 s79, 1280, 0
  s_sub_u32 s71, s71, s79
  s_add_u32 m0, s74, 0
  s_add_u32 s75, s71, 0
  buffer_load_dwordx4 v2, s[24:27], s75 offen lds
  s_waitcnt lgkmcnt(6)
  v_mfma_f32_32x32x16_bf16 v[112:127], a[204:207], a[216:219], v[112:127]
  ds_read_b128 a[252:255], v6 offset:36864
  v_mfma_f32_32x32x16_bf16 v[144:159], a[204:207], a[220:223], v[144:159]
  ds_read_b64_tr_b16 a[212:213], v10 offset:40960
  s_add_u32 m0, s74, 4096
  s_add_u32 s75, s71, 40960
  buffer_load_dwordx4 v2, s[24:27], s75 offen lds
  v_mfma_f32_32x32x16_bf16 v[176:191], a[204:207], a[224:227], v[176:191]
  ds_read_b64_tr_b16 a[214:215], v10 offset:43008
  buffer_load_dwordx4 v[32:35], v45, s[52:55], 0 offen
  v_mfma_f32_32x32x16_bf16 v[208:223], a[204:207], a[228:231], v[208:223]
  v_mfma_f32_32x32x16_bf16 v[240:255], a[204:207], a[232:235], v[240:255]
  buffer_load_dwordx4 v[36:39], v45, s[52:55], 0 offen offset:512
  v_mfma_f32_16x16x32_bf16 a[72:75], a[64:67], a[204:207], a[72:75]
  buffer_load_dwordx4 v[40:43], v46, s[52:55], 0 offen
  s_waitcnt lgkmcnt(6)
  v_mfma_f32_32x32x16_bf16 v[96:111], a[208:211], a[236:239], v[96:111]
  ds_read_b128 a[216:219], v7 offset:20480
  v_accvgpr_read_b32 v54, a128
  s_lshl_b32 s75, s64, 12
  s_add_u32 m0, s75, 126976
  s_nop 0
  buffer_load_dwordx4 v54, s[56:59], 0 offen nt lds
  s_waitcnt lgkmcnt(6)
  v_mfma_f32_32x32x16_bf16 v[128:143], a[208:211], a[240:243], v[128:143]
  ds_read_b64_tr_b16 a[200:201], v9 offset:49152
  s_lshl_b32 s76, s83, 2
  s_mul_hi_u32 s77, s76, 0x33333334
  s_mul_i32 s78, s77, 5
  s_sub_u32 s78, s76, s78
  s_waitcnt lgkmcnt(6)
  v_mfma_f32_32x32x16_bf16 v[160:175], a[208:211], a[244:247], v[160:175]
  ds_read_b64_tr_b16 a[202:203], v9 offset:51200
  v_accvgpr_read_b32 v55, a129
  s_lshl_b32 s75, s64, 12
  s_add_u32 m0, s75, 128000
  s_nop 0
  buffer_load_dwordx4 v55, s[56:59], 0 offen nt lds
  s_waitcnt lgkmcnt(6)
  v_mfma_f32_32x32x16_bf16 v[192:207], a[208:211], a[248:251], v[192:207]
  ds_read_b128 a[220:223], v7 offset:24576
  v_accvgpr_read_b32 v54, a130
  s_lshl_b32 s75, s64, 12
  s_add_u32 m0, s75, 129024
  s_nop 0
  buffer_load_dwordx4 v54, s[56:59], 0 offen nt lds
  s_waitcnt lgkmcnt(6)
  v_mfma_f32_32x32x16_bf16 v[224:239], a[208:211], a[252:255], v[224:239]
  ds_read_b128 a[224:227], v7 offset:28672
  s_mul_i32 s77, s77, 74
  s_add_u32 s77, s77, s82
  s_mul_i32 s77, s77, 5120
  v_mfma_f32_16x16x32_bf16 a[68:71], a[64:67], a[208:211], a[68:71]
  ds_read_b128 a[228:231], v7 offset:32768
  v_accvgpr_read_b32 v55, a131
  s_lshl_b32 s75, s64, 12
  s_add_u32 m0, s75, 130048
  s_nop 0
  buffer_load_dwordx4 v55, s[56:59], 0 offen nt lds
  s_waitcnt lgkmcnt(6)
  v_mfma_f32_32x32x16_bf16 v[112:127], a[212:215], a[236:239], v[112:127]
  ds_read_b128 a[232:235], v7 offset:36864
  s_lshl_b32 s75, s64, 11
  s_add_u32 m0, s75, 143360
  s_nop 0
  buffer_load_dwordx4 v11, s[60:63], 0 offen lds
  v_mfma_f32_32x32x16_bf16 v[144:159], a[212:215], a[240:243], v[144:159]
  ds_read_b64_tr_b16 a[204:205], v10 offset:49152
  s_lshl_b32 s76, s78, 10
  s_add_u32 s77, s77, s76
  s_add_u32 s6, s77, 2621440
  v_mfma_f32_32x32x16_bf16 v[176:191], a[212:215], a[244:247], v[176:191]
  ds_read_b64_tr_b16 a[206:207], v10 offset:51200
  s_cmp_ge_u32 s82, 74
  s_cselect_b32 s6, 1073741824, s6
  s_cmp_eq_u32 s78, 4
  s_cselect_b32 s76, 373760, 0
  v_mfma_f32_32x32x16_bf16 v[208:223], a[212:215], a[248:251], v[208:223]
  s_add_u32 s7, s6, s76
  s_cmp_eq_u32 s78, 3
  s_cselect_b32 s76, 373760, 0
  s_add_u32 s10, s7, s76
  s_cmp_eq_u32 s78, 2
  s_cselect_b32 s76, 373760, 0
  v_mfma_f32_32x32x16_bf16 v[240:255], a[212:215], a[252:255], v[240:255]
  s_add_u32 s11, s10, s76
  v_mfma_f32_16x16x32_bf16 a[72:75], a[64:67], a[212:215], a[72:75]
  s_waitcnt vmcnt(16)
  s_barrier
  s_waitcnt lgkmcnt(6)
  v_mfma_f32_32x32x16_bf16 v[96:111], a[200:203], a[216:219], v[96:111]
  ds_read_b128 a[236:239], v8 offset:20480
  s_add_u32 s69, s69, 245760
  s_cmp_ge_u32 s69, s70
  s_cselect_b32 s79, 2457600, 0
  s_sub_u32 s69, s69, s79
  s_add_u32 m0, s73, 94208
  s_add_u32 s75, s69, 0
  buffer_load_dwordx4 v3, s[28:31], s75 offen offset:0 lds
  s_waitcnt lgkmcnt(6)
  v_mfma_f32_32x32x16_bf16 v[128:143], a[200:203], a[220:223], v[128:143]
  ds_read_b64_tr_b16 a[208:209], v9 offset:57344
  s_waitcnt lgkmcnt(6)
  v_mfma_f32_32x32x16_bf16 v[160:175], a[200:203], a[224:227], v[160:175]
  ds_read_b64_tr_b16 a[210:211], v9 offset:59392
  buffer_load_dwordx4 v4, s[28:31], s75 offen offset:1024 lds
  s_waitcnt lgkmcnt(6)
  v_mfma_f32_32x32x16_bf16 v[192:207], a[200:203], a[228:231], v[192:207]
  ds_read_b128 a[240:243], v8 offset:24576
  s_waitcnt lgkmcnt(6)
  v_mfma_f32_32x32x16_bf16 v[224:239], a[200:203], a[232:235], v[224:239]
  ds_read_b128 a[244:247], v8 offset:28672
  v_mfma_f32_16x16x32_bf16 a[68:71], a[64:67], a[200:203], a[68:71]
  ds_read_b128 a[248:251], v8 offset:32768
  s_add_u32 m0, s73, 102400
  s_add_u32 s75, s69, 61440
  buffer_load_dwordx4 v3, s[28:31], s75 offen offset:0 lds
  s_waitcnt lgkmcnt(6)
  v_mfma_f32_32x32x16_bf16 v[112:127], a[204:207], a[216:219], v[112:127]
  ds_read_b128 a[252:255], v8 offset:36864
  v_mfma_f32_32x32x16_bf16 v[144:159], a[204:207], a[220:223], v[144:159]
  ds_read_b64_tr_b16 a[212:213], v10 offset:57344
  v_mfma_f32_32x32x16_bf16 v[176:191], a[204:207], a[224:227], v[176:191]
  ds_read_b64_tr_b16 a[214:215], v10 offset:59392
  buffer_load_dwordx4 v4, s[28:31], s75 offen offset:1024 lds
  v_mfma_f32_32x32x16_bf16 v[208:223], a[204:207], a[228:231], v[208:223]
  v_mfma_f32_32x32x16_bf16 v[240:255], a[204:207], a[232:235], v[240:255]
  v_mfma_f32_16x16x32_bf16 a[72:75], a[64:67], a[204:207], a[72:75]
  s_add_u32 m0, s74, 8192
  s_add_u32 s75, s71, 81920
  buffer_load_dwordx4 v2, s[24:27], s75 offen lds
  s_waitcnt lgkmcnt(6)
  v_mfma_f32_32x32x16_bf16 v[96:111], a[208:211], a[236:239], v[96:111]
  ds_read_b128 a[216:219], v5 offset:40960
  s_waitcnt lgkmcnt(6)
  v_mfma_f32_32x32x16_bf16 v[128:143], a[208:211], a[240:243], v[128:143]
  ds_read_b64_tr_b16 a[200:201], v9 offset:0
  s_waitcnt lgkmcnt(6)
  v_mfma_f32_32x32x16_bf16 v[160:175], a[208:211], a[244:247], v[160:175]
  ds_read_b64_tr_b16 a[202:203], v9 offset:2048
  s_add_u32 m0, s74, 12288
  s_add_u32 s75, s71, 122880
  buffer_load_dwordx4 v2, s[24:27], s75 offen lds
  s_waitcnt lgkmcnt(6)
  v_mfma_f32_32x32x16_bf16 v[192:207], a[208:211], a[248:251], v[192:207]
  ds_read_b128 a[220:223], v5 offset:45056
  s_waitcnt lgkmcnt(6)
  v_mfma_f32_32x32x16_bf16 v[224:239], a[208:211], a[252:255], v[224:239]
  ds_read_b128 a[224:227], v5 offset:49152
  v_mfma_f32_16x16x32_bf16 a[68:71], a[64:67], a[208:211], a[68:71]
  ds_read_b128 a[228:231], v5 offset:53248
  s_add_u32 m0, s74, 16384
  s_add_u32 s75, s71, 163840
  buffer_load_dwordx4 v2, s[24:27], s75 offen lds
  s_waitcnt lgkmcnt(6)
  v_mfma_f32_32x32x16_bf16 v[112:127], a[212:215], a[236:239], v[112:127]
  ds_read_b128 a[232:235], v5 offset:57344
  v_mfma_f32_32x32x16_bf16 v[144:159], a[212:215], a[240:243], v[144:159]
  ds_read_b64_tr_b16 a[204:205], v10 offset:0
  v_mfma_f32_32x32x16_bf16 v[176:191], a[212:215], a[244:247], v[176:191]
  ds_read_b64_tr_b16 a[206:207], v10 offset:2048
  v_mfma_f32_32x32x16_bf16 v[208:223], a[212:215], a[248:251], v[208:223]
  v_mfma_f32_32x32x16_bf16 v[240:255], a[212:215], a[252:255], v[240:255]
  v_mfma_f32_16x16x32_bf16 a[72:75], a[64:67], a[212:215], a[72:75]
  s_waitcnt vmcnt(19)
  s_barrier
  s_waitcnt lgkmcnt(6)
  v_mfma_f32_32x32x16_bf16 v[96:111], a[200:203], a[216:219], v[96:111]
  ds_read_b128 a[236:239], v6 offset:40960
  s_add_u32 m0, s73, 110592
  s_add_u32 s75, s69, 122880
  buffer_load_dwordx4 v3, s[28:31], s75 offen offset:0 lds
  s_waitcnt lgkmcnt(6)
  v_mfma_f32_32x32x16_bf16 v[128:143], a[200:203], a[220:223], v[128:143]
  ds_read_b64_tr_b16 a[208:209], v9 offset:8192
  v_mov_b32 v66, 0
  s_cmp_eq_u32 s64, 0
  s_cselect_b32 s80, 0, 1073741824
  buffer_load_dword v67, v66, s[48:51], s80 offen sc1
  s_waitcnt lgkmcnt(6)
  v_mfma_f32_32x32x16_bf16 v[160:175], a[200:203], a[224:227], v[160:175]
  ds_read_b64_tr_b16 a[210:211], v9 offset:10240
  s_waitcnt lgkmcnt(6)
  v_mfma_f32_32x32x16_bf16 v[192:207], a[200:203], a[228:231], v[192:207]
  ds_read_b128 a[240:243], v6 offset:45056
  buffer_load_dwordx4 v4, s[28:31], s75 offen offset:1024 lds
  s_waitcnt lgkmcnt(6)
  v_mfma_f32_32x32x16_bf16 v[224:239], a[200:203], a[232:235], v[224:239]
  ds_read_b128 a[244:247], v6 offset:49152
  s_waitcnt lgkmcnt(5)
  v_mfma_f32_32x32x16_bf16 v[112:127], a[204:207], a[216:219], v[112:127]
  ds_read_b128 a[248:251], v6 offset:53248
  v_mfma_f32_32x32x16_bf16 v[144:159], a[204:207], a[220:223], v[144:159]
  ds_read_b128 a[252:255], v6 offset:57344
  s_add_u32 m0, s73, 118784
  s_add_u32 s75, s69, 184320
  buffer_load_dwordx4 v3, s[28:31], s75 offen offset:0 lds
  v_mfma_f32_32x32x16_bf16 v[176:191], a[204:207], a[224:227], v[176:191]
  ds_read_b64_tr_b16 a[212:213], v10 offset:8192
  v_mfma_f32_32x32x16_bf16 v[208:223], a[204:207], a[228:231], v[208:223]
  ds_read_b64_tr_b16 a[214:215], v10 offset:10240
  v_mfma_f32_32x32x16_bf16 v[240:255], a[204:207], a[232:235], v[240:255]
  s_waitcnt lgkmcnt(6)
  v_mfma_f32_32x32x16_bf16 v[96:111], a[208:211], a[236:239], v[96:111]
  ds_read_b128 a[216:219], v7 offset:40960
  buffer_load_dwordx4 v4, s[28:31], s75 offen offset:1024 lds
  s_waitcnt lgkmcnt(6)
  v_mfma_f32_32x32x16_bf16 v[128:143], a[208:211], a[240:243], v[128:143]
  ds_read_b64_tr_b16 a[200:201], v9 offset:16384
  s_waitcnt lgkmcnt(6)
  v_mfma_f32_32x32x16_bf16 v[160:175], a[208:211], a[244:247], v[160:175]
  ds_read_b64_tr_b16 a[202:203], v9 offset:18432
  s_waitcnt lgkmcnt(6)
  v_mfma_f32_32x32x16_bf16 v[192:207], a[208:211], a[248:251], v[192:207]
  ds_read_b128 a[220:223], v7 offset:45056
  s_add_u32 s71, s71, 128
  s_cmp_ge_u32 s71, s72
  s_cselect_b32 s79, 1280, 0
  s_sub_u32 s71, s71, s79
  s_add_u32 m0, s74, 20480
  s_add_u32 s75, s71, 0
  buffer_load_dwordx4 v2, s[24:27], s75 offen lds
  s_waitcnt lgkmcnt(6)
  v_mfma_f32_32x32x16_bf16 v[224:239], a[208:211], a[252:255], v[224:239]
  ds_read_b128 a[224:227], v7 offset:49152
  s_waitcnt lgkmcnt(5)
  v_mfma_f32_32x32x16_bf16 v[112:127], a[212:215], a[236:239], v[112:127]
  ds_read_b128 a[228:231], v7 offset:53248
  v_mfma_f32_32x32x16_bf16 v[144:159], a[212:215], a[240:243], v[144:159]
  ds_read_b128 a[232:235], v7 offset:57344
  s_add_u32 m0, s74, 24576
  s_add_u32 s75, s71, 40960
  buffer_load_dwordx4 v2, s[24:27], s75 offen lds
  v_mfma_f32_32x32x16_bf16 v[176:191], a[212:215], a[244:247], v[176:191]
  ds_read_b64_tr_b16 a[204:205], v10 offset:16384
  v_mfma_f32_32x32x16_bf16 v[208:223], a[212:215], a[248:251], v[208:223]
  ds_read_b64_tr_b16 a[206:207], v10 offset:18432
  v_mfma_f32_32x32x16_bf16 v[240:255], a[212:215], a[252:255], v[240:255]
  s_waitcnt vmcnt(7)
  s_barrier
  s_waitcnt lgkmcnt(6)
  v_mfma_f32_32x32x16_bf16 v[96:111], a[200:203], a[216:219], v[96:111]
  ds_read_b128 a[236:239], v8 offset:40960
  s_add_u32 s69, s69, 245760
  s_cmp_ge_u32 s69, s70
  s_cselect_b32 s79, 2457600, 0
  s_sub_u32 s69, s69, s79
  s_add_u32 m0, s73, 61440
  s_add_u32 s75, s69, 0
  buffer_load_dwordx4 v3, s[28:31], s75 offen offset:0 lds
  s_waitcnt lgkmcnt(6)
  v_mfma_f32_32x32x16_bf16 v[128:143], a[200:203], a[220:223], v[128:143]
  ds_read_b64_tr_b16 a[208:209], v9 offset:24576
  ds_read_b64_tr_b16 a[132:133], v14 offset:0
  ds_read_b64_tr_b16 a[134:135], v14 offset:512
  s_waitcnt lgkmcnt(8)
  v_mfma_f32_32x32x16_bf16 v[160:175], a[200:203], a[224:227], v[160:175]
  ds_read_b64_tr_b16 a[210:211], v9 offset:26624
  buffer_load_dwordx4 v4, s[28:31], s75 offen offset:1024 lds
  ds_read_b64_tr_b16 a[136:137], v14 offset:32
  s_waitcnt lgkmcnt(9)
  v_mfma_f32_32x32x16_bf16 v[192:207], a[200:203], a[228:231], v[192:207]
  ds_read_b128 a[240:243], v8 offset:45056
  ds_read_b64_tr_b16 a[138:139], v14 offset:544
  s_waitcnt lgkmcnt(10)
  v_mfma_f32_32x32x16_bf16 v[224:239], a[200:203], a[232:235], v[224:239]
  ds_read_b128 a[244:247], v8 offset:49152
  ds_read_b64_tr_b16 a[140:141], v14 offset:64
  s_waitcnt lgkmcnt(10)
  v_mfma_f32_32x32x16_bf16 v[112:127], a[204:207], a[216:219], v[112:127]
  ds_read_b128 a[248:251], v8 offset:53248
  s_add_u32 m0, s73, 69632
  s_add_u32 s75, s69, 61440
  buffer_load_dwordx4 v3, s[28:31], s75 offen offset:0 lds
  v_mfma_f32_32x32x16_bf16 v[144:159], a[204:207], a[220:223], v[144:159]
  ds_read_b128 a[252:255], v8 offset:57344
  ds_read_b64_tr_b16 a[142:143], v14 offset:576
  v_mfma_f32_32x32x16_bf16 v[176:191], a[204:207], a[224:227], v[176:191]
  ds_read_b64_tr_b16 a[212:213], v10 offset:24576
  ds_read_b64_tr_b16 a[144:145], v14 offset:96
  ds_read_b64_tr_b16 a[146:147], v14 offset:608
  v_mfma_f32_32x32x16_bf16 v[208:223], a[204:207], a[228:231], v[208:223]
  ds_read_b64_tr_b16 a[214:215], v10 offset:26624
  buffer_load_dwordx4 v4, s[28:31], s75 offen offset:1024 lds
  v_mfma_f32_32x32x16_bf16 v[240:255], a[204:207], a[232:235], v[240:255]
  s_waitcnt lgkmcnt(12)
  v_mfma_f32_32x32x16_bf16 v[96:111], a[208:211], a[236:239], v[96:111]
  ds_read_b128 a[216:219], v5 offset:0
  buffer_store_dwordx4 a[132:135], v15, s[40:43], s6 offen offset:0 sc1
  s_waitcnt lgkmcnt(11)
  v_mfma_f32_32x32x16_bf16 v[128:143], a[208:211], a[240:243], v[128:143]
  ds_read_b64_tr_b16 a[200:201], v9 offset:32768
  s_add_u32 m0, s74, 28672
  s_add_u32 s75, s71, 81920
  buffer_load_dwordx4 v2, s[24:27], s75 offen lds
  s_waitcnt lgkmcnt(10)
  v_mfma_f32_32x32x16_bf16 v[160:175], a[208:211], a[244:247], v[160:175]
  ds_read_b64_tr_b16 a[202:203], v9 offset:34816
  buffer_store_dwordx4 a[136:139], v15, s[40:43], s7 offen offset:1024 sc1
  s_waitcnt lgkmcnt(7)
  buffer_store_dwordx4 a[140:143], v15, s[40:43], s10 offen offset:2048 sc1
  v_mfma_f32_32x32x16_bf16 v[192:207], a[208:211], a[248:251], v[192:207]
  ds_read_b128 a[220:223], v5 offset:4096
  s_waitcnt lgkmcnt(5)
  buffer_store_dwordx4 a[144:147], v15, s[40:43], s11 offen offset:3072 sc1
  v_lshlrev_b32 v70, 2, v1
  v_mfma_f32_32x32x16_bf16 v[224:239], a[208:211], a[252:255], v[224:239]
  ds_read_b128 a[224:227], v5 offset:8192
  s_add_u32 m0, s74, 32768
  s_add_u32 s75, s71, 122880
  buffer_load_dwordx4 v2, s[24:27], s75 offen lds
  s_waitcnt lgkmcnt(5)
  v_mfma_f32_32x32x16_bf16 v[112:127], a[212:215], a[236:239], v[112:127]
  ds_read_b128 a[228:231], v5 offset:12288
  s_add_u32 s80, s68, s3
  s_lshl_b32 s80, s80, 7
  v_mfma_f32_32x32x16_bf16 v[144:159], a[212:215], a[240:243], v[144:159]
  ds_read_b128 a[232:235], v5 offset:16384
  buffer_store_dword a68, v70, s[36:39], s80 offen offset:0 sc1
  v_mfma_f32_32x32x16_bf16 v[176:191], a[212:215], a[244:247], v[176:191]
  ds_read_b64_tr_b16 a[204:205], v10 offset:32768
  s_add_u32 m0, s74, 36864
  s_add_u32 s75, s71, 163840
  buffer_load_dwordx4 v2, s[24:27], s75 offen lds
  v_mfma_f32_32x32x16_bf16 v[208:223], a[212:215], a[248:251], v[208:223]
  ds_read_b64_tr_b16 a[206:207], v10 offset:34816
  buffer_store_dword a72, v70, s[36:39], s80 offen offset:1280 sc1
  v_accvgpr_write_b32 a148, 0
  v_accvgpr_write_b32 a149, 0
  v_mfma_f32_32x32x16_bf16 v[240:255], a[212:215], a[252:255], v[240:255]
  v_accvgpr_write_b32 a150, 0
  v_accvgpr_write_b32 a151, 0
  s_mul_i32 s80, s2, 10240
  s_lshl_b32 s78, s64, 10
  s_add_u32 s80, s80, s78
  s_waitcnt vmcnt(17)
  s_barrier
  s_waitcnt lgkmcnt(6)
  v_mfma_f32_32x32x16_bf16 v[96:111], a[200:203], a[216:219], v[96:111]
  ds_read_b128 a[236:239], v6 offset:0
  s_add_u32 m0, s73, 77824
  s_add_u32 s75, s69, 122880
  buffer_load_dwordx4 v3, s[28:31], s75 offen offset:0 lds
  s_waitcnt lgkmcnt(6)
  v_mfma_f32_32x32x16_bf16 v[128:143], a[200:203], a[220:223], v[128:143]
  ds_read_b64_tr_b16 a[208:209], v9 offset:40960
  buffer_store_dwordx4 a[148:151], v15, s[40:43], s80 offen sc1
  s_add_u32 s80, s80, 4096
  s_waitcnt lgkmcnt(6)
  v_mfma_f32_32x32x16_bf16 v[160:175], a[200:203], a[224:227], v[160:175]
  ds_read_b64_tr_b16 a[210:211], v9 offset:43008
  buffer_store_dwordx4 a[148:151], v15, s[40:43], s80 offen sc1
  s_waitcnt lgkmcnt(6)
  v_mfma_f32_32x32x16_bf16 v[192:207], a[200:203], a[228:231], v[192:207]
  ds_read_b128 a[240:243], v6 offset:4096
  buffer_load_dwordx4 v4, s[28:31], s75 offen offset:1024 lds
  s_waitcnt lgkmcnt(6)
  v_mfma_f32_32x32x16_bf16 v[224:239], a[200:203], a[232:235], v[224:239]
  ds_read_b128 a[244:247], v6 offset:8192
  s_add_u32 s80, s80, 4096
  s_cmp_ge_u32 s64, 2
  s_cselect_b32 s80, 1073741824, s80
  s_waitcnt lgkmcnt(5)
  v_mfma_f32_32x32x16_bf16 v[112:127], a[204:207], a[216:219], v[112:127]
  ds_read_b128 a[248:251], v6 offset:12288
  buffer_store_dwordx4 a[148:151], v15, s[40:43], s80 offen sc1
  s_lshl_b32 s80, s65, 4
  v_mfma_f32_32x32x16_bf16 v[144:159], a[204:207], a[220:223], v[144:159]
  ds_read_b128 a[252:255], v6 offset:16384
  s_add_u32 m0, s73, 86016
  s_add_u32 s75, s69, 184320
  buffer_load_dwordx4 v3, s[28:31], s75 offen offset:0 lds
  v_mfma_f32_32x32x16_bf16 v[176:191], a[204:207], a[224:227], v[176:191]
  ds_read_b64_tr_b16 a[212:213], v10 offset:40960
  s_add_u32 s80, s80, s66
  s_lshl_b32 s80, s80, 2
  s_add_u32 s80, s80, s64
  s_lshl_b32 s80, s80, 12
  v_mfma_f32_32x32x16_bf16 v[208:223], a[204:207], a[228:231], v[208:223]
  ds_read_b64_tr_b16 a[214:215], v10 offset:43008
  s_add_u32 s80, s80, 8273920
  buffer_store_dwordx4 a[148:151], v15, s[40:43], s80 offen offset:0 sc1
  v_mfma_f32_32x32x16_bf16 v[240:255], a[204:207], a[232:235], v[240:255]
  buffer_store_dwordx4 a[148:151], v15, s[40:43], s80 offen offset:1024 sc1
  buffer_store_dwordx4 a[148:151], v15, s[40:43], s80 offen offset:2048 sc1
  buffer_store_dwordx4 a[148:151], v15, s[40:43], s80 offen offset:3072 sc1
  s_waitcnt lgkmcnt(6)
  v_mfma_f32_32x32x16_bf16 v[96:111], a[208:211], a[236:239], v[96:111]
  ds_read_b128 a[216:219], v7 offset:0
  buffer_load_dwordx4 v4, s[28:31], s75 offen offset:1024 lds
  s_mov_b32 s76, 0x3f803f80
  s_waitcnt lgkmcnt(6)
  v_mfma_f32_32x32x16_bf16 v[128:143], a[208:211], a[240:243], v[128:143]
  ds_read_b64_tr_b16 a[200:201], v9 offset:49152
  v_mov_b32 v70, 0
  v_mov_b32 v71, 0
  v_mov_b32 v44, 0
  v_mov_b32 v45, 0
  s_waitcnt lgkmcnt(6)
  v_mfma_f32_32x32x16_bf16 v[160:175], a[208:211], a[244:247], v[160:175]
  ds_read_b64_tr_b16 a[202:203], v9 offset:51200
  v_dot2_f32_bf16 v70, v32, s76, v70
  v_dot2_f32_bf16 v71, v32, v32, v71
  v_dot2_f32_bf16 v44, v33, s76, v44
  v_dot2_f32_bf16 v45, v33, v33, v45
  s_waitcnt lgkmcnt(6)
  v_mfma_f32_32x32x16_bf16 v[192:207], a[208:211], a[248:251], v[192:207]
  ds_read_b128 a[220:223], v7 offset:4096
  s_add_u32 s71, s71, 128
  s_cmp_ge_u32 s71, s72
  s_cselect_b32 s79, 1280, 0
  s_sub_u32 s71, s71, s79
  s_add_u32 m0, s74, 40960
  s_add_u32 s75, s71, 0
  buffer_load_dwordx4 v2, s[24:27], s75 offen lds
  s_waitcnt lgkmcnt(6)
  v_mfma_f32_32x32x16_bf16 v[224:239], a[208:211], a[252:255], v[224:239]
  ds_read_b128 a[224:227], v7 offset:8192
  v_dot2_f32_bf16 v70, v34, s76, v70
  v_dot2_f32_bf16 v71, v34, v34, v71
  v_dot2_f32_bf16 v44, v35, s76, v44
  s_waitcnt lgkmcnt(5)
  v_mfma_f32_32x32x16_bf16 v[112:127], a[212:215], a[236:239], v[112:127]
  ds_read_b128 a[228:231], v7 offset:12288
  v_dot2_f32_bf16 v45, v35, v35, v45
  v_dot2_f32_bf16 v70, v36, s76, v70
  v_dot2_f32_bf16 v71, v36, v36, v71
  v_mfma_f32_32x32x16_bf16 v[144:159], a[212:215], a[240:243], v[144:159]
  ds_read_b128 a[232:235], v7 offset:16384
  s_add_u32 m0, s74, 45056
  s_add_u32 s75, s71, 40960
  buffer_load_dwordx4 v2, s[24:27], s75 offen lds
  v_mfma_f32_32x32x16_bf16 v[176:191], a[212:215], a[244:247], v[176:191]
  ds_read_b64_tr_b16 a[204:205], v10 offset:49152
  v_dot2_f32_bf16 v44, v37, s76, v44
  v_dot2_f32_bf16 v45, v37, v37, v45
  v_dot2_f32_bf16 v70, v38, s76, v70
  v_dot2_f32_bf16 v71, v38, v38, v71
  v_mfma_f32_32x32x16_bf16 v[208:223], a[212:215], a[248:251], v[208:223]
  ds_read_b64_tr_b16 a[206:207], v10 offset:51200
  v_dot2_f32_bf16 v44, v39, s76, v44
  v_dot2_f32_bf16 v45, v39, v39, v45
  v_dot2_f32_bf16 v70, v40, s76, v70
  v_dot2_f32_bf16 v71, v40, v40, v71
  v_mfma_f32_32x32x16_bf16 v[240:255], a[212:215], a[252:255], v[240:255]
  v_dot2_f32_bf16 v44, v41, s76, v44
  v_dot2_f32_bf16 v45, v41, v41, v45
  v_dot2_f32_bf16 v70, v42, s76, v70
  v_dot2_f32_bf16 v71, v42, v42, v71
  v_dot2_f32_bf16 v44, v43, s76, v44
  v_dot2_f32_bf16 v45, v43, v43, v45
  s_waitcnt vmcnt(14)
  s_barrier
  s_waitcnt lgkmcnt(6)
  v_mfma_f32_32x32x16_bf16 v[96:111], a[200:203], a[216:219], v[96:111]
  ds_read_b128 a[236:239], v8 offset:0
  s_add_u32 s69, s69, 245760
  s_cmp_ge_u32 s69, s70
  s_cselect_b32 s79, 2457600, 0
  s_sub_u32 s69, s69, s79
  s_add_u32 m0, s73, 94208
  s_add_u32 s75, s69, 0
  buffer_load_dwordx4 v3, s[28:31], s75 offen offset:0 lds
  s_waitcnt lgkmcnt(6)
  v_mfma_f32_32x32x16_bf16 v[128:143], a[200:203], a[220:223], v[128:143]
  ds_read_b64_tr_b16 a[208:209], v9 offset:57344
  v_pk_add_f32 v[70:71], v[70:71], v[44:45]
  s_waitcnt lgkmcnt(6)
  v_mfma_f32_32x32x16_bf16 v[160:175], a[200:203], a[224:227], v[160:175]
  ds_read_b64_tr_b16 a[210:211], v9 offset:59392
  buffer_load_dwordx4 v4, s[28:31], s75 offen offset:1024 lds
  v_add_f32_dpp v70, v70, v70 row_ror:8 row_mask:0xf bank_mask:0xf
  v_add_f32_dpp v71, v71, v71 row_ror:8 row_mask:0xf bank_mask:0xf
  s_waitcnt lgkmcnt(6)
  v_mfma_f32_32x32x16_bf16 v[192:207], a[200:203], a[228:231], v[192:207]
  ds_read_b128 a[240:243], v8 offset:4096
  v_add_f32_dpp v70, v70, v70 row_ror:4 row_mask:0xf bank_mask:0xf
  v_add_f32_dpp v71, v71, v71 row_ror:4 row_mask:0xf bank_mask:0xf
  s_waitcnt lgkmcnt(6)
  v_mfma_f32_32x32x16_bf16 v[224:239], a[200:203], a[232:235], v[224:239]
  ds_read_b128 a[244:247], v8 offset:8192
  v_add_f32_dpp v70, v70, v70 row_ror:2 row_mask:0xf bank_mask:0xf
  v_add_f32_dpp v71, v71, v71 row_ror:2 row_mask:0xf bank_mask:0xf
  s_waitcnt lgkmcnt(5)
  v_mfma_f32_32x32x16_bf16 v[112:127], a[204:207], a[216:219], v[112:127]
  ds_read_b128 a[248:251], v8 offset:12288
  s_add_u32 m0, s73, 102400
  s_add_u32 s75, s69, 61440
  buffer_load_dwordx4 v3, s[28:31], s75 offen offset:0 lds
  v_mfma_f32_32x32x16_bf16 v[144:159], a[204:207], a[220:223], v[144:159]
  ds_read_b128 a[252:255], v8 offset:16384
  v_add_f32_dpp v70, v70, v70 row_ror:1 row_mask:0xf bank_mask:0xf
  v_add_f32_dpp v71, v71, v71 row_ror:1 row_mask:0xf bank_mask:0xf
  v_mov_b32 v44, v70
  v_mfma_f32_32x32x16_bf16 v[176:191], a[204:207], a[224:227], v[176:191]
  ds_read_b64_tr_b16 a[212:213], v10 offset:57344
  v_mov_b32 v45, v71
  v_permlane16_swap_b32 v70, v44
  v_mfma_f32_32x32x16_bf16 v[208:223], a[204:207], a[228:231], v[208:223]
  ds_read_b64_tr_b16 a[214:215], v10 offset:59392
  buffer_load_dwordx4 v4, s[28:31], s75 offen offset:1024 lds
  v_permlane16_swap_b32 v71, v45
  v_pk_add_f32 v[70:71], v[70:71], v[44:45]
  v_mfma_f32_32x32x16_bf16 v[240:255], a[204:207], a[232:235], v[240:255]
  v_mul_f32 v70, 0x3acccccd, v70
  v_mul_f32 v71, 0x3acccccd, v71
  v_fma_f32 v71, -v70, v70, v71
  v_max_f32 v71, 0, v71
  v_add_f32 v71, 0x3727c5ac, v71
  s_waitcnt lgkmcnt(6)
  v_mfma_f32_32x32x16_bf16 v[96:111], a[208:211], a[236:239], v[96:111]
  ds_read_b128 a[216:219], v5 offset:20480
  v_rsq_f32 v71, v71
  v_lshlrev_b32 v32, 3, v68
  s_waitcnt lgkmcnt(6)
  v_mfma_f32_32x32x16_bf16 v[128:143], a[208:211], a[240:243], v[128:143]
  ds_read_b64_tr_b16 a[200:201], v9 offset:0
  s_add_u32 m0, s74, 49152
  s_add_u32 s75, s71, 81920
  buffer_load_dwordx4 v2, s[24:27], s75 offen lds
  s_waitcnt lgkmcnt(6)
  v_mfma_f32_32x32x16_bf16 v[160:175], a[208:211], a[244:247], v[160:175]
  ds_read_b64_tr_b16 a[202:203], v9 offset:2048
  v_and_b32 v33, 31, v1
  v_cmp_eq_u32 vcc, 0, v33
  v_mov_b32 v33, 1073741824
  s_waitcnt lgkmcnt(6)
  v_mfma_f32_32x32x16_bf16 v[192:207], a[208:211], a[248:251], v[192:207]
  ds_read_b128 a[220:223], v5 offset:24576
  v_cndmask_b32 v32, v33, v32, vcc
  buffer_store_dwordx2 v[70:71], v32, s[32:35], 0 offen sc1
  s_waitcnt lgkmcnt(6)
  v_mfma_f32_32x32x16_bf16 v[224:239], a[208:211], a[252:255], v[224:239]
  ds_read_b128 a[224:227], v5 offset:28672
  s_add_u32 m0, s74, 53248
  s_add_u32 s75, s71, 122880
  buffer_load_dwordx4 v2, s[24:27], s75 offen lds
  s_waitcnt lgkmcnt(5)
  v_mfma_f32_32x32x16_bf16 v[112:127], a[212:215], a[236:239], v[112:127]
  ds_read_b128 a[228:231], v5 offset:32768
  ds_read_u16 v72, v84 offset:0
  v_mfma_f32_32x32x16_bf16 v[144:159], a[212:215], a[240:243], v[144:159]
  ds_read_b128 a[232:235], v5 offset:36864
  ds_read_u16 v73, v84 offset:40
  v_mfma_f32_32x32x16_bf16 v[176:191], a[212:215], a[244:247], v[176:191]
  ds_read_b64_tr_b16 a[204:205], v10 offset:0
  s_add_u32 m0, s74, 57344
  s_add_u32 s75, s71, 163840
  buffer_load_dwordx4 v2, s[24:27], s75 offen lds
  v_mfma_f32_32x32x16_bf16 v[208:223], a[212:215], a[248:251], v[208:223]
  ds_read_b64_tr_b16 a[206:207], v10 offset:2048
  ds_read_u16 v74, v84 offset:80
  ds_read_u16 v75, v84 offset:120
  v_mfma_f32_32x32x16_bf16 v[240:255], a[212:215], a[252:255], v[240:255]
  ds_read_u16 v76, v84 offset:320
  ds_read_u16 v77, v84 offset:360
  ds_read_u16 v78, v84 offset:400
  s_waitcnt vmcnt(17)
  ds_read_u16 v79, v84 offset:440
  ds_read_u16 v80, v85 offset:640
  ds_read_u16 v81, v85 offset:680
  ds_read_u16 v82, v85 offset:720
  ds_read_u16 v83, v85 offset:760
  s_waitcnt lgkmcnt(12)
  v_lshl_or_b32 v24, v73, 16, v72
  s_waitcnt lgkmcnt(8)
  v_lshl_or_b32 v25, v75, 16, v74
  s_waitcnt lgkmcnt(6)
  v_lshl_or_b32 v26, v77, 16, v76
  s_waitcnt lgkmcnt(4)
  v_lshl_or_b32 v27, v79, 16, v78
  s_waitcnt lgkmcnt(2)
  v_lshl_or_b32 v28, v81, 16, v80
  s_waitcnt lgkmcnt(0)
  v_lshl_or_b32 v29, v83, 16, v82
  v_mov_b32 v30, 0
  v_mov_b32 v31, 0
  s_waitcnt vmcnt(2)
  s_cmp_eq_u32 s64, 0
  s_cselect_b64 s[76:77], -1, 0
  v_cmp_ne_u32 vcc, 1, v67
  s_and_b64 vcc, vcc, s[76:77]
  s_cbranch_vccnz L_zspin_att
L_zspin_att_go:
  s_barrier
  v_mfma_f32_32x32x16_bf16 v[96:111], a[200:203], a[216:219], v[96:111]
  ds_read_b128 a[236:239], v6 offset:20480
  s_add_u32 m0, s73, 110592
  s_add_u32 s75, s69, 122880
  buffer_load_dwordx4 v3, s[28:31], s75 offen offset:0 lds
  v_mfma_f32_32x32x16_bf16 v[128:143], a[200:203], a[220:223], v[128:143]
  ds_read_b64_tr_b16 a[208:209], v9 offset:8192
  s_lshl_b32 s80, s2, 2
  s_add_u32 s80, s80, 4096
  v_cmp_eq_u32 vcc, 0, v1
  v_mov_b32 v70, 1073741824
  v_mfma_f32_32x32x16_bf16 v[160:175], a[200:203], a[224:227], v[160:175]
  ds_read_b64_tr_b16 a[210:211], v9 offset:10240
  v_cndmask_b32 v70, v70, 0, vcc
  v_mov_b32 v71, 1
  v_mfma_f32_32x32x16_bf16 v[192:207], a[200:203], a[228:231], v[192:207]
  ds_read_b128 a[240:243], v6 offset:24576
  buffer_load_dwordx4 v4, s[28:31], s75 offen offset:1024 lds
  v_mfma_f32_32x32x16_bf16 v[224:239], a[200:203], a[232:235], v[224:239]
  ds_read_b128 a[244:247], v6 offset:28672
  s_cmp_eq_u32 s64, 0
  s_cselect_b32 s79, s80, 1073741824
  buffer_store_dword v71, v70, s[44:47], s79 offen sc1
  v_mfma_f32_32x32x16_bf16 v[112:127], a[204:207], a[216:219], v[112:127]
  ds_read_b128 a[248:251], v6 offset:32768
  v_mfma_f32_32x32x16_bf16 v[144:159], a[204:207], a[220:223], v[144:159]
  ds_read_b128 a[252:255], v6 offset:36864
  s_add_u32 m0, s73, 118784
  s_add_u32 s75, s69, 184320
  buffer_load_dwordx4 v3, s[28:31], s75 offen offset:0 lds
  v_mfma_f32_32x32x16_bf16 v[176:191], a[204:207], a[224:227], v[176:191]
  ds_read_b64_tr_b16 a[212:213], v10 offset:8192
  v_mfma_f32_32x32x16_bf16 v[208:223], a[204:207], a[228:231], v[208:223]
  ds_read_b64_tr_b16 a[214:215], v10 offset:10240
  v_mfma_f32_32x32x16_bf16 v[240:255], a[204:207], a[232:235], v[240:255]
  s_waitcnt lgkmcnt(6)
  v_mfma_f32_32x32x16_bf16 v[96:111], a[208:211], a[236:239], v[96:111]
  ds_read_b128 a[216:219], v7 offset:20480
  buffer_load_dwordx4 v4, s[28:31], s75 offen offset:1024 lds
  s_waitcnt lgkmcnt(6)
  v_mfma_f32_32x32x16_bf16 v[128:143], a[208:211], a[240:243], v[128:143]
  ds_read_b64_tr_b16 a[200:201], v9 offset:16384
  s_waitcnt lgkmcnt(6)
  v_mfma_f32_32x32x16_bf16 v[160:175], a[208:211], a[244:247], v[160:175]
  ds_read_b64_tr_b16 a[202:203], v9 offset:18432
  s_waitcnt lgkmcnt(6)
  v_mfma_f32_32x32x16_bf16 v[192:207], a[208:211], a[248:251], v[192:207]
  ds_read_b128 a[220:223], v7 offset:24576
  s_add_u32 s71, s71, 128
  s_cmp_ge_u32 s71, s72
  s_cselect_b32 s79, 1280, 0
  s_sub_u32 s71, s71, s79
  s_add_u32 m0, s74, 0
  s_add_u32 s75, s71, 0
  buffer_load_dwordx4 v2, s[24:27], s75 offen lds
  s_waitcnt lgkmcnt(6)
  v_mfma_f32_32x32x16_bf16 v[224:239], a[208:211], a[252:255], v[224:239]
  ds_read_b128 a[224:227], v7 offset:28672
  s_waitcnt lgkmcnt(5)
  v_mfma_f32_32x32x16_bf16 v[112:127], a[212:215], a[236:239], v[112:127]
  ds_read_b128 a[228:231], v7 offset:32768
  v_mfma_f32_32x32x16_bf16 v[144:159], a[212:215], a[240:243], v[144:159]
  ds_read_b128 a[232:235], v7 offset:36864
  s_add_u32 m0, s74, 4096
  s_add_u32 s75, s71, 40960
  buffer_load_dwordx4 v2, s[24:27], s75 offen lds
  v_mfma_f32_32x32x16_bf16 v[176:191], a[212:215], a[244:247], v[176:191]
  ds_read_b64_tr_b16 a[204:205], v10 offset:16384
  v_mfma_f32_32x32x16_bf16 v[208:223], a[212:215], a[248:251], v[208:223]
  ds_read_b64_tr_b16 a[206:207], v10 offset:18432
  v_mfma_f32_32x32x16_bf16 v[240:255], a[212:215], a[252:255], v[240:255]
  s_waitcnt vmcnt(7)
  s_barrier
  s_waitcnt lgkmcnt(6)
  v_mfma_f32_32x32x16_bf16 v[96:111], a[200:203], a[216:219], v[96:111]
  ds_read_b128 a[236:239], v8 offset:20480
  s_add_u32 s69, s69, 245760
  s_cmp_ge_u32 s69, s70
  s_cselect_b32 s79, 2457600, 0
  s_sub_u32 s69, s69, s79
  s_add_u32 m0, s73, 61440
  s_add_u32 s75, s69, 0
  buffer_load_dwordx4 v3, s[28:31], s75 offen offset:0 lds
  s_waitcnt lgkmcnt(6)
  v_mfma_f32_32x32x16_bf16 v[128:143], a[200:203], a[220:223], v[128:143]
  ds_read_b64_tr_b16 a[208:209], v9 offset:24576
  s_waitcnt lgkmcnt(6)
  v_mfma_f32_32x32x16_bf16 v[160:175], a[200:203], a[224:227], v[160:175]
  ds_read_b64_tr_b16 a[210:211], v9 offset:26624
  buffer_load_dwordx4 v4, s[28:31], s75 offen offset:1024 lds
  s_waitcnt lgkmcnt(6)
  v_mfma_f32_32x32x16_bf16 v[192:207], a[200:203], a[228:231], v[192:207]
  ds_read_b128 a[240:243], v8 offset:24576
  s_waitcnt lgkmcnt(6)
  v_mfma_f32_32x32x16_bf16 v[224:239], a[200:203], a[232:235], v[224:239]
  ds_read_b128 a[244:247], v8 offset:28672
  s_waitcnt lgkmcnt(5)
  v_mfma_f32_32x32x16_bf16 v[112:127], a[204:207], a[216:219], v[112:127]
  ds_read_b128 a[248:251], v8 offset:32768
  s_add_u32 m0, s73, 69632
  s_add_u32 s75, s69, 61440
  buffer_load_dwordx4 v3, s[28:31], s75 offen offset:0 lds
  v_mfma_f32_32x32x16_bf16 v[144:159], a[204:207], a[220:223], v[144:159]
  ds_read_b128 a[252:255], v8 offset:36864
  v_mfma_f32_32x32x16_bf16 v[176:191], a[204:207], a[224:227], v[176:191]
  ds_read_b64_tr_b16 a[212:213], v10 offset:24576
  v_mfma_f32_32x32x16_bf16 v[208:223], a[204:207], a[228:231], v[208:223]
  ds_read_b64_tr_b16 a[214:215], v10 offset:26624
  buffer_load_dwordx4 v4, s[28:31], s75 offen offset:1024 lds
  v_mfma_f32_32x32x16_bf16 v[240:255], a[204:207], a[232:235], v[240:255]
  s_waitcnt lgkmcnt(6)
  v_mfma_f32_32x32x16_bf16 v[96:111], a[208:211], a[236:239], v[96:111]
  ds_read_b128 a[216:219], v5 offset:40960
  s_waitcnt lgkmcnt(6)
  v_mfma_f32_32x32x16_bf16 v[128:143], a[208:211], a[240:243], v[128:143]
  ds_read_b64_tr_b16 a[200:201], v9 offset:32768
  s_add_u32 m0, s74, 8192
  s_add_u32 s75, s71, 81920
  buffer_load_dwordx4 v2, s[24:27], s75 offen lds
  s_waitcnt lgkmcnt(6)
  v_mfma_f32_32x32x16_bf16 v[160:175], a[208:211], a[244:247], v[160:175]
  ds_read_b64_tr_b16 a[202:203], v9 offset:34816
  s_waitcnt lgkmcnt(6)
  v_mfma_f32_32x32x16_bf16 v[192:207], a[208:211], a[248:251], v[192:207]
  ds_read_b128 a[220:223], v5 offset:45056
  s_waitcnt lgkmcnt(6)
  v_mfma_f32_32x32x16_bf16 v[224:239], a[208:211], a[252:255], v[224:239]
  ds_read_b128 a[224:227], v5 offset:49152
  s_add_u32 m0, s74, 12288
  s_add_u32 s75, s71, 122880
  buffer_load_dwordx4 v2, s[24:27], s75 offen lds
  s_waitcnt lgkmcnt(5)
  v_mfma_f32_32x32x16_bf16 v[112:127], a[212:215], a[236:239], v[112:127]
  ds_read_b128 a[228:231], v5 offset:53248
  v_mfma_f32_32x32x16_bf16 v[144:159], a[212:215], a[240:243], v[144:159]
  ds_read_b128 a[232:235], v5 offset:57344
  v_mfma_f32_32x32x16_bf16 v[176:191], a[212:215], a[244:247], v[176:191]
  ds_read_b64_tr_b16 a[204:205], v10 offset:32768
  s_add_u32 m0, s74, 16384
  s_add_u32 s75, s71, 163840
  buffer_load_dwordx4 v2, s[24:27], s75 offen lds
  v_mfma_f32_32x32x16_bf16 v[208:223], a[212:215], a[248:251], v[208:223]
  ds_read_b64_tr_b16 a[206:207], v10 offset:34816
  v_mfma_f32_32x32x16_bf16 v[240:255], a[212:215], a[252:255], v[240:255]
  s_waitcnt vmcnt(12)
  s_barrier
  s_waitcnt lgkmcnt(6)
  v_mfma_f32_32x32x16_bf16 v[96:111], a[200:203], a[216:219], v[96:111]
  ds_read_b128 a[236:239], v6 offset:40960
  s_add_u32 m0, s73, 77824
  s_add_u32 s75, s69, 122880
  buffer_load_dwordx4 v3, s[28:31], s75 offen offset:0 lds
  s_waitcnt lgkmcnt(6)
  v_mfma_f32_32x32x16_bf16 v[128:143], a[200:203], a[220:223], v[128:143]
  ds_read_b64_tr_b16 a[208:209], v9 offset:40960
  s_waitcnt lgkmcnt(6)
  v_mfma_f32_32x32x16_bf16 v[160:175], a[200:203], a[224:227], v[160:175]
  ds_read_b64_tr_b16 a[210:211], v9 offset:43008
  s_waitcnt lgkmcnt(6)
  v_mfma_f32_32x32x16_bf16 v[192:207], a[200:203], a[228:231], v[192:207]
  ds_read_b128 a[240:243], v6 offset:45056
  buffer_load_dwordx4 v4, s[28:31], s75 offen offset:1024 lds
  s_waitcnt lgkmcnt(6)
  v_mfma_f32_32x32x16_bf16 v[224:239], a[200:203], a[232:235], v[224:239]
  ds_read_b128 a[244:247], v6 offset:49152
  s_waitcnt lgkmcnt(5)
  v_mfma_f32_32x32x16_bf16 v[112:127], a[204:207], a[216:219], v[112:127]
  ds_read_b128 a[248:251], v6 offset:53248
  v_mfma_f32_32x32x16_bf16 v[144:159], a[204:207], a[220:223], v[144:159]
  ds_read_b128 a[252:255], v6 offset:57344
  s_add_u32 m0, s73, 86016
  s_add_u32 s75, s69, 184320
  buffer_load_dwordx4 v3, s[28:31], s75 offen offset:0 lds
  v_mfma_f32_32x32x16_bf16 v[176:191], a[204:207], a[224:227], v[176:191]
  ds_read_b64_tr_b16 a[212:213], v10 offset:40960
  v_mfma_f32_32x32x16_bf16 v[208:223], a[204:207], a[228:231], v[208:223]
  ds_read_b64_tr_b16 a[214:215], v10 offset:43008
  v_mfma_f32_32x32x16_bf16 v[240:255], a[204:207], a[232:235], v[240:255]
  s_waitcnt lgkmcnt(6)
  v_mfma_f32_32x32x16_bf16 v[96:111], a[208:211], a[236:239], v[96:111]
  ds_read_b128 a[216:219], v7 offset:40960
  buffer_load_dwordx4 v4, s[28:31], s75 offen offset:1024 lds
  s_waitcnt lgkmcnt(6)
  v_mfma_f32_32x32x16_bf16 v[128:143], a[208:211], a[240:243], v[128:143]
  ds_read_b64_tr_b16 a[200:201], v9 offset:49152
  s_waitcnt lgkmcnt(6)
  v_mfma_f32_32x32x16_bf16 v[160:175], a[208:211], a[244:247], v[160:175]
  ds_read_b64_tr_b16 a[202:203], v9 offset:51200
  s_waitcnt lgkmcnt(6)
  v_mfma_f32_32x32x16_bf16 v[192:207], a[208:211], a[248:251], v[192:207]
  ds_read_b128 a[220:223], v7 offset:45056
  s_add_u32 s71, s71, 128
  s_cmp_ge_u32 s71, s72
  s_cselect_b32 s79, 1280, 0
  s_sub_u32 s71, s71, s79
  s_add_u32 m0, s74, 20480
  s_add_u32 s75, s71, 0
  buffer_load_dwordx4 v2, s[24:27], s75 offen lds
  s_waitcnt lgkmcnt(6)
  v_mfma_f32_32x32x16_bf16 v[224:239], a[208:211], a[252:255], v[224:239]
  ds_read_b128 a[224:227], v7 offset:49152
  s_waitcnt lgkmcnt(5)
  v_mfma_f32_32x32x16_bf16 v[112:127], a[212:215], a[236:239], v[112:127]
  ds_read_b128 a[228:231], v7 offset:53248
  v_mfma_f32_32x32x16_bf16 v[144:159], a[212:215], a[240:243], v[144:159]
  ds_read_b128 a[232:235], v7 offset:57344
  s_add_u32 m0, s74, 24576
  s_add_u32 s75, s71, 40960
  buffer_load_dwordx4 v2, s[24:27], s75 offen lds
  v_mfma_f32_32x32x16_bf16 v[176:191], a[212:215], a[244:247], v[176:191]
  ds_read_b64_tr_b16 a[204:205], v10 offset:49152
  v_mfma_f32_32x32x16_bf16 v[208:223], a[212:215], a[248:251], v[208:223]
  ds_read_b64_tr_b16 a[206:207], v10 offset:51200
  v_mfma_f32_32x32x16_bf16 v[240:255], a[212:215], a[252:255], v[240:255]
  s_waitcnt vmcnt(6)
  s_barrier
  s_waitcnt lgkmcnt(6)
  v_mfma_f32_32x32x16_bf16 v[96:111], a[200:203], a[216:219], v[96:111]
  ds_read_b128 a[236:239], v8 offset:40960
  s_add_u32 s69, s69, 245760
  s_cmp_ge_u32 s69, s70
  s_cselect_b32 s79, 2457600, 0
  s_sub_u32 s69, s69, s79
  s_add_u32 m0, s73, 94208
  s_add_u32 s75, s69, 0
  buffer_load_dwordx4 v3, s[28:31], s75 offen offset:0 lds
  s_waitcnt lgkmcnt(6)
  v_mfma_f32_32x32x16_bf16 v[128:143], a[200:203], a[220:223], v[128:143]
  ds_read_b64_tr_b16 a[208:209], v9 offset:57344
  s_waitcnt lgkmcnt(6)
  v_mfma_f32_32x32x16_bf16 v[160:175], a[200:203], a[224:227], v[160:175]
  ds_read_b64_tr_b16 a[210:211], v9 offset:59392
  buffer_load_dwordx4 v4, s[28:31], s75 offen offset:1024 lds
  s_waitcnt lgkmcnt(6)
  v_mfma_f32_32x32x16_bf16 v[192:207], a[200:203], a[228:231], v[192:207]
  ds_read_b128 a[240:243], v8 offset:45056
  s_waitcnt lgkmcnt(6)
  v_mfma_f32_32x32x16_bf16 v[224:239], a[200:203], a[232:235], v[224:239]
  ds_read_b128 a[244:247], v8 offset:49152
  s_waitcnt lgkmcnt(5)
  v_mfma_f32_32x32x16_bf16 v[112:127], a[204:207], a[216:219], v[112:127]
  ds_read_b128 a[248:251], v8 offset:53248
  s_add_u32 m0, s73, 102400
  s_add_u32 s75, s69, 61440
  buffer_load_dwordx4 v3, s[28:31], s75 offen offset:0 lds
  v_mfma_f32_32x32x16_bf16 v[144:159], a[204:207], a[220:223], v[144:159]
  ds_read_b128 a[252:255], v8 offset:57344
  v_mfma_f32_32x32x16_bf16 v[176:191], a[204:207], a[224:227], v[176:191]
  ds_read_b64_tr_b16 a[212:213], v10 offset:57344
  v_mfma_f32_32x32x16_bf16 v[208:223], a[204:207], a[228:231], v[208:223]
  ds_read_b64_tr_b16 a[214:215], v10 offset:59392
  buffer_load_dwordx4 v4, s[28:31], s75 offen offset:1024 lds
  v_mfma_f32_32x32x16_bf16 v[240:255], a[204:207], a[232:235], v[240:255]
  s_waitcnt lgkmcnt(6)
  v_mfma_f32_32x32x16_bf16 v[96:111], a[208:211], a[236:239], v[96:111]
  ds_read_b128 a[216:219], v5 offset:0
  s_waitcnt lgkmcnt(6)
  v_mfma_f32_32x32x16_bf16 v[128:143], a[208:211], a[240:243], v[128:143]
  ds_read_b64_tr_b16 a[200:201], v9 offset:0
  s_add_u32 m0, s74, 28672
  s_add_u32 s75, s71, 81920
  buffer_load_dwordx4 v2, s[24:27], s75 offen lds
  s_waitcnt lgkmcnt(6)
  v_mfma_f32_32x32x16_bf16 v[160:175], a[208:211], a[244:247], v[160:175]
  ds_read_b64_tr_b16 a[202:203], v9 offset:2048
  s_waitcnt lgkmcnt(6)
  v_mfma_f32_32x32x16_bf16 v[192:207], a[208:211], a[248:251], v[192:207]
  ds_read_b128 a[220:223], v5 offset:4096
  s_waitcnt lgkmcnt(6)
  v_mfma_f32_32x32x16_bf16 v[224:239], a[208:211], a[252:255], v[224:239]
  ds_read_b128 a[224:227], v5 offset:8192
  s_add_u32 m0, s74, 32768
  s_add_u32 s75, s71, 122880
  buffer_load_dwordx4 v2, s[24:27], s75 offen lds
  s_waitcnt lgkmcnt(5)
  v_mfma_f32_32x32x16_bf16 v[112:127], a[212:215], a[236:239], v[112:127]
  ds_read_b128 a[228:231], v5 offset:12288
  v_mfma_f32_32x32x16_bf16 v[144:159], a[212:215], a[240:243], v[144:159]
  ds_read_b128 a[232:235], v5 offset:16384
  v_mfma_f32_32x32x16_bf16 v[176:191], a[212:215], a[244:247], v[176:191]
  ds_read_b64_tr_b16 a[204:205], v10 offset:0
  s_add_u32 m0, s74, 36864
  s_add_u32 s75, s71, 163840
  buffer_load_dwordx4 v2, s[24:27], s75 offen lds
  v_mfma_f32_32x32x16_bf16 v[208:223], a[212:215], a[248:251], v[208:223]
  ds_read_b64_tr_b16 a[206:207], v10 offset:2048
  v_mfma_f32_32x32x16_bf16 v[240:255], a[212:215], a[252:255], v[240:255]
  s_waitcnt vmcnt(11)
  s_barrier
  s_waitcnt lgkmcnt(6)
  v_mfma_f32_32x32x16_bf16 v[96:111], a[200:203], a[216:219], v[96:111]
  ds_read_b128 a[236:239], v6 offset:0
  s_add_u32 m0, s73, 110592
  s_add_u32 s75, s69, 122880
  buffer_load_dwordx4 v3, s[28:31], s75 offen offset:0 lds
  s_waitcnt lgkmcnt(6)
  v_mfma_f32_32x32x16_bf16 v[128:143], a[200:203], a[220:223], v[128:143]
  ds_read_b64_tr_b16 a[208:209], v9 offset:8192
  s_mul_i32 s80, s12, 378880
  s_add_u32 s80, s80, 9752576
  s_add_u32 s60, s22, s80
  s_addc_u32 s61, s23, 0
  s_and_b32 s62, s84, 378880
  s_mov_b32 s63, 0x20000
  s_waitcnt lgkmcnt(6)
  v_mfma_f32_32x32x16_bf16 v[160:175], a[200:203], a[224:227], v[160:175]
  ds_read_b64_tr_b16 a[210:211], v9 offset:10240
  s_waitcnt lgkmcnt(6)
  v_mfma_f32_32x32x16_bf16 v[192:207], a[200:203], a[228:231], v[192:207]
  ds_read_b128 a[240:243], v6 offset:4096
  buffer_load_dwordx4 v4, s[28:31], s75 offen offset:1024 lds
  s_waitcnt lgkmcnt(6)
  v_mfma_f32_32x32x16_bf16 v[224:239], a[200:203], a[232:235], v[224:239]
  ds_read_b128 a[244:247], v6 offset:8192
  s_waitcnt lgkmcnt(5)
  v_mfma_f32_32x32x16_bf16 v[112:127], a[204:207], a[216:219], v[112:127]
  ds_read_b128 a[248:251], v6 offset:12288
  v_mfma_f32_32x32x16_bf16 v[144:159], a[204:207], a[220:223], v[144:159]
  ds_read_b128 a[252:255], v6 offset:16384
  s_add_u32 m0, s73, 118784
  s_add_u32 s75, s69, 184320
  buffer_load_dwordx4 v3, s[28:31], s75 offen offset:0 lds
  v_mfma_f32_32x32x16_bf16 v[176:191], a[204:207], a[224:227], v[176:191]
  ds_read_b64_tr_b16 a[212:213], v10 offset:8192
  v_mfma_f32_32x32x16_bf16 v[208:223], a[204:207], a[228:231], v[208:223]
  ds_read_b64_tr_b16 a[214:215], v10 offset:10240
  v_mfma_f32_32x32x16_bf16 v[240:255], a[204:207], a[232:235], v[240:255]
  s_waitcnt lgkmcnt(6)
  v_mfma_f32_32x32x16_bf16 v[96:111], a[208:211], a[236:239], v[96:111]
  ds_read_b128 a[216:219], v7 offset:0
  buffer_load_dwordx4 v4, s[28:31], s75 offen offset:1024 lds
  s_waitcnt lgkmcnt(6)
  v_mfma_f32_32x32x16_bf16 v[128:143], a[208:211], a[240:243], v[128:143]
  ds_read_b64_tr_b16 a[200:201], v9 offset:16384
  s_waitcnt lgkmcnt(6)
  v_mfma_f32_32x32x16_bf16 v[160:175], a[208:211], a[244:247], v[160:175]
  ds_read_b64_tr_b16 a[202:203], v9 offset:18432
  s_waitcnt lgkmcnt(6)
  v_mfma_f32_32x32x16_bf16 v[192:207], a[208:211], a[248:251], v[192:207]
  ds_read_b128 a[220:223], v7 offset:4096
  s_add_u32 s71, s71, 128
  s_cmp_ge_u32 s71, s72
  s_cselect_b32 s79, 1280, 0
  s_sub_u32 s71, s71, s79
  s_add_u32 m0, s74, 40960
  s_add_u32 s75, s71, 0
  buffer_load_dwordx4 v2, s[24:27], s75 offen lds
  s_waitcnt lgkmcnt(6)
  v_mfma_f32_32x32x16_bf16 v[224:239], a[208:211], a[252:255], v[224:239]
  ds_read_b128 a[224:227], v7 offset:8192
  s_waitcnt lgkmcnt(5)
  v_mfma_f32_32x32x16_bf16 v[112:127], a[212:215], a[236:239], v[112:127]
  ds_read_b128 a[228:231], v7 offset:12288
  v_mfma_f32_32x32x16_bf16 v[144:159], a[212:215], a[240:243], v[144:159]
  ds_read_b128 a[232:235], v7 offset:16384
  s_add_u32 m0, s74, 45056
  s_add_u32 s75, s71, 40960
  buffer_load_dwordx4 v2, s[24:27], s75 offen lds
  v_mfma_f32_32x32x16_bf16 v[176:191], a[212:215], a[244:247], v[176:191]
  ds_read_b64_tr_b16 a[204:205], v10 offset:16384
  v_mfma_f32_32x32x16_bf16 v[208:223], a[212:215], a[248:251], v[208:223]
  ds_read_b64_tr_b16 a[206:207], v10 offset:18432
  v_mfma_f32_32x32x16_bf16 v[240:255], a[212:215], a[252:255], v[240:255]
  s_waitcnt vmcnt(6)
  s_barrier
  s_waitcnt lgkmcnt(6)
  v_mfma_f32_32x32x16_bf16 v[96:111], a[200:203], a[216:219], v[96:111]
  ds_read_b128 a[236:239], v8 offset:0
  s_add_u32 s69, s69, 245760
  s_cmp_ge_u32 s69, s70
  s_cselect_b32 s79, 2457600, 0
  s_sub_u32 s69, s69, s79
  s_add_u32 m0, s73, 61440
  s_add_u32 s75, s69, 0
  buffer_load_dwordx4 v3, s[28:31], s75 offen offset:0 lds
  s_waitcnt lgkmcnt(6)
  v_mfma_f32_32x32x16_bf16 v[128:143], a[200:203], a[220:223], v[128:143]
  ds_read_b64_tr_b16 a[208:209], v9 offset:24576
  v_lshlrev_b32 v32, 2, v1
  v_lshlrev_b32 v33, 4, v1
  s_waitcnt lgkmcnt(6)
  v_mfma_f32_32x32x16_bf16 v[160:175], a[200:203], a[224:227], v[160:175]
  ds_read_b64_tr_b16 a[210:211], v9 offset:26624
  buffer_load_dwordx4 v4, s[28:31], s75 offen offset:1024 lds
  s_waitcnt lgkmcnt(6)
  v_mfma_f32_32x32x16_bf16 v[192:207], a[200:203], a[228:231], v[192:207]
  ds_read_b128 a[240:243], v8 offset:4096
  s_cmp_eq_u32 s64, 0
  s_cselect_b32 s80, 4096, 1073741824
  buffer_load_dwordx4 v[60:63], v33, s[44:47], s80 offen sc1
  s_waitcnt lgkmcnt(6)
  v_mfma_f32_32x32x16_bf16 v[224:239], a[200:203], a[232:235], v[224:239]
  ds_read_b128 a[244:247], v8 offset:8192
  s_waitcnt lgkmcnt(5)
  v_mfma_f32_32x32x16_bf16 v[112:127], a[204:207], a[216:219], v[112:127]
  ds_read_b128 a[248:251], v8 offset:12288
  s_add_u32 m0, s73, 69632
  s_add_u32 s75, s69, 61440
  buffer_load_dwordx4 v3, s[28:31], s75 offen offset:0 lds
  v_mfma_f32_32x32x16_bf16 v[144:159], a[204:207], a[220:223], v[144:159]
  ds_read_b128 a[252:255], v8 offset:16384
  v_mfma_f32_32x32x16_bf16 v[176:191], a[204:207], a[224:227], v[176:191]
  ds_read_b64_tr_b16 a[212:213], v10 offset:24576
  v_mfma_f32_32x32x16_bf16 v[208:223], a[204:207], a[228:231], v[208:223]
  ds_read_b64_tr_b16 a[214:215], v10 offset:26624
  buffer_load_dwordx4 v4, s[28:31], s75 offen offset:1024 lds
  v_mfma_f32_32x32x16_bf16 v[240:255], a[204:207], a[232:235], v[240:255]
  s_waitcnt lgkmcnt(6)
  v_mfma_f32_32x32x16_bf16 v[96:111], a[208:211], a[236:239], v[96:111]
  ds_read_b128 a[216:219], v5 offset:20480
  s_waitcnt lgkmcnt(6)
  v_mfma_f32_32x32x16_bf16 v[128:143], a[208:211], a[240:243], v[128:143]
  ds_read_b64_tr_b16 a[200:201], v9 offset:32768
  s_add_u32 m0, s74, 49152
  s_add_u32 s75, s71, 81920
  buffer_load_dwordx4 v2, s[24:27], s75 offen lds
  s_waitcnt lgkmcnt(6)
  v_mfma_f32_32x32x16_bf16 v[160:175], a[208:211], a[244:247], v[160:175]
  ds_read_b64_tr_b16 a[202:203], v9 offset:34816
  s_waitcnt lgkmcnt(6)
  v_mfma_f32_32x32x16_bf16 v[192:207], a[208:211], a[248:251], v[192:207]
  ds_read_b128 a[220:223], v5 offset:24576
  s_waitcnt lgkmcnt(6)
  v_mfma_f32_32x32x16_bf16 v[224:239], a[208:211], a[252:255], v[224:239]
  ds_read_b128 a[224:227], v5 offset:28672
  s_add_u32 m0, s74, 53248
  s_add_u32 s75, s71, 122880
  buffer_load_dwordx4 v2, s[24:27], s75 offen lds
  s_waitcnt lgkmcnt(5)
  v_mfma_f32_32x32x16_bf16 v[112:127], a[212:215], a[236:239], v[112:127]
  ds_read_b128 a[228:231], v5 offset:32768
  v_mfma_f32_32x32x16_bf16 v[144:159], a[212:215], a[240:243], v[144:159]
  ds_read_b128 a[232:235], v5 offset:36864
  v_mfma_f32_32x32x16_bf16 v[176:191], a[212:215], a[244:247], v[176:191]
  ds_read_b64_tr_b16 a[204:205], v10 offset:32768
  s_add_u32 m0, s74, 57344
  s_add_u32 s75, s71, 163840
  buffer_load_dwordx4 v2, s[24:27], s75 offen lds
  v_mfma_f32_32x32x16_bf16 v[208:223], a[212:215], a[248:251], v[208:223]
  ds_read_b64_tr_b16 a[206:207], v10 offset:34816
  v_mfma_f32_32x32x16_bf16 v[240:255], a[212:215], a[252:255], v[240:255]
  s_waitcnt vmcnt(12)
  s_barrier
  s_waitcnt lgkmcnt(6)
  v_mfma_f32_32x32x16_bf16 v[96:111], a[200:203], a[216:219], v[96:111]
  ds_read_b128 a[236:239], v6 offset:20480
  s_add_u32 m0, s73, 77824
  s_add_u32 s75, s69, 122880
  buffer_load_dwordx4 v3, s[28:31], s75 offen offset:0 lds
  s_waitcnt lgkmcnt(6)
  v_mfma_f32_32x32x16_bf16 v[128:143], a[200:203], a[220:223], v[128:143]
  ds_read_b64_tr_b16 a[208:209], v9 offset:40960
  s_waitcnt lgkmcnt(6)
  v_mfma_f32_32x32x16_bf16 v[160:175], a[200:203], a[224:227], v[160:175]
  ds_read_b64_tr_b16 a[210:211], v9 offset:43008
  s_waitcnt lgkmcnt(6)
  v_mfma_f32_32x32x16_bf16 v[192:207], a[200:203], a[228:231], v[192:207]
  ds_read_b128 a[240:243], v6 offset:24576
  buffer_load_dwordx4 v4, s[28:31], s75 offen offset:1024 lds
  s_waitcnt lgkmcnt(6)
  v_mfma_f32_32x32x16_bf16 v[224:239], a[200:203], a[232:235], v[224:239]
  ds_read_b128 a[244:247], v6 offset:28672
  s_waitcnt lgkmcnt(5)
  v_mfma_f32_32x32x16_bf16 v[112:127], a[204:207], a[216:219], v[112:127]
  ds_read_b128 a[248:251], v6 offset:32768
  v_mfma_f32_32x32x16_bf16 v[144:159], a[204:207], a[220:223], v[144:159]
  ds_read_b128 a[252:255], v6 offset:36864
  s_add_u32 m0, s73, 86016
  s_add_u32 s75, s69, 184320
  buffer_load_dwordx4 v3, s[28:31], s75 offen offset:0 lds
  v_mfma_f32_32x32x16_bf16 v[176:191], a[204:207], a[224:227], v[176:191]
  ds_read_b64_tr_b16 a[212:213], v10 offset:40960
  v_mfma_f32_32x32x16_bf16 v[208:223], a[204:207], a[228:231], v[208:223]
  ds_read_b64_tr_b16 a[214:215], v10 offset:43008
  v_mfma_f32_32x32x16_bf16 v[240:255], a[204:207], a[232:235], v[240:255]
  s_waitcnt lgkmcnt(6)
  v_mfma_f32_32x32x16_bf16 v[96:111], a[208:211], a[236:239], v[96:111]
  ds_read_b128 a[216:219], v7 offset:20480
  buffer_load_dwordx4 v4, s[28:31], s75 offen offset:1024 lds
  s_waitcnt lgkmcnt(6)
  v_mfma_f32_32x32x16_bf16 v[128:143], a[208:211], a[240:243], v[128:143]
  ds_read_b64_tr_b16 a[200:201], v9 offset:49152
  s_waitcnt lgkmcnt(6)
  v_mfma_f32_32x32x16_bf16 v[160:175], a[208:211], a[244:247], v[160:175]
  ds_read_b64_tr_b16 a[202:203], v9 offset:51200
  s_waitcnt lgkmcnt(6)
  v_mfma_f32_32x32x16_bf16 v[192:207], a[208:211], a[248:251], v[192:207]
  ds_read_b128 a[220:223], v7 offset:24576
  s_add_u32 s71, s71, 128
  s_cmp_ge_u32 s71, s72
  s_cselect_b32 s79, 1280, 0
  s_sub_u32 s71, s71, s79
  s_add_u32 m0, s74, 0
  s_add_u32 s75, s71, 0
  buffer_load_dwordx4 v2, s[24:27], s75 offen lds
  s_waitcnt lgkmcnt(6)
  v_mfma_f32_32x32x16_bf16 v[224:239], a[208:211], a[252:255], v[224:239]
  ds_read_b128 a[224:227], v7 offset:28672
  s_waitcnt lgkmcnt(5)
  v_mfma_f32_32x32x16_bf16 v[112:127], a[212:215], a[236:239], v[112:127]
  ds_read_b128 a[228:231], v7 offset:32768
  v_mfma_f32_32x32x16_bf16 v[144:159], a[212:215], a[240:243], v[144:159]
  ds_read_b128 a[232:235], v7 offset:36864
  s_add_u32 m0, s74, 4096
  s_add_u32 s75, s71, 40960
  buffer_load_dwordx4 v2, s[24:27], s75 offen lds
  v_mfma_f32_32x32x16_bf16 v[176:191], a[212:215], a[244:247], v[176:191]
  ds_read_b64_tr_b16 a[204:205], v10 offset:49152
  v_mfma_f32_32x32x16_bf16 v[208:223], a[212:215], a[248:251], v[208:223]
  ds_read_b64_tr_b16 a[206:207], v10 offset:51200
  v_mfma_f32_32x32x16_bf16 v[240:255], a[212:215], a[252:255], v[240:255]
  s_waitcnt vmcnt(6)
  s_barrier
  s_waitcnt lgkmcnt(6)
  v_mfma_f32_32x32x16_bf16 v[96:111], a[200:203], a[216:219], v[96:111]
  ds_read_b128 a[236:239], v8 offset:20480
  s_add_u32 s69, s69, 245760
  s_cmp_ge_u32 s69, s70
  s_cselect_b32 s79, 2457600, 0
  s_sub_u32 s69, s69, s79
  s_add_u32 m0, s73, 94208
  s_add_u32 s75, s69, 0
  buffer_load_dwordx4 v3, s[28:31], s75 offen offset:0 lds
  s_waitcnt lgkmcnt(6)
  v_mfma_f32_32x32x16_bf16 v[128:143], a[200:203], a[220:223], v[128:143]
  ds_read_b64_tr_b16 a[208:209], v9 offset:57344
  s_waitcnt lgkmcnt(6)
  v_mfma_f32_32x32x16_bf16 v[160:175], a[200:203], a[224:227], v[160:175]
  ds_read_b64_tr_b16 a[210:211], v9 offset:59392
  buffer_load_dwordx4 v4, s[28:31], s75 offen offset:1024 lds
  s_waitcnt lgkmcnt(6)
  v_mfma_f32_32x32x16_bf16 v[192:207], a[200:203], a[228:231], v[192:207]
  ds_read_b128 a[240:243], v8 offset:24576
  s_waitcnt lgkmcnt(6)
  v_mfma_f32_32x32x16_bf16 v[224:239], a[200:203], a[232:235], v[224:239]
  ds_read_b128 a[244:247], v8 offset:28672
  s_waitcnt lgkmcnt(5)
  v_mfma_f32_32x32x16_bf16 v[112:127], a[204:207], a[216:219], v[112:127]
  ds_read_b128 a[248:251], v8 offset:32768
  s_add_u32 m0, s73, 102400
  s_add_u32 s75, s69, 61440
  buffer_load_dwordx4 v3, s[28:31], s75 offen offset:0 lds
  v_mfma_f32_32x32x16_bf16 v[144:159], a[204:207], a[220:223], v[144:159]
  ds_read_b128 a[252:255], v8 offset:36864
  v_mfma_f32_32x32x16_bf16 v[176:191], a[204:207], a[224:227], v[176:191]
  ds_read_b64_tr_b16 a[212:213], v10 offset:57344
  v_mfma_f32_32x32x16_bf16 v[208:223], a[204:207], a[228:231], v[208:223]
  ds_read_b64_tr_b16 a[214:215], v10 offset:59392
  buffer_load_dwordx4 v4, s[28:31], s75 offen offset:1024 lds
  v_mfma_f32_32x32x16_bf16 v[240:255], a[204:207], a[232:235], v[240:255]
  s_waitcnt lgkmcnt(6)
  v_mfma_f32_32x32x16_bf16 v[96:111], a[208:211], a[236:239], v[96:111]
  ds_read_b128 a[216:219], v5 offset:40960
  s_waitcnt lgkmcnt(6)
  v_mfma_f32_32x32x16_bf16 v[128:143], a[208:211], a[240:243], v[128:143]
  ds_read_b64_tr_b16 a[200:201], v9 offset:0
  s_add_u32 m0, s74, 8192
  s_add_u32 s75, s71, 81920
  buffer_load_dwordx4 v2, s[24:27], s75 offen lds
  s_waitcnt lgkmcnt(6)
  v_mfma_f32_32x32x16_bf16 v[160:175], a[208:211], a[244:247], v[160:175]
  ds_read_b64_tr_b16 a[202:203], v9 offset:2048
  s_waitcnt lgkmcnt(6)
  v_mfma_f32_32x32x16_bf16 v[192:207], a[208:211], a[248:251], v[192:207]
  ds_read_b128 a[220:223], v5 offset:45056
  s_waitcnt lgkmcnt(6)
  v_mfma_f32_32x32x16_bf16 v[224:239], a[208:211], a[252:255], v[224:239]
  ds_read_b128 a[224:227], v5 offset:49152
  s_add_u32 m0, s74, 12288
  s_add_u32 s75, s71, 122880
  buffer_load_dwordx4 v2, s[24:27], s75 offen lds
  s_waitcnt lgkmcnt(5)
  v_mfma_f32_32x32x16_bf16 v[112:127], a[212:215], a[236:239], v[112:127]
  ds_read_b128 a[228:231], v5 offset:53248
  v_mfma_f32_32x32x16_bf16 v[144:159], a[212:215], a[240:243], v[144:159]
  ds_read_b128 a[232:235], v5 offset:57344
  v_mfma_f32_32x32x16_bf16 v[176:191], a[212:215], a[244:247], v[176:191]
  ds_read_b64_tr_b16 a[204:205], v10 offset:0
  s_add_u32 m0, s74, 16384
  s_add_u32 s75, s71, 163840
  buffer_load_dwordx4 v2, s[24:27], s75 offen lds
  v_mfma_f32_32x32x16_bf16 v[208:223], a[212:215], a[248:251], v[208:223]
  ds_read_b64_tr_b16 a[206:207], v10 offset:2048
  v_mfma_f32_32x32x16_bf16 v[240:255], a[212:215], a[252:255], v[240:255]
  s_waitcnt vmcnt(11)
  s_cmp_eq_u32 s64, 0
  s_cselect_b64 s[76:77], -1, 0
  v_and_b32 v60, v60, v61
  v_and_b32 v62, v62, v63
  v_and_b32 v60, v60, v62
  v_cmp_ne_u32 vcc, 1, v60
  s_and_b64 vcc, vcc, s[76:77]
  s_cbranch_vccnz L_spin_att
L_spin_att_go:
  s_barrier
  s_waitcnt lgkmcnt(6)
  v_mfma_f32_32x32x16_bf16 v[96:111], a[200:203], a[216:219], v[96:111]
  ds_read_b128 a[236:239], v6 offset:40960
  s_add_u32 m0, s73, 110592
  s_add_u32 s75, s69, 122880
  buffer_load_dwordx4 v3, s[28:31], s75 offen offset:0 lds
  s_waitcnt lgkmcnt(6)
  v_mfma_f32_32x32x16_bf16 v[128:143], a[200:203], a[220:223], v[128:143]
  ds_read_b64_tr_b16 a[208:209], v9 offset:8192
  s_add_u32 s80, s67, 0
  s_lshl_b32 s80, s80, 8
  buffer_load_dwordx2 a[190:191], v13, s[32:35], s80 offen sc1
  s_waitcnt lgkmcnt(6)
  v_mfma_f32_32x32x16_bf16 v[160:175], a[200:203], a[224:227], v[160:175]
  ds_read_b64_tr_b16 a[210:211], v9 offset:10240
  s_add_u32 s80, s67, 1
  s_lshl_b32 s80, s80, 8
  buffer_load_dwordx2 a[192:193], v13, s[32:35], s80 offen sc1
  s_waitcnt lgkmcnt(6)
  v_mfma_f32_32x32x16_bf16 v[192:207], a[200:203], a[228:231], v[192:207]
  ds_read_b128 a[240:243], v6 offset:45056
  s_add_u32 s80, s67, 2
  s_lshl_b32 s80, s80, 8
  buffer_load_dwordx2 a[194:195], v13, s[32:35], s80 offen sc1
  s_waitcnt lgkmcnt(6)
  v_mfma_f32_32x32x16_bf16 v[224:239], a[200:203], a[232:235], v[224:239]
  ds_read_b128 a[244:247], v6 offset:49152
  s_waitcnt lgkmcnt(5)
  v_mfma_f32_32x32x16_bf16 v[112:127], a[204:207], a[216:219], v[112:127]
  ds_read_b128 a[248:251], v6 offset:53248
  buffer_load_dwordx4 v4, s[28:31], s75 offen offset:1024 lds
  v_mfma_f32_32x32x16_bf16 v[144:159], a[204:207], a[220:223], v[144:159]
  ds_read_b128 a[252:255], v6 offset:57344
  s_add_u32 s80, s67, 3
  s_lshl_b32 s80, s80, 8
  buffer_load_dwordx2 a[196:197], v13, s[32:35], s80 offen sc1
  v_mfma_f32_32x32x16_bf16 v[176:191], a[204:207], a[224:227], v[176:191]
  ds_read_b64_tr_b16 a[212:213], v10 offset:8192
  s_add_u32 s80, s67, 4
  s_lshl_b32 s80, s80, 8
  buffer_load_dwordx2 a[198:199], v13, s[32:35], s80 offen sc1
  v_mfma_f32_32x32x16_bf16 v[208:223], a[204:207], a[228:231], v[208:223]
  ds_read_b64_tr_b16 a[214:215], v10 offset:10240
  buffer_load_dword v36, v32, s[36:39], 0 offen offset:0 sc1
  v_mfma_f32_32x32x16_bf16 v[240:255], a[204:207], a[232:235], v[240:255]
  buffer_load_dword v37, v32, s[36:39], 0 offen offset:256 sc1
  buffer_load_dword v38, v32, s[36:39], 0 offen offset:512 sc1
  buffer_load_dword v39, v32, s[36:39], 0 offen offset:768 sc1
  s_waitcnt lgkmcnt(6)
  v_mfma_f32_32x32x16_bf16 v[96:111], a[208:211], a[236:239], v[96:111]
  ds_read_b128 a[216:219], v7 offset:40960
  s_add_u32 m0, s73, 118784
  s_add_u32 s75, s69, 184320
  buffer_load_dwordx4 v3, s[28:31], s75 offen offset:0 lds
  s_waitcnt lgkmcnt(6)
  v_mfma_f32_32x32x16_bf16 v[128:143], a[208:211], a[240:243], v[128:143]
  ds_read_b64_tr_b16 a[200:201], v9 offset:16384
  buffer_load_dword v40, v32, s[36:39], 0 offen offset:1024 sc1
  buffer_load_dword v42, v32, s[36:39], 0 offen offset:1280 sc1
  s_waitcnt lgkmcnt(6)
  v_mfma_f32_32x32x16_bf16 v[160:175], a[208:211], a[244:247], v[160:175]
  ds_read_b64_tr_b16 a[202:203], v9 offset:18432
  buffer_load_dword v43, v32, s[36:39], 0 offen offset:1536 sc1
  buffer_load_dword v44, v32, s[36:39], 0 offen offset:1792 sc1
  s_waitcnt lgkmcnt(6)
  v_mfma_f32_32x32x16_bf16 v[192:207], a[208:211], a[248:251], v[192:207]
  ds_read_b128 a[220:223], v7 offset:45056
  buffer_load_dword v45, v32, s[36:39], 0 offen offset:2048 sc1
  s_waitcnt lgkmcnt(6)
  v_mfma_f32_32x32x16_bf16 v[224:239], a[208:211], a[252:255], v[224:239]
  ds_read_b128 a[224:227], v7 offset:49152
  buffer_load_dword v46, v32, s[36:39], 0 offen offset:2304 sc1
  v_accvgpr_write_b32 a162, 0
  s_waitcnt lgkmcnt(5)
  v_mfma_f32_32x32x16_bf16 v[112:127], a[212:215], a[236:239], v[112:127]
  ds_read_b128 a[228:231], v7 offset:53248
  buffer_load_dwordx4 v4, s[28:31], s75 offen offset:1024 lds
  v_accvgpr_write_b32 a163, 0
  v_mfma_f32_32x32x16_bf16 v[144:159], a[212:215], a[240:243], v[144:159]
  ds_read_b128 a[232:235], v7 offset:57344
  v_accvgpr_write_b32 a166, 0
  v_accvgpr_write_b32 a167, 0
  v_accvgpr_write_b32 a170, 0
  v_mfma_f32_32x32x16_bf16 v[176:191], a[212:215], a[244:247], v[176:191]
  ds_read_b64_tr_b16 a[204:205], v10 offset:16384
  v_accvgpr_write_b32 a171, 0
  v_accvgpr_write_b32 a174, 0
  v_accvgpr_write_b32 a175, 0
  v_accvgpr_write_b32 a178, 0
  v_mfma_f32_32x32x16_bf16 v[208:223], a[212:215], a[248:251], v[208:223]
  ds_read_b64_tr_b16 a[206:207], v10 offset:18432
  v_accvgpr_write_b32 a179, 0
  v_mfma_f32_32x32x16_bf16 v[240:255], a[212:215], a[252:255], v[240:255]
  s_waitcnt vmcnt(19)
  s_barrier
  s_waitcnt lgkmcnt(6)
  v_mfma_f32_32x32x16_bf16 v[96:111], a[200:203], a[216:219], v[96:111]
  ds_read_b128 a[236:239], v8 offset:40960
  s_add_u32 s20, s14, 0
  s_cmp_ge_u32 s20, 266240
  s_cselect_b32 s21, 266240, 0
  s_sub_u32 s20, s20, s21
  s_add_u32 s20, s20, s13
  buffer_load_dwordx4 a[0:3], v11, s[60:63], s20 offen offset:0 sc1
  s_waitcnt lgkmcnt(6)
  v_mfma_f32_32x32x16_bf16 v[128:143], a[200:203], a[220:223], v[128:143]
  ds_read_b64_tr_b16 a[208:209], v9 offset:24576
  s_waitcnt lgkmcnt(6)
  v_mfma_f32_32x32x16_bf16 v[160:175], a[200:203], a[224:227], v[160:175]
  ds_read_b64_tr_b16 a[210:211], v9 offset:26624
  buffer_load_dwordx4 a[4:7], v11, s[60:63], s20 offen offset:1024 sc1
  s_waitcnt lgkmcnt(6)
  v_mfma_f32_32x32x16_bf16 v[192:207], a[200:203], a[228:231], v[192:207]
  ds_read_b128 a[240:243], v8 offset:45056
  s_waitcnt lgkmcnt(6)
  v_mfma_f32_32x32x16_bf16 v[224:239], a[200:203], a[232:235], v[224:239]
  ds_read_b128 a[244:247], v8 offset:49152
  buffer_load_dwordx4 a[8:11], v11, s[60:63], s20 offen offset:2048 sc1
  s_waitcnt lgkmcnt(5)
  v_mfma_f32_32x32x16_bf16 v[112:127], a[204:207], a[216:219], v[112:127]
  ds_read_b128 a[248:251], v8 offset:53248
  v_mfma_f32_32x32x16_bf16 v[144:159], a[204:207], a[220:223], v[144:159]
  ds_read_b128 a[252:255], v8 offset:57344
  buffer_load_dwordx4 a[12:15], v11, s[60:63], s20 offen offset:3072 sc1
  v_mfma_f32_32x32x16_bf16 v[176:191], a[204:207], a[224:227], v[176:191]
  ds_read_b64_tr_b16 a[212:213], v10 offset:24576
  v_mfma_f32_32x32x16_bf16 v[208:223], a[204:207], a[228:231], v[208:223]
  ds_read_b64_tr_b16 a[214:215], v10 offset:26624
  s_add_u32 s20, s20, 4096
  buffer_load_dwordx4 a[16:19], v11, s[60:63], s20 offen sc1
  v_mfma_f32_32x32x16_bf16 v[240:255], a[204:207], a[232:235], v[240:255]
  s_waitcnt lgkmcnt(6)
  v_mfma_f32_32x32x16_bf16 v[96:111], a[208:211], a[236:239], v[96:111]
  ds_read_b128 a[216:219], v5 offset:0
  s_add_u32 s20, s14, 20480
  s_cmp_ge_u32 s20, 266240
  s_cselect_b32 s21, 266240, 0
  s_sub_u32 s20, s20, s21
  s_add_u32 s20, s20, s13
  buffer_load_dwordx4 a[20:23], v11, s[60:63], s20 offen offset:0 sc1
  s_waitcnt lgkmcnt(6)
  v_mfma_f32_32x32x16_bf16 v[128:143], a[208:211], a[240:243], v[128:143]
  ds_read_b64_tr_b16 a[200:201], v9 offset:32768
  s_waitcnt lgkmcnt(6)
  v_mfma_f32_32x32x16_bf16 v[160:175], a[208:211], a[244:247], v[160:175]
  ds_read_b64_tr_b16 a[202:203], v9 offset:34816
  buffer_load_dwordx4 a[24:27], v11, s[60:63], s20 offen offset:1024 sc1
  s_waitcnt lgkmcnt(6)
  v_mfma_f32_32x32x16_bf16 v[192:207], a[208:211], a[248:251], v[192:207]
  ds_read_b128 a[220:223], v5 offset:4096
  s_waitcnt lgkmcnt(6)
  v_mfma_f32_32x32x16_bf16 v[224:239], a[208:211], a[252:255], v[224:239]
  ds_read_b128 a[224:227], v5 offset:8192
  buffer_load_dwordx4 a[28:31], v11, s[60:63], s20 offen offset:2048 sc1
  s_waitcnt lgkmcnt(5)
  v_mfma_f32_32x32x16_bf16 v[112:127], a[212:215], a[236:239], v[112:127]
  ds_read_b128 a[228:231], v5 offset:12288
  v_mfma_f32_32x32x16_bf16 v[144:159], a[212:215], a[240:243], v[144:159]
  ds_read_b128 a[232:235], v5 offset:16384
  buffer_load_dwordx4 a[32:35], v11, s[60:63], s20 offen offset:3072 sc1
  v_mfma_f32_32x32x16_bf16 v[176:191], a[212:215], a[244:247], v[176:191]
  ds_read_b64_tr_b16 a[204:205], v10 offset:32768
  v_mfma_f32_32x32x16_bf16 v[208:223], a[212:215], a[248:251], v[208:223]
  ds_read_b64_tr_b16 a[206:207], v10 offset:34816
  s_add_u32 s20, s20, 4096
  buffer_load_dwordx4 a[36:39], v11, s[60:63], s20 offen sc1
  s_waitcnt vmcnt(20)
  v_add_f32 v36, v36, v37
  v_mfma_f32_32x32x16_bf16 v[240:255], a[212:215], a[252:255], v[240:255]
  s_waitcnt vmcnt(18)
  v_add_f32 v38, v38, v39
  s_waitcnt vmcnt(16)
  v_add_f32 v36, v36, v40
  v_add_f32 v41, v36, v38
  v_mov_b32 v40, v41
  s_barrier
  s_waitcnt lgkmcnt(6)
  v_mfma_f32_32x32x16_bf16 v[96:111], a[200:203], a[216:219], v[96:111]
  ds_read_b128 a[236:239], v6 offset:0
  s_add_u32 s20, s14, 40960
  s_cmp_ge_u32 s20, 266240
  s_cselect_b32 s21, 266240, 0
  s_sub_u32 s20, s20, s21
  s_add_u32 s20, s20, s13
  buffer_load_dwordx4 a[40:43], v11, s[60:63], s20 offen offset:0 sc1
  s_waitcnt lgkmcnt(6)
  v_mfma_f32_32x32x16_bf16 v[128:143], a[200:203], a[220:223], v[128:143]
  ds_read_b64_tr_b16 a[208:209], v9 offset:40960
  v_permlane32_swap_b32 v41, v40
  v_add_f32 v41, v41, v40
  v_cmp_gt_u32 vcc, 32, v1
  s_waitcnt lgkmcnt(6)
  v_mfma_f32_32x32x16_bf16 v[160:175], a[200:203], a[224:227], v[160:175]
  ds_read_b64_tr_b16 a[210:211], v9 offset:43008
  buffer_load_dwordx4 a[44:47], v11, s[60:63], s20 offen offset:1024 sc1
  v_cndmask_b32 v41, 0, v41, vcc
  v_cvt_pk_bf16_f32 v37, v41, 0
  s_waitcnt lgkmcnt(6)
  v_mfma_f32_32x32x16_bf16 v[192:207], a[200:203], a[228:231], v[192:207]
  ds_read_b128 a[240:243], v6 offset:4096
  v_lshlrev_b32 v36, 16, v37
  v_sub_f32 v36, v41, v36
  v_cvt_pk_bf16_f32 v36, v41, v36
  s_waitcnt lgkmcnt(6)
  v_mfma_f32_32x32x16_bf16 v[224:239], a[200:203], a[232:235], v[224:239]
  ds_read_b128 a[244:247], v6 offset:8192
  buffer_load_dwordx4 a[48:51], v11, s[60:63], s20 offen offset:2048 sc1
  v_mov_b32 v38, 0
  s_waitcnt lgkmcnt(5)
  v_mfma_f32_32x32x16_bf16 v[112:127], a[204:207], a[216:219], v[112:127]
  ds_read_b128 a[248:251], v6 offset:12288
  v_mov_b32 v39, 0
  s_waitcnt vmcnt(17)
  v_add_f32 v42, v42, v43
  s_waitcnt vmcnt(15)
  v_add_f32 v44, v44, v45
  v_mfma_f32_32x32x16_bf16 v[144:159], a[204:207], a[220:223], v[144:159]
  ds_read_b128 a[252:255], v6 offset:16384
  buffer_load_dwordx4 a[52:55], v11, s[60:63], s20 offen offset:3072 sc1
  s_waitcnt vmcnt(15)
  v_add_f32 v42, v42, v46
  v_mfma_f32_32x32x16_bf16 v[176:191], a[204:207], a[224:227], v[176:191]
  ds_read_b64_tr_b16 a[212:213], v10 offset:40960
  v_add_f32 v47, v42, v44
  v_mov_b32 v46, v47
  v_mfma_f32_32x32x16_bf16 v[208:223], a[204:207], a[228:231], v[208:223]
  ds_read_b64_tr_b16 a[214:215], v10 offset:43008
  s_add_u32 s20, s20, 4096
  buffer_load_dwordx4 a[56:59], v11, s[60:63], s20 offen sc1
  v_permlane32_swap_b32 v47, v46
  v_mfma_f32_32x32x16_bf16 v[240:255], a[204:207], a[232:235], v[240:255]
  v_add_f32 v47, v47, v46
  v_cmp_gt_u32 vcc, 32, v1
  s_waitcnt lgkmcnt(6)
  v_mfma_f32_32x32x16_bf16 v[96:111], a[208:211], a[236:239], v[96:111]
  ds_read_b128 a[216:219], v7 offset:0
  s_add_u32 s20, s14, 61440
  s_cmp_ge_u32 s20, 266240
  s_cselect_b32 s21, 266240, 0
  s_sub_u32 s20, s20, s21
  s_add_u32 s20, s20, s13
  buffer_load_dwordx4 a[60:63], v11, s[60:63], s20 offen offset:0 sc1
  s_waitcnt lgkmcnt(6)
  v_mfma_f32_32x32x16_bf16 v[128:143], a[208:211], a[240:243], v[128:143]
  ds_read_b64_tr_b16 a[200:201], v9 offset:49152
  v_cndmask_b32 v47, 0, v47, vcc
  v_cvt_pk_bf16_f32 v43, v47, 0
  v_lshlrev_b32 v42, 16, v43
  v_sub_f32 v42, v47, v42
  s_waitcnt lgkmcnt(6)
  v_mfma_f32_32x32x16_bf16 v[160:175], a[208:211], a[244:247], v[160:175]
  ds_read_b64_tr_b16 a[202:203], v9 offset:51200
  buffer_load_dwordx4 a[64:67], v11, s[60:63], s20 offen offset:1024 sc1
  v_cvt_pk_bf16_f32 v42, v47, v42
  v_mov_b32 v44, 0
  s_waitcnt lgkmcnt(6)
  v_mfma_f32_32x32x16_bf16 v[192:207], a[208:211], a[248:251], v[192:207]
  ds_read_b128 a[220:223], v7 offset:4096
  v_mov_b32 v45, 0
  v_accvgpr_read_b32 v52, a190
  v_cvt_pk_bf16_f32 v34, -v52, -v52
  s_waitcnt lgkmcnt(6)
  v_mfma_f32_32x32x16_bf16 v[224:239], a[208:211], a[252:255], v[224:239]
  ds_read_b128 a[224:227], v7 offset:8192
  buffer_load_dwordx4 a[68:71], v11, s[60:63], s20 offen offset:2048 sc1
  v_lshlrev_b32 v35, 16, v34
  s_waitcnt lgkmcnt(5)
  v_mfma_f32_32x32x16_bf16 v[112:127], a[212:215], a[236:239], v[112:127]
  ds_read_b128 a[228:231], v7 offset:12288
  v_sub_f32_e64 v35, -v52, v35
  v_cvt_pk_bf16_f32 v35, v35, 0
  v_accvgpr_write_b32 a160, v34
  v_mfma_f32_32x32x16_bf16 v[144:159], a[212:215], a[240:243], v[144:159]
  ds_read_b128 a[232:235], v7 offset:16384
  buffer_load_dwordx4 a[72:75], v11, s[60:63], s20 offen offset:3072 sc1
  v_accvgpr_write_b32 a161, v35
  v_mfma_f32_32x32x16_bf16 v[176:191], a[212:215], a[244:247], v[176:191]
  ds_read_b64_tr_b16 a[204:205], v10 offset:49152
  v_accvgpr_read_b32 v52, a192
  v_cvt_pk_bf16_f32 v34, -v52, -v52
  v_lshlrev_b32 v35, 16, v34
  v_sub_f32_e64 v35, -v52, v35
  v_mfma_f32_32x32x16_bf16 v[208:223], a[212:215], a[248:251], v[208:223]
  ds_read_b64_tr_b16 a[206:207], v10 offset:51200
  s_add_u32 s20, s20, 4096
  buffer_load_dwordx4 a[76:79], v11, s[60:63], s20 offen sc1
  v_cvt_pk_bf16_f32 v35, v35, 0
  v_mfma_f32_32x32x16_bf16 v[240:255], a[212:215], a[252:255], v[240:255]
  v_accvgpr_write_b32 a164, v34
  v_accvgpr_write_b32 a165, v35
  v_accvgpr_read_b32 v52, a194
  v_cvt_pk_bf16_f32 v34, -v52, -v52
  v_lshlrev_b32 v35, 16, v34
  v_sub_f32_e64 v35, -v52, v35
  s_waitcnt vmcnt(20)
  s_barrier
  s_waitcnt lgkmcnt(6)
  v_mfma_f32_32x32x16_bf16 v[96:111], a[200:203], a[216:219], v[96:111]
  ds_read_b128 a[236:239], v8 offset:0
  s_add_u32 s20, s14, 81920
  s_cmp_ge_u32 s20, 266240
  s_cselect_b32 s21, 266240, 0
  s_sub_u32 s20, s20, s21
  s_add_u32 s20, s20, s13
  buffer_load_dwordx4 a[80:83], v11, s[60:63], s20 offen offset:0 sc1
  s_waitcnt lgkmcnt(6)
  v_mfma_f32_32x32x16_bf16 v[128:143], a[200:203], a[220:223], v[128:143]
  ds_read_b64_tr_b16 a[208:209], v9 offset:57344
  v_cvt_pk_bf16_f32 v35, v35, 0
  v_accvgpr_write_b32 a168, v34
  v_accvgpr_write_b32 a169, v35
  v_accvgpr_read_b32 v52, a196
  s_waitcnt lgkmcnt(6)
  v_mfma_f32_32x32x16_bf16 v[160:175], a[200:203], a[224:227], v[160:175]
  ds_read_b64_tr_b16 a[210:211], v9 offset:59392
  buffer_load_dwordx4 a[84:87], v11, s[60:63], s20 offen offset:1024 sc1
  v_cvt_pk_bf16_f32 v34, -v52, -v52
  v_lshlrev_b32 v35, 16, v34
  s_waitcnt lgkmcnt(6)
  v_mfma_f32_32x32x16_bf16 v[192:207], a[200:203], a[228:231], v[192:207]
  ds_read_b128 a[240:243], v8 offset:4096
  v_sub_f32_e64 v35, -v52, v35
  v_cvt_pk_bf16_f32 v35, v35, 0
  v_accvgpr_write_b32 a172, v34
  s_waitcnt lgkmcnt(6)
  v_mfma_f32_32x32x16_bf16 v[224:239], a[200:203], a[232:235], v[224:239]
  ds_read_b128 a[244:247], v8 offset:8192
  buffer_load_dwordx4 a[88:91], v11, s[60:63], s20 offen offset:2048 sc1
  v_accvgpr_write_b32 a173, v35
  s_waitcnt lgkmcnt(5)
  v_mfma_f32_32x32x16_bf16 v[112:127], a[204:207], a[216:219], v[112:127]
  ds_read_b128 a[248:251], v8 offset:12288
  v_accvgpr_read_b32 v52, a198
  v_cvt_pk_bf16_f32 v34, -v52, -v52
  v_lshlrev_b32 v35, 16, v34
  v_mfma_f32_32x32x16_bf16 v[144:159], a[204:207], a[220:223], v[144:159]
  ds_read_b128 a[252:255], v8 offset:16384
  buffer_load_dwordx4 a[92:95], v11, s[60:63], s20 offen offset:3072 sc1
  v_sub_f32_e64 v35, -v52, v35
  v_mfma_f32_32x32x16_bf16 v[176:191], a[204:207], a[224:227], v[176:191]
  ds_read_b64_tr_b16 a[212:213], v10 offset:57344
  v_cvt_pk_bf16_f32 v35, v35, 0
  v_accvgpr_write_b32 a176, v34
  v_accvgpr_write_b32 a177, v35
  s_lshl_b32 s76, s65, 2
  v_mfma_f32_32x32x16_bf16 v[208:223], a[204:207], a[228:231], v[208:223]
  ds_read_b64_tr_b16 a[214:215], v10 offset:59392
  s_add_u32 s20, s20, 4096
  buffer_load_dwordx4 a[96:99], v11, s[60:63], s20 offen sc1
  s_add_u32 s76, s76, s64
  v_mfma_f32_32x32x16_bf16 v[240:255], a[204:207], a[232:235], v[240:255]
  s_mul_i32 s77, s76, 81920
  s_add_u32 s77, s77, 12783616
  s_add_u32 s52, s22, s77
  s_addc_u32 s53, s23, 0
  s_and_b32 s54, s84, 81920
  s_mov_b32 s55, 0x20000
  s_waitcnt lgkmcnt(6)
  v_mfma_f32_32x32x16_bf16 v[96:111], a[208:211], a[236:239], v[96:111]
  s_add_u32 s20, s14, 102400
  s_cmp_ge_u32 s20, 266240
  s_cselect_b32 s21, 266240, 0
  s_sub_u32 s20, s20, s21
  s_add_u32 s20, s20, s13
  buffer_load_dwordx4 a[100:103], v11, s[60:63], s20 offen offset:0 sc1
  s_waitcnt lgkmcnt(5)
  v_mfma_f32_32x32x16_bf16 v[128:143], a[208:211], a[240:243], v[128:143]
  s_lshl_b32 s81, s65, 4
  s_add_u32 s81, s81, s66
  s_lshl_b32 s81, s81, 2
  s_add_u32 s81, s81, 6656
  s_and_b32 s78, s84, s81
  s_andn2_b32 s81, 1073741824, s84
  s_waitcnt lgkmcnt(4)
  v_mfma_f32_32x32x16_bf16 v[160:175], a[208:211], a[244:247], v[160:175]
  buffer_load_dwordx4 a[104:107], v11, s[60:63], s20 offen offset:1024 sc1
  s_or_b32 s81, s81, s78
  s_cmp_eq_u32 s64, 0
  s_cselect_b32 s81, s81, 1073741824
  v_mov_b32 v3, 1
  s_waitcnt lgkmcnt(3)
  v_mfma_f32_32x32x16_bf16 v[192:207], a[208:211], a[248:251], v[192:207]
  v_mov_b32 v4, 1073741824
  v_cndmask_b32 v4, v4, 0, s[16:17]
  s_lshr_b32 s76, s66, 2
  s_lshl_b32 s76, s76, 3
  s_mul_hi_u32 s77, s76, 0x33333334
  s_add_u32 s78, s76, 7
  s_waitcnt lgkmcnt(2)
  v_mfma_f32_32x32x16_bf16 v[224:239], a[208:211], a[252:255], v[224:239]
  buffer_load_dwordx4 a[108:111], v11, s[60:63], s20 offen offset:2048 sc1
  s_mul_hi_u32 s78, s78, 0x33333334
  s_add_u32 s78, s78, 1
  s_lshl_b32 s8, 1, s78
  s_lshl_b32 s78, 1, s77
  s_waitcnt lgkmcnt(0)
  v_mfma_f32_32x32x16_bf16 v[112:127], a[212:215], a[236:239], v[112:127]
  s_sub_u32 s8, s8, s78
  s_and_b32 s8, s8, s84
  s_mov_b32 s9, 0
  s_lshl_b32 s77, s64, 1
  s_add_u32 s10, s76, s77
  s_mul_i32 s10, s10, 1280
  v_mfma_f32_32x32x16_bf16 v[144:159], a[212:215], a[240:243], v[144:159]
  buffer_load_dwordx4 a[112:115], v11, s[60:63], s20 offen offset:3072 sc1
  s_lshl_b32 s76, s65, 2
  s_and_b32 s77, s66, 3
  s_add_u32 s76, s76, s77
  s_mul_i32 s76, s76, 81920
  v_mfma_f32_32x32x16_bf16 v[176:191], a[212:215], a[244:247], v[176:191]
  s_add_u32 s76, s76, 12783616
  s_add_u32 s24, s22, s76
  s_addc_u32 s25, s23, 0
  s_and_b32 s26, s84, 81920
  s_mov_b32 s27, 0x20000
  s_lshl_b32 s11, s65, 6
  v_mfma_f32_32x32x16_bf16 v[208:223], a[212:215], a[248:251], v[208:223]
  s_add_u32 s20, s20, 4096
  buffer_load_dwordx4 a[116:119], v11, s[60:63], s20 offen sc1
  s_add_u32 s11, s11, 6656
  v_and_b32 v23, 15, v1
  v_mul_u32_u24 v21, 192, v23
  v_mfma_f32_32x32x16_bf16 v[240:255], a[212:215], a[252:255], v[240:255]
  v_lshrrev_b32 v22, 4, v1
  v_lshl_add_u32 v21, v22, 4, v21
  v_cmp_gt_u32 vcc, 5, v23
  v_mov_b32 v22, 1073741824
  s_nop 0
  v_cndmask_b32 v22, v22, v21, vcc
  s_lshl_b32 s76, s65, 4
  s_add_u32 s76, s76, s66
  s_lshl_b32 s76, s76, 2
  s_add_u32 s76, s76, s64
  s_lshl_b32 s76, s76, 12
  s_add_u32 s76, s76, 15405056
  s_add_u32 s56, s22, s76
  s_addc_u32 s57, s23, 0
  s_and_b32 s58, s84, 4096
  s_mov_b32 s59, 0x20000
L_epi_att:
  s_cbranch_execz L_nb2
  s_barrier
L_nb2:
  v_mov_b32 v2, 0x3f80
  v_mov_b32 v38, 0
  v_mov_b32 v39, 0
  v_mov_b32 v70, 0
  v_mov_b32 v71, 0
  v_mov_b32 v5, 0x0d800000
  v_mfma_f32_32x32x16_bf16 v[128:143], v[36:39], a[164:167], v[128:143]
  v_accvgpr_read_b32 v88, a193
  v_mul_f32 v90, 0x3fb8aa3b, v88
  s_add_u32 s76, s67, 0
  s_mul_i32 s76, s76, 1280
  s_add_u32 s80, s67, 1
  s_mul_i32 s80, s80, 1280
  v_accvgpr_read_b32 v88, a195
  v_mfma_f32_32x32x16_bf16 v[160:175], v[36:39], a[168:171], v[160:175]
  v_accvgpr_read_b32 v56, a191
  v_mul_f32 v58, 0x3fb8aa3b, v56
  v_accvgpr_read_b32 v56, a191
  v_accvgpr_write_b32 a200, v5
  v_cvt_pk_bf16_f32 v64, v128, v129
  v_cvt_pk_bf16_f32 v65, v130, v131
  v_cvt_pk_bf16_f32 v66, v132, v133
  v_mfma_f32_32x32x16_bf16 v[192:207], v[36:39], a[172:175], v[192:207]
  v_cvt_pk_bf16_f32 v67, v134, v135
  v_cvt_pk_bf16_f32 v68, v136, v137
  v_cvt_pk_bf16_f32 v69, v138, v139
  v_accvgpr_write_b32 a201, v5
  v_accvgpr_write_b32 a202, v5
  v_accvgpr_write_b32 a203, v5
  v_accvgpr_write_b32 a208, v5
  v_mfma_f32_32x32x16_bf16 v[224:239], v[36:39], a[176:179], v[224:239]
  v_accvgpr_write_b32 a209, v5
  v_accvgpr_write_b32 a210, v5
  s_add_u32 m0, s13, 49152
  s_add_u32 s20, s14, 204800
  s_cmp_ge_u32 s20, 266240
  s_cselect_b32 s21, 266240, 0
  s_sub_u32 s20, s20, s21
  s_add_u32 s20, s20, s13
  buffer_load_dwordx4 v11, s[60:63], s20 offen offset:0 sc1 lds
  v_accvgpr_write_b32 a211, v5
  v_accvgpr_write_b32 a216, v5
  v_accvgpr_write_b32 a217, v5
  v_accvgpr_write_b32 a218, v5
  v_accvgpr_write_b32 a219, v5
  v_mfma_f32_32x32x16_bf16 v[72:87], v[24:27], v[64:67], 0
  v_cvt_pk_bf16_f32 v64, v160, v161
  v_cvt_pk_bf16_f32 v65, v162, v163
  v_cvt_pk_bf16_f32 v66, v164, v165
  v_cvt_pk_bf16_f32 v67, v166, v167
  v_accvgpr_write_b32 a204, v5
  v_accvgpr_write_b32 a205, v5
  v_accvgpr_write_b32 a206, v5
  v_mfma_f32_32x32x16_bf16 v[72:87], v[28:31], v[68:71], v[72:87]
  v_cvt_pk_bf16_f32 v68, v168, v169
  v_cvt_pk_bf16_f32 v69, v170, v171
  v_accvgpr_write_b32 a207, v5
  v_accvgpr_write_b32 a212, v5
  v_accvgpr_write_b32 a213, v5
  v_accvgpr_write_b32 a214, v5
  v_accvgpr_write_b32 a215, v5
  v_mfma_f32_32x32x16_bf16 v[96:111], v[36:39], a[160:163], v[96:111]
  v_accvgpr_write_b32 a220, v5
  v_accvgpr_write_b32 a221, v5
  v_accvgpr_write_b32 a222, v5
  v_accvgpr_write_b32 a223, v5
  v_mfma_f32_32x32x16_bf16 v[112:127], v[42:45], a[160:163], v[112:127]
  buffer_load_dwordx4 v11, s[60:63], s20 offen offset:1024 sc1 lds
  s_nop 5
  v_cvt_pk_bf16_f32 v36, v104, v105
  v_cvt_pk_bf16_f32 v37, v106, v107
  v_cvt_pk_bf16_f32 v32, v96, v97
  v_cvt_pk_bf16_f32 v33, v98, v99
  v_cvt_pk_bf16_f32 v34, v100, v101
  v_cvt_pk_bf16_f32 v35, v102, v103
  v_pk_mul_f32 v[72:73], v[72:73], v[90:91] op_sel_hi:[1,0]
  v_pk_mul_f32 v[74:75], v[74:75], v[90:91] op_sel_hi:[1,0]
  v_cvt_pk_bf16_f32 v72, v72, v73
  v_pk_mul_f32 v[76:77], v[76:77], v[90:91] op_sel_hi:[1,0]
  v_cvt_pk_bf16_f32 v73, v74, v75
  v_pk_mul_f32 v[78:79], v[78:79], v[90:91] op_sel_hi:[1,0]
  v_pk_mul_f32 v[80:81], v[80:81], v[90:91] op_sel_hi:[1,0]
  v_cvt_pk_bf16_f32 v74, v76, v77
  v_cvt_pk_bf16_f32 v75, v78, v79
  v_cvt_pk_bf16_f32 v76, v80, v81
  buffer_store_dwordx4 v[72:75], v11, s[52:55], s80 offen sc1
  v_mul_f32 v90, 0x3fb8aa3b, v88
  v_accvgpr_read_b32 v88, a197
  v_pk_mul_f32 v[104:105], v[104:105], v[56:57] op_sel_hi:[1,0]
  v_pk_mul_f32 v[106:107], v[106:107], v[56:57] op_sel_hi:[1,0]
  v_pk_mul_f32 v[108:109], v[108:109], v[56:57] op_sel_hi:[1,0]
  v_pk_mul_f32 v[110:111], v[110:111], v[56:57] op_sel_hi:[1,0]
  v_pk_mul_f32 v[124:125], v[124:125], v[56:57] op_sel_hi:[1,0]
  v_pk_mul_f32 v[126:127], v[126:127], v[56:57] op_sel_hi:[1,0]
  v_cvt_pk_bf16_f32 v104, v104, v105
  v_cvt_pk_bf16_f32 v105, v106, v107
  buffer_load_dwordx4 v11, s[60:63], s20 offen offset:2048 sc1 lds
  v_cvt_pk_bf16_f32 v108, v108, v109
  v_cmp_lt_f32 vcc, 0, v56
  s_nop 1
  v_cndmask_b32 v57, 0, v2, vcc
  buffer_store_dword v76, v12, s[52:55], s80 offen offset:1024 sc1
  v_mfma_f32_32x32x16_bf16 v[72:87], v[24:27], v[64:67], 0
  s_add_u32 s80, s67, 2
  s_mul_i32 s80, s80, 1280
  v_cvt_pk_bf16_f32 v64, v192, v193
  v_cvt_pk_bf16_f32 v65, v194, v195
  v_cvt_pk_bf16_f32 v66, v196, v197
  v_cvt_pk_bf16_f32 v67, v198, v199
  v_cvt_pk_bf16_f32 v109, v110, v111
  v_mfma_f32_32x32x16_bf16 v[72:87], v[28:31], v[68:71], v[72:87]
  v_cvt_pk_bf16_f32 v68, v200, v201
  v_cvt_pk_bf16_f32 v69, v202, v203
  v_cndmask_b32 v104, v104, v57, s[18:19]
  v_cndmask_b32 v105, v105, 0, s[18:19]
  ds_write_b64 v17, v[108:109] offset:0
  v_mfma_f32_32x32x16_bf16 v[144:159], v[42:45], a[164:167], v[144:159]
  v_cvt_pk_bf16_f32 v124, v124, v125
  v_cvt_pk_bf16_f32 v125, v126, v127
  ds_write_b64 v18, v[104:105] offset:0
  v_mfma_f32_32x32x16_bf16 v[176:191], v[42:45], a[168:171], v[176:191]
  ds_write_b64 v17, v[124:125] offset:24
  v_mfma_f32_32x32x16_bf16 v[208:223], v[42:45], a[172:175], v[208:223]
  v_mfma_f32_32x32x16_bf16 v[240:255], v[42:45], a[176:179], v[240:255]
  v_mfma_f32_32x32x16_bf16 v[40:55], v[24:27], v[32:35], 0
  buffer_load_dwordx4 v11, s[60:63], s20 offen offset:3072 sc1 lds
  v_cvt_pk_bf16_f32 v32, v112, v113
  v_cvt_pk_bf16_f32 v33, v114, v115
  v_cvt_pk_bf16_f32 v34, v116, v117
  v_cvt_pk_bf16_f32 v35, v118, v119
  s_nop 1
  v_mfma_f32_32x32x16_bf16 v[96:111], v[24:27], v[32:35], 0
  ds_read_b64_tr_b16 v[32:33], v20 offset:0
  ds_read_b64_tr_b16 v[34:35], v20 offset:288
  v_mfma_f32_32x32x16_bf16 v[40:55], v[28:31], v[36:39], v[40:55]
  v_cvt_pk_bf16_f32 v36, v120, v121
  v_cvt_pk_bf16_f32 v37, v122, v123
  s_nop 1
  v_mfma_f32_32x32x16_bf16 v[96:111], v[28:31], v[36:39], v[96:111]
  ds_read_b64_tr_b16 v[36:37], v20 offset:32
  ds_read_b64_tr_b16 v[38:39], v20 offset:320
  v_pk_mul_f32 v[72:73], v[72:73], v[90:91] op_sel_hi:[1,0]
  v_pk_mul_f32 v[74:75], v[74:75], v[90:91] op_sel_hi:[1,0]
  v_cvt_pk_bf16_f32 v72, v72, v73
  v_pk_mul_f32 v[76:77], v[76:77], v[90:91] op_sel_hi:[1,0]
  v_cvt_pk_bf16_f32 v73, v74, v75
  v_pk_mul_f32 v[78:79], v[78:79], v[90:91] op_sel_hi:[1,0]
  v_pk_mul_f32 v[80:81], v[80:81], v[90:91] op_sel_hi:[1,0]
  v_cvt_pk_bf16_f32 v74, v76, v77
  v_cvt_pk_bf16_f32 v75, v78, v79
  v_cvt_pk_bf16_f32 v76, v80, v81
  buffer_store_dwordx4 v[72:75], v11, s[52:55], s80 offen sc1
  v_mul_f32 v90, 0x3fb8aa3b, v88
  v_accvgpr_read_b32 v88, a199
  v_max3_f32 v60, v96, v97, v98
  s_add_u32 m0, s13, 53248
  s_add_u32 s20, s20, 4096
  buffer_load_dwordx4 v11, s[60:63], s20 offen sc1 lds
  v_max3_f32 v61, -v96, -v97, -v98
  v_max3_f32 v60, v60, v99, v100
  v_max3_f32 v61, v61, -v99, -v100
  v_max3_f32 v60, v60, v101, v102
  v_max3_f32 v61, v61, -v101, -v102
  v_max3_f32 v60, v60, v103, v104
  v_max3_f32 v61, v61, -v103, -v104
  v_max_f32 v60, v60, v105
  v_max_f32_e64 v61, v61, -v105
  v_pk_mul_f32 v[40:41], v[40:41], v[58:59] op_sel_hi:[1,0]
  buffer_store_dword v76, v12, s[52:55], s80 offen offset:1024 sc1
  v_pk_mul_f32 v[42:43], v[42:43], v[58:59] op_sel_hi:[1,0]
  v_pk_mul_f32 v[44:45], v[44:45], v[58:59] op_sel_hi:[1,0]
  v_pk_mul_f32 v[46:47], v[46:47], v[58:59] op_sel_hi:[1,0]
  v_pk_mul_f32 v[48:49], v[48:49], v[58:59] op_sel_hi:[1,0]
  v_mfma_f32_32x32x16_bf16 v[72:87], v[24:27], v[64:67], 0
  s_add_u32 s80, s67, 3
  s_mul_i32 s80, s80, 1280
  v_cvt_pk_bf16_f32 v64, v224, v225
  v_cvt_pk_bf16_f32 v65, v226, v227
  v_cvt_pk_bf16_f32 v66, v228, v229
  v_cvt_pk_bf16_f32 v67, v230, v231
  v_permlane32_swap_b32 v60, v61
  v_mfma_f32_32x32x16_bf16 v[72:87], v[28:31], v[68:71], v[72:87]
  v_cvt_pk_bf16_f32 v68, v232, v233
  v_cvt_pk_bf16_f32 v69, v234, v235
  v_max_f32 v60, v60, v61
  s_add_u32 m0, s13, 69632
  s_add_u32 s20, s14, 225280
  s_cmp_ge_u32 s20, 266240
  s_cselect_b32 s21, 266240, 0
  s_sub_u32 s20, s20, s21
  s_add_u32 s20, s20, s13
  buffer_load_dwordx4 v11, s[60:63], s20 offen offset:0 sc1 lds
  v_mov_b32 v61, v60
  v_mul_f32 v58, 0x3fb8aa3b, v56
  v_cvt_pk_bf16_f32 v40, v40, v41
  v_permlane32_swap_b32 v60, v61
  v_cvt_pk_bf16_f32 v41, v42, v43
  v_cvt_pk_bf16_f32 v42, v44, v45
  v_pk_mul_f32 v[62:63], v[60:61], v[58:59] op_sel_hi:[1,0]
  v_pk_fma_f32 v[112:113], v[96:97], v[58:59], v[62:63] op_sel:[0,0,1] op_sel_hi:[1,0,1] neg_lo:[1,0,1] neg_hi:[1,0,1]
  v_pk_mul_f32 v[72:73], v[72:73], v[90:91] op_sel_hi:[1,0]
  v_pk_mul_f32 v[74:75], v[74:75], v[90:91] op_sel_hi:[1,0]
  v_cvt_pk_bf16_f32 v72, v72, v73
  v_pk_mul_f32 v[76:77], v[76:77], v[90:91] op_sel_hi:[1,0]
  v_pk_mul_f32 v[78:79], v[78:79], v[90:91] op_sel_hi:[1,0]
  v_pk_mul_f32 v[80:81], v[80:81], v[90:91] op_sel_hi:[1,0]
  v_cvt_pk_bf16_f32 v73, v74, v75
  v_cvt_pk_bf16_f32 v74, v76, v77
  v_mul_f32 v90, 0x3fb8aa3b, v88
  v_cvt_pk_bf16_f32 v75, v78, v79
  v_cvt_pk_bf16_f32 v76, v80, v81
  buffer_store_dwordx4 v[72:75], v11, s[52:55], s80 offen sc1
  v_pk_fma_f32 v[114:115], v[98:99], v[58:59], v[62:63] op_sel:[0,0,1] op_sel_hi:[1,0,1] neg_lo:[1,0,1] neg_hi:[1,0,1]
  v_pk_fma_f32 v[116:117], v[100:101], v[58:59], v[62:63] op_sel:[0,0,1] op_sel_hi:[1,0,1] neg_lo:[1,0,1] neg_hi:[1,0,1]
  v_pk_fma_f32 v[118:119], v[102:103], v[58:59], v[62:63] op_sel:[0,0,1] op_sel_hi:[1,0,1] neg_lo:[1,0,1] neg_hi:[1,0,1]
  v_pk_fma_f32 v[96:97], v[96:97], v[58:59], v[62:63] op_sel_hi:[1,0,0] neg_lo:[0,0,1] neg_hi:[0,0,1]
  v_pk_fma_f32 v[98:99], v[98:99], v[58:59], v[62:63] op_sel_hi:[1,0,0] neg_lo:[0,0,1] neg_hi:[0,0,1]
  v_pk_fma_f32 v[100:101], v[100:101], v[58:59], v[62:63] op_sel_hi:[1,0,0] neg_lo:[0,0,1] neg_hi:[0,0,1]
  v_pk_fma_f32 v[102:103], v[102:103], v[58:59], v[62:63] op_sel_hi:[1,0,0] neg_lo:[0,0,1] neg_hi:[0,0,1]
  buffer_load_dwordx4 v11, s[60:63], s20 offen offset:1024 sc1 lds
  v_pk_fma_f32 v[120:121], v[104:105], v[58:59], v[62:63] op_sel:[0,0,1] op_sel_hi:[1,0,1] neg_lo:[1,0,1] neg_hi:[1,0,1]
  v_exp_f32 v96, v96
  v_exp_f32 v112, v112
  v_exp_f32 v97, v97
  buffer_store_dword v76, v12, s[52:55], s80 offen offset:1024 sc1
  v_pk_fma_f32 v[104:105], v[104:105], v[58:59], v[62:63] op_sel_hi:[1,0,0] neg_lo:[0,0,1] neg_hi:[0,0,1]
  v_mfma_f32_32x32x16_bf16 v[72:87], v[24:27], v[64:67], 0
  s_add_u32 s80, s67, 4
  s_mul_i32 s80, s80, 1280
  v_exp_f32 v113, v113
  v_exp_f32 v98, v98
  v_exp_f32 v114, v114
  v_mfma_f32_32x32x16_bf16 v[72:87], v[28:31], v[68:71], v[72:87]
  v_exp_f32 v99, v99
  v_exp_f32 v115, v115
  v_exp_f32 v100, v100
  v_exp_f32 v116, v116
  v_exp_f32 v101, v101
  v_exp_f32 v117, v117
  s_nop 5
  v_pk_mul_f32 v[72:73], v[72:73], v[90:91] op_sel_hi:[1,0]
  v_pk_mul_f32 v[74:75], v[74:75], v[90:91] op_sel_hi:[1,0]
  v_pk_mul_f32 v[76:77], v[76:77], v[90:91] op_sel_hi:[1,0]
  v_pk_mul_f32 v[78:79], v[78:79], v[90:91] op_sel_hi:[1,0]
  v_pk_mul_f32 v[80:81], v[80:81], v[90:91] op_sel_hi:[1,0]
  v_cvt_pk_bf16_f32 v72, v72, v73
  v_cvt_pk_bf16_f32 v73, v74, v75
  v_cvt_pk_bf16_f32 v74, v76, v77
  buffer_load_dwordx4 v11, s[60:63], s20 offen offset:2048 sc1 lds
  v_cvt_pk_bf16_f32 v75, v78, v79
  v_cvt_pk_bf16_f32 v76, v80, v81
  buffer_store_dwordx4 v[72:75], v11, s[52:55], s80 offen sc1
  v_exp_f32 v102, v102
  v_exp_f32 v118, v118
  v_exp_f32 v103, v103
  v_exp_f32 v119, v119
  v_exp_f32 v104, v104
  v_exp_f32 v120, v120
  v_exp_f32 v105, v105
  buffer_store_dword v76, v12, s[52:55], s80 offen offset:1024 sc1
  v_exp_f32 v121, v121
  v_pk_add_f32 v[106:107], v[96:97], v[98:99]
  v_pk_add_f32 v[108:109], v[100:101], v[102:103]
  v_pk_add_f32 v[122:123], v[112:113], v[114:115]
  v_pk_add_f32 v[124:125], v[116:117], v[118:119]
  v_pk_add_f32 v[106:107], v[106:107], v[108:109]
  v_pk_add_f32 v[122:123], v[122:123], v[124:125]
  v_pk_add_f32 v[106:107], v[106:107], v[104:105]
  v_pk_add_f32 v[122:123], v[122:123], v[120:121]
  v_add_f32 v60, v106, v107
  v_add_f32 v61, v122, v123
  v_cvt_pk_bf16_f32 v43, v46, v47
  v_cvt_pk_bf16_f32 v44, v48, v49
  v_permlane32_swap_b32 v60, v61
  v_add_f32 v60, v60, v61
  v_rcp_f32 v60, v60
  buffer_load_dwordx4 v11, s[60:63], s20 offen offset:3072 sc1 lds
  buffer_store_dwordx4 v[40:43], v11, s[52:55], s76 offen sc1
  v_mov_b32 v61, v60
  v_accvgpr_read_b32 v88, a193
  v_pk_mul_f32 v[136:137], v[136:137], v[88:89] op_sel_hi:[1,0]
  v_permlane32_swap_b32 v60, v61
  v_pk_mul_f32 v[96:97], v[96:97], v[60:61] op_sel_hi:[1,0]
  v_pk_mul_f32 v[112:113], v[112:113], v[60:61] op_sel:[0,1] op_sel_hi:[1,1]
  v_pk_mul_f32 v[98:99], v[98:99], v[60:61] op_sel_hi:[1,0]
  v_pk_mul_f32 v[114:115], v[114:115], v[60:61] op_sel:[0,1] op_sel_hi:[1,1]
  v_pk_mul_f32 v[100:101], v[100:101], v[60:61] op_sel_hi:[1,0]
  v_pk_mul_f32 v[116:117], v[116:117], v[60:61] op_sel:[0,1] op_sel_hi:[1,1]
  v_pk_mul_f32 v[102:103], v[102:103], v[60:61] op_sel_hi:[1,0]
  v_pk_mul_f32 v[118:119], v[118:119], v[60:61] op_sel:[0,1] op_sel_hi:[1,1]
  buffer_store_dword v44, v12, s[52:55], s76 offen offset:1024 sc1
  v_pk_mul_f32 v[104:105], v[104:105], v[60:61] op_sel_hi:[1,0]
  v_pk_mul_f32 v[120:121], v[120:121], v[60:61] op_sel:[0,1] op_sel_hi:[1,1]
  v_cvt_pk_bf16_f32 v40, v96, v97
  v_cvt_pk_bf16_f32 v41, v98, v99
  v_cvt_pk_bf16_f32 v42, v100, v101
  v_cvt_pk_bf16_f32 v43, v102, v103
  v_cvt_pk_bf16_f32 v44, v104, v105
  v_cvt_pk_bf16_f32 v45, v112, v113
  v_cvt_pk_bf16_f32 v46, v114, v115
  v_cvt_pk_bf16_f32 v47, v116, v117
  v_cvt_pk_bf16_f32 v48, v118, v119
  v_cvt_pk_bf16_f32 v49, v120, v121
  ds_write_b128 v16, v[40:43] offset:0
  s_add_u32 m0, s13, 73728
  s_add_u32 s20, s20, 4096
  buffer_load_dwordx4 v11, s[60:63], s20 offen sc1 lds
  v_pk_mul_f32 v[138:139], v[138:139], v[88:89] op_sel_hi:[1,0]
  v_pk_mul_f32 v[140:141], v[140:141], v[88:89] op_sel_hi:[1,0]
  v_pk_mul_f32 v[142:143], v[142:143], v[88:89] op_sel_hi:[1,0]
  v_pk_mul_f32 v[156:157], v[156:157], v[88:89] op_sel_hi:[1,0]
  v_pk_mul_f32 v[158:159], v[158:159], v[88:89] op_sel_hi:[1,0]
  v_cvt_pk_bf16_f32 v136, v136, v137
  v_cvt_pk_bf16_f32 v137, v138, v139
  v_cvt_pk_bf16_f32 v140, v140, v141
  ds_write_b128 v16, v[44:47] offset:32
  v_cmp_lt_f32 vcc, 0, v88
  s_nop 1
  v_cndmask_b32 v89, 0, v2, vcc
  v_cvt_pk_bf16_f32 v141, v142, v143
  v_cndmask_b32 v136, v136, v89, s[18:19]
  v_cndmask_b32 v137, v137, 0, s[18:19]
  v_accvgpr_read_b32 v56, a195
  v_pk_mul_f32 v[168:169], v[168:169], v[56:57] op_sel_hi:[1,0]
  v_pk_mul_f32 v[170:171], v[170:171], v[56:57] op_sel_hi:[1,0]
  ds_write_b64 v16, v[48:49] offset:64
  v_pk_mul_f32 v[172:173], v[172:173], v[56:57] op_sel_hi:[1,0]
  v_pk_mul_f32 v[174:175], v[174:175], v[56:57] op_sel_hi:[1,0]
  v_pk_mul_f32 v[188:189], v[188:189], v[56:57] op_sel_hi:[1,0]
  v_pk_mul_f32 v[190:191], v[190:191], v[56:57] op_sel_hi:[1,0]
  v_cvt_pk_bf16_f32 v168, v168, v169
  ds_write_b64 v17, v[140:141] offset:6144
  v_cvt_pk_bf16_f32 v64, v144, v145
  v_cvt_pk_bf16_f32 v65, v146, v147
  v_cvt_pk_bf16_f32 v66, v148, v149
  s_add_u32 s20, s14, 122880
  s_cmp_ge_u32 s20, 266240
  s_cselect_b32 s21, 266240, 0
  s_sub_u32 s20, s20, s21
  s_add_u32 s20, s20, s13
  buffer_load_dwordx4 a[120:123], v11, s[60:63], s20 offen offset:0 sc1
  v_cvt_pk_bf16_f32 v67, v150, v151
  v_cvt_pk_bf16_f32 v169, v170, v171
  ds_read_b64_tr_b16 v[96:97], v19 offset:0
  v_cvt_pk_bf16_f32 v172, v172, v173
  v_cmp_lt_f32 vcc, 0, v56
  s_nop 1
  v_cndmask_b32 v57, 0, v2, vcc
  ds_read_b64_tr_b16 v[98:99], v19 offset:448
  v_cvt_pk_bf16_f32 v173, v174, v175
  v_cndmask_b32 v168, v168, v57, s[18:19]
  ds_read_b64_tr_b16 v[100:101], v19 offset:32
  v_cndmask_b32 v169, v169, 0, s[18:19]
  v_cvt_pk_bf16_f32 v68, v152, v153
  ds_read_b64_tr_b16 v[102:103], v19 offset:480
  v_cvt_pk_bf16_f32 v69, v154, v155
  v_mul_f32 v90, 0x3fb8aa3b, v88
  ds_read_b64_tr_b16 v[104:105], v19 offset:64
  v_cvt_pk_bf16_f32 v156, v156, v157
  v_cvt_pk_bf16_f32 v157, v158, v159
  ds_read_b64_tr_b16 v[106:107], v19 offset:512
  v_mul_f32 v58, 0x3fb8aa3b, v56
  v_cvt_pk_bf16_f32 v188, v188, v189
  ds_write_b64 v18, v[136:137] offset:6144
  v_mfma_f32_32x32x16_bf16 v[128:143], v[24:27], v[64:67], 0
  v_cvt_pk_bf16_f32 v189, v190, v191
  v_accvgpr_read_b32 v88, a197
  v_accvgpr_read_b32 v56, a199
  ds_write_b64 v17, v[172:173] offset:0
  buffer_load_dwordx4 a[124:127], v11, s[60:63], s20 offen offset:1024 sc1
  s_waitcnt lgkmcnt(6)
  v_mfma_f32_16x16x32_bf16 a[200:203], v[96:99], v[32:35], a[200:203]
  s_waitcnt lgkmcnt(4)
  v_mfma_f32_16x16x32_bf16 a[208:211], v[100:103], v[32:35], a[208:211]
  ds_write_b64 v18, v[168:169] offset:0
  v_mfma_f32_16x16x32_bf16 a[204:207], v[96:99], v[36:39], a[204:207]
  s_waitcnt lgkmcnt(3)
  v_mfma_f32_16x16x32_bf16 a[216:219], v[104:107], v[32:35], a[216:219]
  v_cvt_pk_bf16_f32 v32, v176, v177
  v_cvt_pk_bf16_f32 v33, v178, v179
  v_cvt_pk_bf16_f32 v34, v180, v181
  v_cvt_pk_bf16_f32 v35, v182, v183
  v_mfma_f32_16x16x32_bf16 a[212:215], v[100:103], v[36:39], a[212:215]
  ds_write_b64 v17, v[156:157] offset:6168
  v_mfma_f32_32x32x16_bf16 v[160:175], v[24:27], v[32:35], 0
  ds_write_b64 v17, v[188:189] offset:24
  v_mfma_f32_16x16x32_bf16 a[220:223], v[104:107], v[36:39], a[220:223]
  v_cvt_pk_bf16_f32 v36, v184, v185
  v_cvt_pk_bf16_f32 v37, v186, v187
  v_mfma_f32_32x32x16_bf16 v[128:143], v[28:31], v[68:71], v[128:143]
  ds_read_b64_tr_b16 v[64:65], v20 offset:6144
  ds_read_b64_tr_b16 v[66:67], v20 offset:6432
  v_mfma_f32_32x32x16_bf16 v[160:175], v[28:31], v[36:39], v[160:175]
  ds_read_b64_tr_b16 v[32:33], v20 offset:0
  s_nop 7
  v_max3_f32 v92, v128, v129, v130
  v_max3_f32 v93, -v128, -v129, -v130
  v_max3_f32 v92, v92, v131, v132
  v_max3_f32 v93, v93, -v131, -v132
  v_max3_f32 v92, v92, v133, v134
  v_max3_f32 v93, v93, -v133, -v134
  buffer_load_dwordx4 a[128:131], v11, s[60:63], s20 offen offset:2048 sc1
  v_max3_f32 v92, v92, v135, v136
  v_max3_f32 v93, v93, -v135, -v136
  v_max_f32 v92, v92, v137
  v_max_f32_e64 v93, v93, -v137
  v_max3_f32 v60, v160, v161, v162
  v_max3_f32 v61, -v160, -v161, -v162
  v_max3_f32 v60, v60, v163, v164
  v_max3_f32 v61, v61, -v163, -v164
  v_max3_f32 v60, v60, v165, v166
  v_max3_f32 v61, v61, -v165, -v166
  v_permlane32_swap_b32 v92, v93
  v_max3_f32 v60, v60, v167, v168
  v_max3_f32 v61, v61, -v167, -v168
  v_max_f32 v60, v60, v169
  v_max_f32_e64 v61, v61, -v169
  v_max_f32 v92, v92, v93
  v_mov_b32 v93, v92
  v_permlane32_swap_b32 v60, v61
  s_nop 0
  v_permlane32_swap_b32 v92, v93
  v_max_f32 v60, v60, v61
  v_mov_b32 v61, v60
  v_pk_mul_f32 v[94:95], v[92:93], v[90:91] op_sel_hi:[1,0]
  v_pk_fma_f32 v[144:145], v[128:129], v[90:91], v[94:95] op_sel:[0,0,1] op_sel_hi:[1,0,1] neg_lo:[1,0,1] neg_hi:[1,0,1]
  v_pk_fma_f32 v[146:147], v[130:131], v[90:91], v[94:95] op_sel:[0,0,1] op_sel_hi:[1,0,1] neg_lo:[1,0,1] neg_hi:[1,0,1]
  v_pk_fma_f32 v[148:149], v[132:133], v[90:91], v[94:95] op_sel:[0,0,1] op_sel_hi:[1,0,1] neg_lo:[1,0,1] neg_hi:[1,0,1]
  v_pk_fma_f32 v[150:151], v[134:135], v[90:91], v[94:95] op_sel:[0,0,1] op_sel_hi:[1,0,1] neg_lo:[1,0,1] neg_hi:[1,0,1]
  v_pk_fma_f32 v[128:129], v[128:129], v[90:91], v[94:95] op_sel_hi:[1,0,0] neg_lo:[0,0,1] neg_hi:[0,0,1]
  buffer_load_dwordx4 a[132:135], v11, s[60:63], s20 offen offset:3072 sc1
  v_pk_fma_f32 v[130:131], v[130:131], v[90:91], v[94:95] op_sel_hi:[1,0,0] neg_lo:[0,0,1] neg_hi:[0,0,1]
  v_pk_fma_f32 v[132:133], v[132:133], v[90:91], v[94:95] op_sel_hi:[1,0,0] neg_lo:[0,0,1] neg_hi:[0,0,1]
  v_pk_fma_f32 v[134:135], v[134:135], v[90:91], v[94:95] op_sel_hi:[1,0,0] neg_lo:[0,0,1] neg_hi:[0,0,1]
  v_permlane32_swap_b32 v60, v61
  v_pk_fma_f32 v[152:153], v[136:137], v[90:91], v[94:95] op_sel:[0,0,1] op_sel_hi:[1,0,1] neg_lo:[1,0,1] neg_hi:[1,0,1]
  v_exp_f32 v128, v128
  v_exp_f32 v144, v144
  v_exp_f32 v129, v129
  v_exp_f32 v145, v145
  v_exp_f32 v130, v130
  v_exp_f32 v146, v146
  v_exp_f32 v131, v131
  v_exp_f32 v147, v147
  v_exp_f32 v132, v132
  v_exp_f32 v148, v148
  v_exp_f32 v133, v133
  v_exp_f32 v149, v149
  v_exp_f32 v134, v134
  v_exp_f32 v150, v150
  v_exp_f32 v135, v135
  v_exp_f32 v151, v151
  v_pk_fma_f32 v[136:137], v[136:137], v[90:91], v[94:95] op_sel_hi:[1,0,0] neg_lo:[0,0,1] neg_hi:[0,0,1]
  v_pk_mul_f32 v[62:63], v[60:61], v[58:59] op_sel_hi:[1,0]
  v_exp_f32 v136, v136
  v_exp_f32 v152, v152
  v_exp_f32 v137, v137
  v_exp_f32 v153, v153
  s_add_u32 s20, s20, 4096
  buffer_load_dwordx4 a[136:139], v11, s[60:63], s20 offen sc1
  v_pk_fma_f32 v[176:177], v[160:161], v[58:59], v[62:63] op_sel:[0,0,1] op_sel_hi:[1,0,1] neg_lo:[1,0,1] neg_hi:[1,0,1]
  v_pk_fma_f32 v[178:179], v[162:163], v[58:59], v[62:63] op_sel:[0,0,1] op_sel_hi:[1,0,1] neg_lo:[1,0,1] neg_hi:[1,0,1]
  v_pk_fma_f32 v[180:181], v[164:165], v[58:59], v[62:63] op_sel:[0,0,1] op_sel_hi:[1,0,1] neg_lo:[1,0,1] neg_hi:[1,0,1]
  v_pk_fma_f32 v[182:183], v[166:167], v[58:59], v[62:63] op_sel:[0,0,1] op_sel_hi:[1,0,1] neg_lo:[1,0,1] neg_hi:[1,0,1]
  v_pk_add_f32 v[138:139], v[128:129], v[130:131]
  v_pk_add_f32 v[140:141], v[132:133], v[134:135]
  v_pk_add_f32 v[154:155], v[144:145], v[146:147]
  v_pk_add_f32 v[156:157], v[148:149], v[150:151]
  v_pk_fma_f32 v[160:161], v[160:161], v[58:59], v[62:63] op_sel_hi:[1,0,0] neg_lo:[0,0,1] neg_hi:[0,0,1]
  v_pk_fma_f32 v[162:163], v[162:163], v[58:59], v[62:63] op_sel_hi:[1,0,0] neg_lo:[0,0,1] neg_hi:[0,0,1]
  v_pk_fma_f32 v[164:165], v[164:165], v[58:59], v[62:63] op_sel_hi:[1,0,0] neg_lo:[0,0,1] neg_hi:[0,0,1]
  v_pk_fma_f32 v[166:167], v[166:167], v[58:59], v[62:63] op_sel_hi:[1,0,0] neg_lo:[0,0,1] neg_hi:[0,0,1]
  v_pk_add_f32 v[138:139], v[138:139], v[140:141]
  v_pk_add_f32 v[154:155], v[154:155], v[156:157]
  v_pk_fma_f32 v[184:185], v[168:169], v[58:59], v[62:63] op_sel:[0,0,1] op_sel_hi:[1,0,1] neg_lo:[1,0,1] neg_hi:[1,0,1]
  v_exp_f32 v160, v160
  v_exp_f32 v176, v176
  v_exp_f32 v161, v161
  v_exp_f32 v177, v177
  v_exp_f32 v162, v162
  v_exp_f32 v178, v178
  v_exp_f32 v163, v163
  v_exp_f32 v179, v179
  v_exp_f32 v164, v164
  v_exp_f32 v180, v180
  v_exp_f32 v165, v165
  v_exp_f32 v181, v181
  s_add_u32 s20, s14, 143360
  s_cmp_ge_u32 s20, 266240
  s_cselect_b32 s21, 266240, 0
  s_sub_u32 s20, s20, s21
  s_add_u32 s20, s20, s13
  buffer_load_dwordx4 a[140:143], v11, s[60:63], s20 offen offset:0 sc1
  v_exp_f32 v166, v166
  v_exp_f32 v182, v182
  v_exp_f32 v167, v167
  v_exp_f32 v183, v183
  s_waitcnt vmcnt(7)
  s_cbranch_execz L_nb3
  s_barrier
L_nb3:
  s_cbranch_execz L_dry_done
L_dry1:
  buffer_store_dword v3, v4, s[44:47], s81 offen sc1
  v_pk_add_f32 v[138:139], v[138:139], v[136:137]
  v_pk_add_f32 v[154:155], v[154:155], v[152:153]
  v_pk_fma_f32 v[168:169], v[168:169], v[58:59], v[62:63] op_sel_hi:[1,0,0] neg_lo:[0,0,1] neg_hi:[0,0,1]
  v_add_f32 v92, v138, v139
  v_add_f32 v93, v154, v155
  v_exp_f32 v168, v168
  v_exp_f32 v184, v184
  v_exp_f32 v169, v169
  v_exp_f32 v185, v185
  v_pk_add_f32 v[170:171], v[160:161], v[162:163]
  v_pk_add_f32 v[172:173], v[164:165], v[166:167]
  v_pk_add_f32 v[186:187], v[176:177], v[178:179]
  v_pk_add_f32 v[188:189], v[180:181], v[182:183]
  v_pk_add_f32 v[170:171], v[170:171], v[172:173]
  v_pk_add_f32 v[186:187], v[186:187], v[188:189]
  v_permlane32_swap_b32 v92, v93
  v_pk_add_f32 v[170:171], v[170:171], v[168:169]
  v_pk_add_f32 v[186:187], v[186:187], v[184:185]
  v_add_f32 v60, v170, v171
  v_add_f32 v61, v186, v187
  v_add_f32 v92, v92, v93
  v_rcp_f32 v92, v92
  v_permlane32_swap_b32 v60, v61
  v_mov_b32 v93, v92
  v_add_f32 v60, v60, v61
  v_rcp_f32 v60, v60
  buffer_load_dwordx4 a[144:147], v11, s[60:63], s20 offen offset:1024 sc1
  v_permlane32_swap_b32 v92, v93
  v_mov_b32 v61, v60
  v_pk_mul_f32 v[128:129], v[128:129], v[92:93] op_sel_hi:[1,0]
  v_pk_mul_f32 v[144:145], v[144:145], v[92:93] op_sel:[0,1] op_sel_hi:[1,1]
  v_pk_mul_f32 v[130:131], v[130:131], v[92:93] op_sel_hi:[1,0]
  v_pk_mul_f32 v[146:147], v[146:147], v[92:93] op_sel:[0,1] op_sel_hi:[1,1]
  v_pk_mul_f32 v[132:133], v[132:133], v[92:93] op_sel_hi:[1,0]
  v_pk_mul_f32 v[148:149], v[148:149], v[92:93] op_sel:[0,1] op_sel_hi:[1,1]
  v_pk_mul_f32 v[134:135], v[134:135], v[92:93] op_sel_hi:[1,0]
  v_pk_mul_f32 v[150:151], v[150:151], v[92:93] op_sel:[0,1] op_sel_hi:[1,1]
  v_pk_mul_f32 v[136:137], v[136:137], v[92:93] op_sel_hi:[1,0]
  v_pk_mul_f32 v[152:153], v[152:153], v[92:93] op_sel:[0,1] op_sel_hi:[1,1]
  v_cvt_pk_bf16_f32 v72, v128, v129
  v_cvt_pk_bf16_f32 v73, v130, v131
  v_cvt_pk_bf16_f32 v74, v132, v133
  v_cvt_pk_bf16_f32 v75, v134, v135
  v_cvt_pk_bf16_f32 v76, v136, v137
  v_cvt_pk_bf16_f32 v77, v144, v145
  v_cvt_pk_bf16_f32 v78, v146, v147
  v_cvt_pk_bf16_f32 v79, v148, v149
  v_cvt_pk_bf16_f32 v80, v150, v151
  v_cvt_pk_bf16_f32 v81, v152, v153
  ds_write_b128 v16, v[72:75] offset:6144
  v_permlane32_swap_b32 v60, v61
  v_pk_mul_f32 v[160:161], v[160:161], v[60:61] op_sel_hi:[1,0]
  v_pk_mul_f32 v[176:177], v[176:177], v[60:61] op_sel:[0,1] op_sel_hi:[1,1]
  buffer_load_dwordx4 a[148:151], v11, s[60:63], s20 offen offset:2048 sc1
  v_pk_mul_f32 v[162:163], v[162:163], v[60:61] op_sel_hi:[1,0]
  v_pk_mul_f32 v[178:179], v[178:179], v[60:61] op_sel:[0,1] op_sel_hi:[1,1]
  v_pk_mul_f32 v[164:165], v[164:165], v[60:61] op_sel_hi:[1,0]
  v_pk_mul_f32 v[180:181], v[180:181], v[60:61] op_sel:[0,1] op_sel_hi:[1,1]
  ds_write_b128 v16, v[76:79] offset:6176
  v_pk_mul_f32 v[166:167], v[166:167], v[60:61] op_sel_hi:[1,0]
  v_pk_mul_f32 v[182:183], v[182:183], v[60:61] op_sel:[0,1] op_sel_hi:[1,1]
  v_pk_mul_f32 v[168:169], v[168:169], v[60:61] op_sel_hi:[1,0]
  v_pk_mul_f32 v[184:185], v[184:185], v[60:61] op_sel:[0,1] op_sel_hi:[1,1]
  v_cvt_pk_bf16_f32 v40, v160, v161
  v_cvt_pk_bf16_f32 v41, v162, v163
  v_cvt_pk_bf16_f32 v42, v164, v165
  v_cvt_pk_bf16_f32 v43, v166, v167
  ds_write_b64 v16, v[80:81] offset:6208
  v_cvt_pk_bf16_f32 v44, v168, v169
  v_cvt_pk_bf16_f32 v45, v176, v177
  v_cvt_pk_bf16_f32 v46, v178, v179
  v_cvt_pk_bf16_f32 v47, v180, v181
  v_cvt_pk_bf16_f32 v48, v182, v183
  v_cvt_pk_bf16_f32 v49, v184, v185
  ds_write_b128 v16, v[40:43] offset:0
  v_pk_mul_f32 v[200:201], v[200:201], v[88:89] op_sel_hi:[1,0]
  v_pk_mul_f32 v[202:203], v[202:203], v[88:89] op_sel_hi:[1,0]
  v_pk_mul_f32 v[204:205], v[204:205], v[88:89] op_sel_hi:[1,0]
  v_pk_mul_f32 v[206:207], v[206:207], v[88:89] op_sel_hi:[1,0]
  v_pk_mul_f32 v[220:221], v[220:221], v[88:89] op_sel_hi:[1,0]
  buffer_load_dwordx4 a[152:155], v11, s[60:63], s20 offen offset:3072 sc1
  v_pk_mul_f32 v[222:223], v[222:223], v[88:89] op_sel_hi:[1,0]
  v_cvt_pk_bf16_f32 v200, v200, v201
  v_cvt_pk_bf16_f32 v201, v202, v203
  ds_write_b128 v16, v[44:47] offset:32
  v_cvt_pk_bf16_f32 v204, v204, v205
  v_cmp_lt_f32 vcc, 0, v88
  s_nop 1
  v_cndmask_b32 v89, 0, v2, vcc
  v_cvt_pk_bf16_f32 v205, v206, v207
  v_cndmask_b32 v200, v200, v89, s[18:19]
  v_cndmask_b32 v201, v201, 0, s[18:19]
  v_pk_mul_f32 v[232:233], v[232:233], v[56:57] op_sel_hi:[1,0]
  v_pk_mul_f32 v[234:235], v[234:235], v[56:57] op_sel_hi:[1,0]
  ds_write_b64 v16, v[48:49] offset:64
  v_pk_mul_f32 v[236:237], v[236:237], v[56:57] op_sel_hi:[1,0]
  v_pk_mul_f32 v[238:239], v[238:239], v[56:57] op_sel_hi:[1,0]
  v_pk_mul_f32 v[252:253], v[252:253], v[56:57] op_sel_hi:[1,0]
  v_pk_mul_f32 v[254:255], v[254:255], v[56:57] op_sel_hi:[1,0]
  v_cvt_pk_bf16_f32 v232, v232, v233
  ds_read_b64_tr_b16 v[128:129], v19 offset:6144
  v_cvt_pk_bf16_f32 v233, v234, v235
  v_cvt_pk_bf16_f32 v236, v236, v237
  ds_read_b64_tr_b16 v[130:131], v19 offset:6592
  v_cmp_lt_f32 vcc, 0, v56
  s_nop 1
  v_cndmask_b32 v57, 0, v2, vcc
  ds_read_b64_tr_b16 v[132:133], v19 offset:6176
  v_cvt_pk_bf16_f32 v237, v238, v239
  s_add_u32 s20, s20, 4096
  buffer_load_dwordx4 a[156:159], v11, s[60:63], s20 offen sc1
  v_cndmask_b32 v232, v232, v57, s[18:19]
  ds_read_b64_tr_b16 v[134:135], v19 offset:6624
  v_cndmask_b32 v233, v233, 0, s[18:19]
  v_mul_f32 v90, 0x3fb8aa3b, v88
  ds_read_b64_tr_b16 v[136:137], v19 offset:6208
  v_cvt_pk_bf16_f32 v220, v220, v221
  v_cvt_pk_bf16_f32 v221, v222, v223
  ds_read_b64_tr_b16 v[138:139], v19 offset:6656
  v_mul_f32 v58, 0x3fb8aa3b, v56
  v_cvt_pk_bf16_f32 v252, v252, v253
  ds_read_b64_tr_b16 v[34:35], v20 offset:288
  v_cvt_pk_bf16_f32 v253, v254, v255
  ds_read_b64_tr_b16 v[160:161], v19 offset:0
  s_waitcnt lgkmcnt(6)
  v_mfma_f32_16x16x32_bf16 a[200:203], v[128:131], v[64:67], a[200:203]
  ds_read_b64_tr_b16 v[162:163], v19 offset:448
  ds_read_b64_tr_b16 v[164:165], v19 offset:32
  s_waitcnt lgkmcnt(6)
  v_mfma_f32_16x16x32_bf16 a[208:211], v[132:135], v[64:67], a[208:211]
  ds_read_b64_tr_b16 v[166:167], v19 offset:480
  ds_read_b64_tr_b16 v[168:169], v19 offset:64
  s_waitcnt lgkmcnt(6)
  v_mfma_f32_16x16x32_bf16 a[216:219], v[136:139], v[64:67], a[216:219]
  v_cvt_pk_bf16_f32 v64, v208, v209
  ds_read_b64_tr_b16 v[170:171], v19 offset:512
  v_cvt_pk_bf16_f32 v65, v210, v211
  v_cvt_pk_bf16_f32 v66, v212, v213
  ds_read_b64_tr_b16 v[68:69], v20 offset:6176
  v_cvt_pk_bf16_f32 v67, v214, v215
  s_add_u32 s20, s14, 163840
  s_cmp_ge_u32 s20, 266240
  s_cselect_b32 s21, 266240, 0
  s_sub_u32 s20, s20, s21
  s_add_u32 s20, s20, s13
  buffer_load_dwordx4 a[160:163], v11, s[60:63], s20 offen offset:0 sc1
  ds_read_b64_tr_b16 v[70:71], v20 offset:6464
  s_waitcnt lgkmcnt(6)
  v_mfma_f32_16x16x32_bf16 a[200:203], v[160:163], v[32:35], a[200:203]
  ds_read_b64_tr_b16 v[36:37], v20 offset:32
  ds_read_b64_tr_b16 v[38:39], v20 offset:320
  s_waitcnt lgkmcnt(6)
  v_mfma_f32_16x16x32_bf16 a[208:211], v[164:167], v[32:35], a[208:211]
  ds_write_b64 v17, v[204:205] offset:6144
  s_waitcnt lgkmcnt(5)
  v_mfma_f32_16x16x32_bf16 a[216:219], v[168:171], v[32:35], a[216:219]
  v_cvt_pk_bf16_f32 v32, v240, v241
  v_cvt_pk_bf16_f32 v33, v242, v243
  ds_write_b64 v18, v[200:201] offset:6144
  v_mfma_f32_32x32x16_bf16 v[192:207], v[24:27], v[64:67], 0
  v_cvt_pk_bf16_f32 v34, v244, v245
  v_cvt_pk_bf16_f32 v35, v246, v247
  ds_write_b64 v17, v[236:237] offset:0
  s_waitcnt lgkmcnt(5)
  v_mfma_f32_16x16x32_bf16 a[204:207], v[128:131], v[68:71], a[204:207]
  v_mfma_f32_16x16x32_bf16 a[212:215], v[132:135], v[68:71], a[212:215]
  ds_write_b64 v18, v[232:233] offset:0
  v_mfma_f32_16x16x32_bf16 a[220:223], v[136:139], v[68:71], a[220:223]
  v_cvt_pk_bf16_f32 v68, v216, v217
  v_cvt_pk_bf16_f32 v69, v218, v219
  v_mfma_f32_32x32x16_bf16 v[224:239], v[24:27], v[32:35], 0
  ds_write_b64 v17, v[220:221] offset:6168
  s_waitcnt lgkmcnt(5)
  v_mfma_f32_16x16x32_bf16 a[204:207], v[160:163], v[36:39], a[204:207]
  ds_write_b64 v17, v[252:253] offset:24
  v_mfma_f32_16x16x32_bf16 a[212:215], v[164:167], v[36:39], a[212:215]
  v_mfma_f32_16x16x32_bf16 a[220:223], v[168:171], v[36:39], a[220:223]
  buffer_load_dwordx4 a[164:167], v11, s[60:63], s20 offen offset:1024 sc1
  v_cvt_pk_bf16_f32 v36, v248, v249
  v_cvt_pk_bf16_f32 v37, v250, v251
  ds_read_b64_tr_b16 v[64:65], v20 offset:6144
  v_mfma_f32_32x32x16_bf16 v[192:207], v[28:31], v[68:71], v[192:207]
  ds_read_b64_tr_b16 v[66:67], v20 offset:6432
  ds_read_b64_tr_b16 v[68:69], v20 offset:6176
  v_mfma_f32_32x32x16_bf16 v[224:239], v[28:31], v[36:39], v[224:239]
  ds_read_b64_tr_b16 v[70:71], v20 offset:6464
  s_nop 7
  v_max3_f32 v92, v192, v193, v194
  v_max3_f32 v93, -v192, -v193, -v194
  v_max3_f32 v92, v92, v195, v196
  v_max3_f32 v93, v93, -v195, -v196
  v_max3_f32 v92, v92, v197, v198
  v_max3_f32 v93, v93, -v197, -v198
  v_max3_f32 v92, v92, v199, v200
  v_max3_f32 v93, v93, -v199, -v200
  v_max_f32 v92, v92, v201
  v_max_f32_e64 v93, v93, -v201
  v_max3_f32 v60, v224, v225, v226
  v_max3_f32 v61, -v224, -v225, -v226
  v_max3_f32 v60, v60, v227, v228
  v_max3_f32 v61, v61, -v227, -v228
  v_max3_f32 v60, v60, v229, v230
  v_max3_f32 v61, v61, -v229, -v230
  v_permlane32_swap_b32 v92, v93
  v_max3_f32 v60, v60, v231, v232
  buffer_load_dwordx4 a[168:171], v11, s[60:63], s20 offen offset:2048 sc1
  v_max3_f32 v61, v61, -v231, -v232
  v_max_f32 v60, v60, v233
  v_max_f32_e64 v61, v61, -v233
  v_max_f32 v92, v92, v93
  v_mov_b32 v93, v92
  v_permlane32_swap_b32 v60, v61
  s_nop 0
  v_permlane32_swap_b32 v92, v93
  v_max_f32 v60, v60, v61
  v_mov_b32 v61, v60
  v_pk_mul_f32 v[94:95], v[92:93], v[90:91] op_sel_hi:[1,0]
  v_pk_fma_f32 v[208:209], v[192:193], v[90:91], v[94:95] op_sel:[0,0,1] op_sel_hi:[1,0,1] neg_lo:[1,0,1] neg_hi:[1,0,1]
  v_pk_fma_f32 v[210:211], v[194:195], v[90:91], v[94:95] op_sel:[0,0,1] op_sel_hi:[1,0,1] neg_lo:[1,0,1] neg_hi:[1,0,1]
  v_pk_fma_f32 v[212:213], v[196:197], v[90:91], v[94:95] op_sel:[0,0,1] op_sel_hi:[1,0,1] neg_lo:[1,0,1] neg_hi:[1,0,1]
  v_pk_fma_f32 v[214:215], v[198:199], v[90:91], v[94:95] op_sel:[0,0,1] op_sel_hi:[1,0,1] neg_lo:[1,0,1] neg_hi:[1,0,1]
  v_pk_fma_f32 v[192:193], v[192:193], v[90:91], v[94:95] op_sel_hi:[1,0,0] neg_lo:[0,0,1] neg_hi:[0,0,1]
  v_pk_fma_f32 v[194:195], v[194:195], v[90:91], v[94:95] op_sel_hi:[1,0,0] neg_lo:[0,0,1] neg_hi:[0,0,1]
  v_pk_fma_f32 v[196:197], v[196:197], v[90:91], v[94:95] op_sel_hi:[1,0,0] neg_lo:[0,0,1] neg_hi:[0,0,1]
  v_pk_fma_f32 v[198:199], v[198:199], v[90:91], v[94:95] op_sel_hi:[1,0,0] neg_lo:[0,0,1] neg_hi:[0,0,1]
  v_permlane32_swap_b32 v60, v61
  v_pk_fma_f32 v[216:217], v[200:201], v[90:91], v[94:95] op_sel:[0,0,1] op_sel_hi:[1,0,1] neg_lo:[1,0,1] neg_hi:[1,0,1]
  v_exp_f32 v192, v192
  v_exp_f32 v208, v208
  v_exp_f32 v193, v193
  v_exp_f32 v209, v209
  v_exp_f32 v194, v194
  v_exp_f32 v210, v210
  buffer_load_dwordx4 a[172:175], v11, s[60:63], s20 offen offset:3072 sc1
  v_exp_f32 v195, v195
  v_exp_f32 v211, v211
  v_exp_f32 v196, v196
  v_exp_f32 v212, v212
  v_exp_f32 v197, v197
  v_exp_f32 v213, v213
  v_exp_f32 v198, v198
  v_exp_f32 v214, v214
  v_exp_f32 v199, v199
  v_exp_f32 v215, v215
  v_pk_fma_f32 v[200:201], v[200:201], v[90:91], v[94:95] op_sel_hi:[1,0,0] neg_lo:[0,0,1] neg_hi:[0,0,1]
  v_pk_mul_f32 v[62:63], v[60:61], v[58:59] op_sel_hi:[1,0]
  v_exp_f32 v200, v200
  v_exp_f32 v216, v216
  v_exp_f32 v201, v201
  v_exp_f32 v217, v217
  v_pk_fma_f32 v[240:241], v[224:225], v[58:59], v[62:63] op_sel:[0,0,1] op_sel_hi:[1,0,1] neg_lo:[1,0,1] neg_hi:[1,0,1]
  v_pk_fma_f32 v[242:243], v[226:227], v[58:59], v[62:63] op_sel:[0,0,1] op_sel_hi:[1,0,1] neg_lo:[1,0,1] neg_hi:[1,0,1]
  v_pk_fma_f32 v[244:245], v[228:229], v[58:59], v[62:63] op_sel:[0,0,1] op_sel_hi:[1,0,1] neg_lo:[1,0,1] neg_hi:[1,0,1]
  v_pk_fma_f32 v[246:247], v[230:231], v[58:59], v[62:63] op_sel:[0,0,1] op_sel_hi:[1,0,1] neg_lo:[1,0,1] neg_hi:[1,0,1]
  v_pk_add_f32 v[202:203], v[192:193], v[194:195]
  v_pk_add_f32 v[204:205], v[196:197], v[198:199]
  v_pk_add_f32 v[218:219], v[208:209], v[210:211]
  v_pk_add_f32 v[220:221], v[212:213], v[214:215]
  v_pk_fma_f32 v[224:225], v[224:225], v[58:59], v[62:63] op_sel_hi:[1,0,0] neg_lo:[0,0,1] neg_hi:[0,0,1]
  v_pk_fma_f32 v[226:227], v[226:227], v[58:59], v[62:63] op_sel_hi:[1,0,0] neg_lo:[0,0,1] neg_hi:[0,0,1]
  s_add_u32 s20, s20, 4096
  buffer_load_dwordx4 a[176:179], v11, s[60:63], s20 offen sc1
  v_pk_fma_f32 v[228:229], v[228:229], v[58:59], v[62:63] op_sel_hi:[1,0,0] neg_lo:[0,0,1] neg_hi:[0,0,1]
  v_pk_fma_f32 v[230:231], v[230:231], v[58:59], v[62:63] op_sel_hi:[1,0,0] neg_lo:[0,0,1] neg_hi:[0,0,1]
  v_pk_add_f32 v[202:203], v[202:203], v[204:205]
  v_pk_add_f32 v[218:219], v[218:219], v[220:221]
  v_pk_fma_f32 v[248:249], v[232:233], v[58:59], v[62:63] op_sel:[0,0,1] op_sel_hi:[1,0,1] neg_lo:[1,0,1] neg_hi:[1,0,1]
  v_exp_f32 v224, v224
  v_exp_f32 v240, v240
  v_exp_f32 v225, v225
  v_exp_f32 v241, v241
  v_exp_f32 v226, v226
  v_exp_f32 v242, v242
  v_exp_f32 v227, v227
  v_exp_f32 v243, v243
  v_exp_f32 v228, v228
  v_exp_f32 v244, v244
  v_exp_f32 v229, v229
  v_exp_f32 v245, v245
  v_exp_f32 v230, v230
  v_exp_f32 v246, v246
  v_exp_f32 v231, v231
  v_exp_f32 v247, v247
  v_pk_add_f32 v[202:203], v[202:203], v[200:201]
  v_pk_add_f32 v[218:219], v[218:219], v[216:217]
  v_pk_fma_f32 v[232:233], v[232:233], v[58:59], v[62:63] op_sel_hi:[1,0,0] neg_lo:[0,0,1] neg_hi:[0,0,1]
  v_add_f32 v92, v202, v203
  v_add_f32 v93, v218, v219
  v_exp_f32 v232, v232
  v_exp_f32 v248, v248
  v_exp_f32 v233, v233
  v_exp_f32 v249, v249
  v_pk_add_f32 v[234:235], v[224:225], v[226:227]
  v_pk_add_f32 v[236:237], v[228:229], v[230:231]
  v_pk_add_f32 v[250:251], v[240:241], v[242:243]
  v_pk_add_f32 v[252:253], v[244:245], v[246:247]
  v_pk_add_f32 v[234:235], v[234:235], v[236:237]
  v_pk_add_f32 v[250:251], v[250:251], v[252:253]
  v_permlane32_swap_b32 v92, v93
  v_pk_add_f32 v[234:235], v[234:235], v[232:233]
  v_pk_add_f32 v[250:251], v[250:251], v[248:249]
  v_add_f32 v60, v234, v235
  v_add_f32 v61, v250, v251
  v_add_f32 v92, v92, v93
  v_rcp_f32 v92, v92
  v_permlane32_swap_b32 v60, v61
  v_mov_b32 v93, v92
  v_add_f32 v60, v60, v61
  v_rcp_f32 v60, v60
  v_permlane32_swap_b32 v92, v93
  v_mov_b32 v61, v60
  v_pk_mul_f32 v[192:193], v[192:193], v[92:93] op_sel_hi:[1,0]
  v_pk_mul_f32 v[208:209], v[208:209], v[92:93] op_sel:[0,1] op_sel_hi:[1,1]
  v_pk_mul_f32 v[194:195], v[194:195], v[92:93] op_sel_hi:[1,0]
  v_pk_mul_f32 v[210:211], v[210:211], v[92:93] op_sel:[0,1] op_sel_hi:[1,1]
  v_pk_mul_f32 v[196:197], v[196:197], v[92:93] op_sel_hi:[1,0]
  v_pk_mul_f32 v[212:213], v[212:213], v[92:93] op_sel:[0,1] op_sel_hi:[1,1]
  v_pk_mul_f32 v[198:199], v[198:199], v[92:93] op_sel_hi:[1,0]
  v_pk_mul_f32 v[214:215], v[214:215], v[92:93] op_sel:[0,1] op_sel_hi:[1,1]
  v_pk_mul_f32 v[200:201], v[200:201], v[92:93] op_sel_hi:[1,0]
  v_pk_mul_f32 v[216:217], v[216:217], v[92:93] op_sel:[0,1] op_sel_hi:[1,1]
  v_cvt_pk_bf16_f32 v72, v192, v193
  v_cvt_pk_bf16_f32 v73, v194, v195
  v_cvt_pk_bf16_f32 v74, v196, v197
  v_cvt_pk_bf16_f32 v75, v198, v199
  v_cvt_pk_bf16_f32 v76, v200, v201
  v_cvt_pk_bf16_f32 v77, v208, v209
  v_cvt_pk_bf16_f32 v78, v210, v211
  v_cvt_pk_bf16_f32 v79, v212, v213
  v_cvt_pk_bf16_f32 v80, v214, v215
  v_cvt_pk_bf16_f32 v81, v216, v217
  ds_write_b128 v16, v[72:75] offset:6144
  v_permlane32_swap_b32 v60, v61
  v_pk_mul_f32 v[224:225], v[224:225], v[60:61] op_sel_hi:[1,0]
  v_pk_mul_f32 v[240:241], v[240:241], v[60:61] op_sel:[0,1] op_sel_hi:[1,1]
  v_pk_mul_f32 v[226:227], v[226:227], v[60:61] op_sel_hi:[1,0]
  v_pk_mul_f32 v[242:243], v[242:243], v[60:61] op_sel:[0,1] op_sel_hi:[1,1]
  v_pk_mul_f32 v[228:229], v[228:229], v[60:61] op_sel_hi:[1,0]
  v_pk_mul_f32 v[244:245], v[244:245], v[60:61] op_sel:[0,1] op_sel_hi:[1,1]
  ds_write_b128 v16, v[76:79] offset:6176
  v_pk_mul_f32 v[230:231], v[230:231], v[60:61] op_sel_hi:[1,0]
  v_pk_mul_f32 v[246:247], v[246:247], v[60:61] op_sel:[0,1] op_sel_hi:[1,1]
  v_pk_mul_f32 v[232:233], v[232:233], v[60:61] op_sel_hi:[1,0]
  v_pk_mul_f32 v[248:249], v[248:249], v[60:61] op_sel:[0,1] op_sel_hi:[1,1]
  v_cvt_pk_bf16_f32 v40, v224, v225
  v_cvt_pk_bf16_f32 v41, v226, v227
  buffer_load_dword v3, v12, s[44:47], s11 offen sc1
  v_cvt_pk_bf16_f32 v42, v228, v229
  v_cvt_pk_bf16_f32 v43, v230, v231
  ds_write_b64 v16, v[80:81] offset:6208
  v_cvt_pk_bf16_f32 v44, v232, v233
  v_cvt_pk_bf16_f32 v45, v240, v241
  v_cvt_pk_bf16_f32 v46, v242, v243
  v_cvt_pk_bf16_f32 v47, v244, v245
  v_cvt_pk_bf16_f32 v48, v246, v247
  v_cvt_pk_bf16_f32 v49, v248, v249
  ds_write_b128 v16, v[40:43] offset:0
  ds_write_b128 v16, v[44:47] offset:32
  ds_write_b64 v16, v[48:49] offset:64
  ds_read_b64_tr_b16 v[192:193], v19 offset:6144
  ds_read_b64_tr_b16 v[194:195], v19 offset:6592
  ds_read_b64_tr_b16 v[196:197], v19 offset:6176
  ds_read_b64_tr_b16 v[198:199], v19 offset:6624
  ds_read_b64_tr_b16 v[200:201], v19 offset:6208
  ds_read_b64_tr_b16 v[202:203], v19 offset:6656
  ds_read_b64_tr_b16 v[32:33], v20 offset:0
  ds_read_b64_tr_b16 v[34:35], v20 offset:288
  s_waitcnt lgkmcnt(6)
  v_mfma_f32_16x16x32_bf16 a[200:203], v[192:195], v[64:67], a[200:203]
  ds_read_b64_tr_b16 v[36:37], v20 offset:32
  v_mfma_f32_16x16x32_bf16 a[204:207], v[192:195], v[68:71], a[204:207]
  ds_read_b64_tr_b16 v[38:39], v20 offset:320
  s_waitcnt lgkmcnt(6)
  v_mfma_f32_16x16x32_bf16 a[208:211], v[196:199], v[64:67], a[208:211]
  ds_read_b64_tr_b16 v[224:225], v19 offset:0
  v_mfma_f32_16x16x32_bf16 a[212:215], v[196:199], v[68:71], a[212:215]
  ds_read_b64_tr_b16 v[226:227], v19 offset:448
  s_waitcnt lgkmcnt(6)
  v_mfma_f32_16x16x32_bf16 a[216:219], v[200:203], v[64:67], a[216:219]
  ds_read_b64_tr_b16 v[228:229], v19 offset:32
  v_mfma_f32_16x16x32_bf16 a[220:223], v[200:203], v[68:71], a[220:223]
  ds_read_b64_tr_b16 v[230:231], v19 offset:480
  ds_read_b64_tr_b16 v[232:233], v19 offset:64
  ds_read_b64_tr_b16 v[234:235], v19 offset:512
  s_waitcnt lgkmcnt(4)
  v_mfma_f32_16x16x32_bf16 a[200:203], v[224:227], v[32:35], a[200:203]
  v_mfma_f32_16x16x32_bf16 a[204:207], v[224:227], v[36:39], a[204:207]
  s_waitcnt lgkmcnt(2)
  v_mfma_f32_16x16x32_bf16 a[208:211], v[228:231], v[32:35], a[208:211]
  v_mfma_f32_16x16x32_bf16 a[212:215], v[228:231], v[36:39], a[212:215]
  s_waitcnt lgkmcnt(0)
  v_mfma_f32_16x16x32_bf16 a[216:219], v[232:235], v[32:35], a[216:219]
  v_mfma_f32_16x16x32_bf16 a[220:223], v[232:235], v[36:39], a[220:223]
  s_nop 0
  buffer_store_dwordx4 a[200:203], v21, s[56:59], 0 offen offset:0 sc1
  buffer_store_dwordx4 a[204:207], v22, s[56:59], 0 offen offset:3072 sc1
  s_nop 0
  buffer_store_dwordx4 a[208:211], v21, s[56:59], 0 offen offset:64 sc1
  buffer_store_dwordx4 a[212:215], v22, s[56:59], 0 offen offset:3136 sc1
  s_nop 0
  buffer_store_dwordx4 a[216:219], v21, s[56:59], 0 offen offset:128 sc1
  buffer_store_dwordx4 a[220:223], v22, s[56:59], 0 offen offset:3200 sc1
  s_waitcnt vmcnt(6)
  v_cmp_ne_u32 vcc, 1, v3
  s_and_b64 vcc, vcc, s[8:9]
  s_cbranch_vccnz L_AL_spin
L_AL_go:
  buffer_load_dwordx4 v[160:163], v11, s[24:27], s10 offen offset:0 sc1
  buffer_load_dword v164, v12, s[24:27], s10 offen offset:1024 sc1
  buffer_load_dwordx4 v[166:169], v11, s[24:27], s10 offen offset:1280 sc1
  buffer_load_dword v170, v12, s[24:27], s10 offen offset:2304 sc1
  s_mov_b32 s81, 1073741824
  s_mov_b32 s80, 1
  s_nop 1
L_dry2:
L_Bpre:
  s_waitcnt lgkmcnt(0)
  s_load_dwordx2 s[6:7], s[0:1], 64
  s_and_b32 s76, s2, 7
  s_lshr_b32 s77, s2, 3
  s_lshr_b32 s65, s76, 1
  s_lshl_b32 s65, s65, 3
  s_and_b32 s78, s77, 7
  s_add_u32 s65, s65, s78
  s_lshl_b32 s66, s76, 2
  s_and_b32 s78, s77, 3
  s_add_u32 s66, s66, s78
  s_lshr_b32 s67, s77, 2
  s_lshl_b32 s68, s67, 3
  s_lshl_b32 s78, s64, 1
  s_add_u32 s68, s68, s78
  v_and_b32 v1, 63, v0
  v_lshlrev_b32 v2, 4, v1
  v_lshlrev_b32 v4, 4, v0
  v_lshlrev_b32 v5, 2, v1
  s_add_u32 s48, s22, 40960
  s_addc_u32 s49, s23, 0
  s_and_b32 s50, s84, 12288
  s_mov_b32 s51, 0x20000
  s_cmp_eq_u32 s64, 0
  s_cselect_b32 s79, s84, 0
  s_and_b32 s8, s79, 0x1ff
  s_mov_b32 s9, 0
  s_and_b32 s10, s79, 0x1fff
  s_mov_b32 s11, 0
  s_lshr_b32 s76, s65, 1
  s_lshl_b32 s76, s76, 6
  s_add_u32 s16, s76, 5120
  s_cmp_eq_u32 s64, 0
  s_cselect_b32 s17, 0, 1073741824
  s_cselect_b32 s16, s16, 1073741824
  s_lshr_b32 s76, s66, 2
  s_mul_i32 s76, s76, 262144
  s_and_b32 s77, s66, 3
  s_lshl_b32 s77, s77, 12
  s_add_u32 s76, s76, s77
  s_add_u32 s76, s76, 15405056
  s_add_u32 s36, s22, s76
  s_addc_u32 s37, s23, 0
  s_and_b32 s38, s84, 262144
  s_mov_b32 s39, 0x20000
  v_lshlrev_b32 v3, 14, v1
  v_add_u32 v3, 3968, v3
  v_cmp_gt_u32 vcc, 13, v1
  v_mov_b32 v48, 1073741824
  s_nop 0
  v_cndmask_b32 v3, v48, v3, vcc
  v_mov_b32 v21, 0
  s_cmp_eq_u32 s80, 1
  s_cbranch_scc1 L_BA
  s_cmp_eq_u32 s64, 0
  s_cselect_b32 s79, s84, 0
  s_lshl_b32 s76, s67, 3
  s_mul_hi_u32 s77, s76, 0x33333334
  s_add_u32 s76, s76, 7
  s_mul_hi_u32 s78, s76, 0x33333334
  s_add_u32 s78, s78, 1
  s_lshl_b32 s82, 1, s78
  s_lshl_b32 s78, 1, s77
  s_sub_u32 s82, s82, s78
  s_and_b32 s82, s82, s79
  s_mov_b32 s83, 0
  s_lshr_b32 s76, s66, 2
  s_lshl_b32 s76, s76, 6
  s_add_u32 s73, s76, 6656
  s_cmp_eq_u32 s64, 0
  s_cselect_b32 s73, s73, 1073741824
  s_mul_i32 s76, s66, 81920
  s_add_u32 s76, s76, 12783616
  s_add_u32 s56, s22, s76
  s_addc_u32 s57, s23, 0
  s_and_b32 s58, s84, 81920
  s_mov_b32 s59, 0x20000
  v_mov_b32 v102, 1
  v_cmp_eq_u32 vcc, 0, v1
  v_mov_b32 v103, 1073741824
  s_nop 0
  v_cndmask_b32 v103, v103, 0, vcc
  s_cmp_eq_u32 s64, 0
  s_cselect_b32 s81, s81, 1073741824
  s_cmp_lg_u32 s80, 0
  s_cbranch_scc1 L_B2
  s_add_u32 s76, s64, 0
  s_and_b32 s76, s76, 3
  s_mul_i32 s77, s76, 55296
  s_mul_i32 s78, s76, 20480
  v_add_u32 v6, s77, v2
  v_add_u32 v10, s78, v2
  s_add_u32 s76, s64, 1
  s_and_b32 s76, s76, 3
  s_mul_i32 s77, s76, 55296
  s_mul_i32 s78, s76, 20480
  v_add_u32 v7, s77, v2
  v_add_u32 v11, s78, v2
  s_lshl_b32 s76, s76, 10
  v_add_u32 v17, s76, v2
  s_add_u32 s76, s64, 2
  s_and_b32 s76, s76, 3
  s_mul_i32 s77, s76, 55296
  s_mul_i32 s78, s76, 20480
  v_add_u32 v8, s77, v2
  v_add_u32 v12, s78, v2
  s_lshl_b32 s76, s76, 10
  v_add_u32 v18, s76, v2
  s_add_u32 s76, s64, 3
  s_and_b32 s76, s76, 3
  s_mul_i32 s77, s76, 55296
  s_mul_i32 s78, s76, 20480
  v_add_u32 v9, s77, v2
  v_add_u32 v13, s78, v2
  s_lshl_b32 s76, s76, 10
  v_add_u32 v19, s76, v2
  s_mul_i32 s76, s65, 221184
  s_add_u32 s76, s76, 53248
  s_add_u32 s24, s22, s76
  s_addc_u32 s25, s23, 0
  s_and_b32 s26, s84, 221184
  s_mov_b32 s27, 0x20000
  s_waitcnt lgkmcnt(0)
  s_add_u32 s40, s6, 0
  s_addc_u32 s41, s7, 0
  s_and_b32 s42, s84, 2621440
  s_mov_b32 s43, 0x20000
  s_movk_i32 s76, 252
  v_cmp_gt_u32 s[6:7], s76, v0
  v_mul_u32_u24 v148, 5462, v0
  v_lshrrev_b32 v148, 16, v148
  v_mul_u32_u24 v149, 12, v148
  v_sub_u32 v149, v0, v149
  v_cmp_eq_u32 vcc, 9, v149
  v_cmp_eq_u32 s[18:19], 11, v149
  s_or_b64 vcc, vcc, s[18:19]
  v_cmp_le_u32 s[18:19], 21, v148
  s_or_b64 s[18:19], vcc, s[18:19]
  v_mul_u32_u24 v148, 96, v148
  v_lshl_add_u32 v100, v149, 3, v148
  v_and_b32 v148, 31, v1
  v_lshrrev_b32 v149, 3, v148
  v_lshlrev_b32 v149, 2, v149
  v_and_b32 v150, 3, v148
  v_add_u32 v149, v149, v150
  v_bfe_u32 v150, v148, 2, 1
  v_mul_u32_u24 v150, 10, v150
  v_add_u32 v150, v150, v149
  v_cmp_eq_u32 vcc, 10, v149
  s_nop 1
  v_cndmask_b32 v150, v150, 20, vcc
  v_cmp_lt_u32 vcc, 10, v149
  s_nop 1
  v_cndmask_b32 v150, v150, 21, vcc
  v_mul_u32_u24 v150, 96, v150
  v_lshrrev_b32 v151, 5, v1
  v_lshl_add_u32 v101, v151, 4, v150
  s_mul_i32 s76, s65, 81920
  s_add_u32 s76, s76, 7131136
  s_add_u32 s28, s22, s76
  s_addc_u32 s29, s23, 0
  s_and_b32 s30, s84, 81920
  s_mov_b32 s31, 0x20000
  s_add_u32 s52, s22, 7131136
  s_addc_u32 s53, s23, 0
  s_and_b32 s54, s84, 2621440
  s_mov_b32 s55, 0x20000
  s_add_u32 s32, s4, 0
  s_addc_u32 s33, s5, 0
  s_and_b32 s34, s84, 2621440
  s_mov_b32 s35, 0x20000
  v_and_b32 v144, 15, v1
  s_lshl_b32 s76, s64, 4
  v_add_u32 v144, s76, v144
  v_mul_u32_u24 v144, 1280, v144
  v_lshrrev_b32 v145, 4, v1
  v_lshl_add_u32 v14, v145, 3, v144
  v_lshl_add_u32 v15, v145, 4, v144
  s_mul_i32 s76, s64, 1024
  v_add_u32 v16, s76, v2
  s_mul_i32 s69, s65, 81920
  s_mul_i32 s76, s12, 160
  s_add_u32 s69, s69, s76
  v_and_b32 v144, 15, v1
  v_lshlrev_b32 v144, 4, v144
  v_bfe_u32 v145, v1, 4, 1
  v_mul_u32_u24 v145, 20480, v145
  v_add_u32 v144, v144, v145
  v_lshrrev_b32 v145, 5, v1
  v_lshl_add_u32 v20, v145, 8, v144
  v_lshl_add_u32 v21, v145, 2, v144
  s_lshr_b32 s76, s66, 1
  s_mul_i32 s76, s76, 5
  s_and_b32 s77, s66, 1
  s_lshl_b32 s78, s77, 1
  s_add_u32 s70, s76, s78
  s_lshl_b32 s70, s70, 8
  s_add_u32 s71, s76, 4
  s_lshl_b32 s71, s71, 8
  s_lshl_b32 s77, s77, 3
  s_add_u32 s71, s71, s77
  s_mul_i32 s76, s68, 40960
  s_add_u32 s70, s70, s76
  s_add_u32 s71, s71, s76
  s_mov_b32 s74, 0x358637bd
  s_mul_i32 s76, s64, 5120
  s_add_u32 s76, s76, 49152
  v_add_u32 v22, s76, v2
  v_add_u32 v23, 61440, v22
  s_waitcnt vmcnt(0)
  s_cbranch_execz L_nb4
  s_barrier
L_nb4:
  buffer_load_dword v48, v5, s[48:51], s73 offen sc1
  buffer_store_dword v102, v103, s[44:47], s81 offen sc1
  s_add_u32 m0, s13, 49152
  s_add_u32 s20, s14, 204800
  s_cmp_ge_u32 s20, 266240
  s_cselect_b32 s21, 266240, 0
  s_sub_u32 s20, s20, s21
  s_add_u32 s20, s20, s13
  buffer_load_dwordx4 v2, s[60:63], s20 offen offset:0 sc1 lds
  buffer_load_dwordx4 v2, s[60:63], s20 offen offset:1024 sc1 lds
  buffer_load_dwordx4 v2, s[60:63], s20 offen offset:2048 sc1 lds
  buffer_load_dwordx4 v2, s[60:63], s20 offen offset:3072 sc1 lds
  s_add_u32 m0, s13, 53248
  s_add_u32 s20, s20, 4096
  buffer_load_dwordx4 v2, s[60:63], s20 offen sc1 lds
  s_add_u32 m0, s13, 69632
  s_add_u32 s20, s14, 225280
  s_cmp_ge_u32 s20, 266240
  s_cselect_b32 s21, 266240, 0
  s_sub_u32 s20, s20, s21
  s_add_u32 s20, s20, s13
  buffer_load_dwordx4 v2, s[60:63], s20 offen offset:0 sc1 lds
  buffer_load_dwordx4 v2, s[60:63], s20 offen offset:1024 sc1 lds
  buffer_load_dwordx4 v2, s[60:63], s20 offen offset:2048 sc1 lds
  buffer_load_dwordx4 v2, s[60:63], s20 offen offset:3072 sc1 lds
  s_add_u32 m0, s13, 73728
  s_add_u32 s20, s20, 4096
  buffer_load_dwordx4 v2, s[60:63], s20 offen sc1 lds
  s_add_u32 m0, s13, 90112
  s_add_u32 s20, s14, 245760
  s_cmp_ge_u32 s20, 266240
  s_cselect_b32 s21, 266240, 0
  s_sub_u32 s20, s20, s21
  s_add_u32 s20, s20, s13
  buffer_load_dwordx4 v2, s[60:63], s20 offen offset:0 sc1 lds
  buffer_load_dwordx4 v2, s[60:63], s20 offen offset:1024 sc1 lds
  s_waitcnt vmcnt(13)
  v_cmp_ne_u32 vcc, 1, v48
  s_and_b64 vcc, vcc, s[82:83]
  s_cbranch_vccnz L_BLF_spin
L_BLF_go:
  s_cbranch_execz L_nb5
  s_barrier
L_nb5:
  s_mul_i32 s76, s68, 1280
  buffer_load_dwordx4 v[160:163], v2, s[56:59], s76 offen offset:0 sc1
  buffer_load_dword v164, v5, s[56:59], s76 offen offset:1024 sc1
  buffer_load_dwordx4 v[166:169], v2, s[56:59], s76 offen offset:1280 sc1
  buffer_load_dword v170, v5, s[56:59], s76 offen offset:2304 sc1
  buffer_load_dwordx4 v2, s[60:63], s20 offen offset:2048 sc1 lds
  buffer_load_dwordx4 v2, s[60:63], s20 offen offset:3072 sc1 lds
  s_add_u32 m0, s13, 94208
  s_add_u32 s20, s20, 4096
  buffer_load_dwordx4 v2, s[60:63], s20 offen sc1 lds
  s_add_u32 m0, s13, 110592
  s_add_u32 s20, s13, 266240
  s_cmp_ge_u32 s64, 2
  s_cselect_b32 s20, 1073741824, s20
  buffer_load_dwordx4 v2, s[60:63], s20 offen offset:0 sc1 lds
  buffer_load_dwordx4 v2, s[60:63], s20 offen offset:1024 sc1 lds
  buffer_load_dwordx4 v2, s[60:63], s20 offen offset:2048 sc1 lds
  buffer_load_dwordx4 v2, s[60:63], s20 offen offset:3072 sc1 lds
  s_add_u32 m0, s13, 114688
  s_add_u32 s20, s20, 4096
  buffer_load_dwordx4 v2, s[60:63], s20 offen sc1 lds
  s_add_u32 m0, s13, 131072
  s_add_u32 s20, s13, 276480
  buffer_load_dwordx4 v2, s[60:63], s20 offen offset:0 sc1 lds
  buffer_load_dwordx4 v2, s[60:63], s20 offen offset:1024 sc1 lds
  buffer_load_dwordx4 v2, s[60:63], s20 offen offset:2048 sc1 lds
  buffer_load_dwordx4 v2, s[60:63], s20 offen offset:3072 sc1 lds
  s_waitcnt vmcnt(15)
  v_and_b32 v53, 0xffff0000, v160
  v_lshlrev_b32 v52, 16, v160
  v_and_b32 v55, 0xffff0000, v161
  v_lshlrev_b32 v54, 16, v161
  v_and_b32 v57, 0xffff0000, v162
  v_lshlrev_b32 v56, 16, v162
  v_and_b32 v59, 0xffff0000, v163
  v_lshlrev_b32 v58, 16, v163
  s_waitcnt vmcnt(14)
  v_and_b32 v61, 0xffff0000, v164
  v_lshlrev_b32 v60, 16, v164
  s_waitcnt vmcnt(13)
  v_and_b32 v65, 0xffff0000, v166
  v_lshlrev_b32 v64, 16, v166
  v_and_b32 v67, 0xffff0000, v167
  v_lshlrev_b32 v66, 16, v167
  v_and_b32 v69, 0xffff0000, v168
  v_lshlrev_b32 v68, 16, v168
  v_and_b32 v71, 0xffff0000, v169
  v_lshlrev_b32 v70, 16, v169
  s_waitcnt vmcnt(12)
  v_and_b32 v73, 0xffff0000, v170
  v_lshlrev_b32 v72, 16, v170
  buffer_load_dword v109, v3, s[36:39], s17 offen sc1
  v_max3_f32 v96, v52, v53, v54
  v_max3_f32 v97, -v52, -v53, -v54
  v_max3_f32 v104, v64, v65, v66
  v_max3_f32 v105, -v64, -v65, -v66
  v_max3_f32 v96, v96, v55, v56
  v_max3_f32 v97, v97, -v55, -v56
  v_max3_f32 v104, v104, v67, v68
  v_max3_f32 v105, v105, -v67, -v68
  v_max3_f32 v96, v96, v57, v58
  v_max3_f32 v97, v97, -v57, -v58
  v_max3_f32 v104, v104, v69, v70
  v_max3_f32 v105, v105, -v69, -v70
  v_max3_f32 v96, v96, v59, v60
  v_max3_f32 v97, v97, -v59, -v60
  v_max3_f32 v104, v104, v71, v72
  v_max3_f32 v105, v105, -v71, -v72
  v_max_f32 v96, v96, v61
  v_max_f32_e64 v97, v97, -v61
  v_max_f32 v104, v104, v73
  v_max_f32_e64 v105, v105, -v73
  v_permlane32_swap_b32 v96, v97
  s_nop 0
  v_permlane32_swap_b32 v104, v105
  v_max_f32 v96, v96, v97
  v_max_f32 v104, v104, v105
  v_mov_b32 v97, v96
  v_mov_b32 v105, v104
  v_mov_b32 v34, 0
  v_permlane32_swap_b32 v96, v97
  v_permlane32_swap_b32 v104, v105
  v_pk_add_f32 v[76:77], v[96:97], v[52:53] op_sel:[1,0] op_sel_hi:[1,1] neg_lo:[1,1] neg_hi:[1,1]
  v_pk_add_f32 v[78:79], v[96:97], v[54:55] op_sel:[1,0] op_sel_hi:[1,1] neg_lo:[1,1] neg_hi:[1,1]
  v_pk_add_f32 v[80:81], v[96:97], v[56:57] op_sel:[1,0] op_sel_hi:[1,1] neg_lo:[1,1] neg_hi:[1,1]
  v_pk_add_f32 v[82:83], v[96:97], v[58:59] op_sel:[1,0] op_sel_hi:[1,1] neg_lo:[1,1] neg_hi:[1,1]
  v_pk_add_f32 v[86:87], v[104:105], v[64:65] op_sel:[1,0] op_sel_hi:[1,1] neg_lo:[1,1] neg_hi:[1,1]
  v_pk_add_f32 v[88:89], v[104:105], v[66:67] op_sel:[1,0] op_sel_hi:[1,1] neg_lo:[1,1] neg_hi:[1,1]
  v_pk_add_f32 v[90:91], v[104:105], v[68:69] op_sel:[1,0] op_sel_hi:[1,1] neg_lo:[1,1] neg_hi:[1,1]
  v_pk_add_f32 v[92:93], v[104:105], v[70:71] op_sel:[1,0] op_sel_hi:[1,1] neg_lo:[1,1] neg_hi:[1,1]
  v_pk_add_f32 v[52:53], v[52:53], v[96:97] op_sel_hi:[1,0] neg_lo:[0,1] neg_hi:[0,1]
  v_pk_add_f32 v[54:55], v[54:55], v[96:97] op_sel_hi:[1,0] neg_lo:[0,1] neg_hi:[0,1]
  v_pk_add_f32 v[56:57], v[56:57], v[96:97] op_sel_hi:[1,0] neg_lo:[0,1] neg_hi:[0,1]
  v_pk_add_f32 v[58:59], v[58:59], v[96:97] op_sel_hi:[1,0] neg_lo:[0,1] neg_hi:[0,1]
  v_pk_add_f32 v[64:65], v[64:65], v[104:105] op_sel_hi:[1,0] neg_lo:[0,1] neg_hi:[0,1]
  v_pk_add_f32 v[66:67], v[66:67], v[104:105] op_sel_hi:[1,0] neg_lo:[0,1] neg_hi:[0,1]
  v_pk_add_f32 v[68:69], v[68:69], v[104:105] op_sel_hi:[1,0] neg_lo:[0,1] neg_hi:[0,1]
  v_pk_add_f32 v[70:71], v[70:71], v[104:105] op_sel_hi:[1,0] neg_lo:[0,1] neg_hi:[0,1]
  v_pk_add_f32 v[84:85], v[96:97], v[60:61] op_sel:[1,0] op_sel_hi:[1,1] neg_lo:[1,1] neg_hi:[1,1]
  v_exp_f32 v52, v52
  v_exp_f32 v53, v53
  v_exp_f32 v54, v54
  v_exp_f32 v55, v55
  v_exp_f32 v56, v56
  v_exp_f32 v57, v57
  v_exp_f32 v58, v58
  v_exp_f32 v59, v59
  v_pk_add_f32 v[94:95], v[104:105], v[72:73] op_sel:[1,0] op_sel_hi:[1,1] neg_lo:[1,1] neg_hi:[1,1]
  v_exp_f32 v64, v64
  v_exp_f32 v65, v65
  v_exp_f32 v66, v66
  v_exp_f32 v67, v67
  v_exp_f32 v68, v68
  v_exp_f32 v69, v69
  v_exp_f32 v70, v70
  v_exp_f32 v71, v71
  v_pk_add_f32 v[60:61], v[60:61], v[96:97] op_sel_hi:[1,0] neg_lo:[0,1] neg_hi:[0,1]
  buffer_load_dword v110, v3, s[36:39], s17 offen sc1
  v_pk_add_f32 v[72:73], v[72:73], v[104:105] op_sel_hi:[1,0] neg_lo:[0,1] neg_hi:[0,1]
  v_exp_f32 v60, v60
  v_exp_f32 v61, v61
  v_exp_f32 v72, v72
  v_exp_f32 v73, v73
  v_pk_add_f32 v[98:99], v[52:53], v[54:55]
  v_pk_add_f32 v[24:25], v[56:57], v[58:59]
  v_pk_add_f32 v[106:107], v[64:65], v[66:67]
  v_pk_add_f32 v[36:37], v[68:69], v[70:71]
  v_exp_f32 v76, v76
  v_exp_f32 v77, v77
  v_exp_f32 v78, v78
  v_exp_f32 v79, v79
  v_exp_f32 v80, v80
  v_exp_f32 v81, v81
  v_exp_f32 v82, v82
  v_exp_f32 v83, v83
  v_pk_add_f32 v[98:99], v[98:99], v[24:25]
  v_exp_f32 v86, v86
  v_exp_f32 v87, v87
  v_exp_f32 v88, v88
  v_exp_f32 v89, v89
  v_exp_f32 v90, v90
  v_exp_f32 v91, v91
  v_exp_f32 v92, v92
  v_exp_f32 v93, v93
  v_pk_add_f32 v[106:107], v[106:107], v[36:37]
  v_pk_add_f32 v[98:99], v[98:99], v[60:61]
  v_pk_add_f32 v[106:107], v[106:107], v[72:73]
  v_exp_f32 v84, v84
  v_exp_f32 v85, v85
  v_add_f32 v96, v98, v99
  v_exp_f32 v94, v94
  v_exp_f32 v95, v95
  v_add_f32 v104, v106, v107
  v_pk_add_f32 v[98:99], v[76:77], v[78:79]
  v_pk_add_f32 v[24:25], v[80:81], v[82:83]
  v_pk_add_f32 v[106:107], v[86:87], v[88:89]
  v_pk_add_f32 v[36:37], v[90:91], v[92:93]
  v_pk_add_f32 v[98:99], v[98:99], v[24:25]
  v_pk_add_f32 v[106:107], v[106:107], v[36:37]
  v_pk_add_f32 v[98:99], v[98:99], v[84:85]
  v_pk_add_f32 v[106:107], v[106:107], v[94:95]
  v_add_f32 v97, v98, v99
  v_add_f32 v105, v106, v107
  v_mov_b32 v35, 0
  v_permlane32_swap_b32 v96, v97
  v_permlane32_swap_b32 v104, v105
  v_add_f32 v96, v96, v97
  v_add_f32 v104, v104, v105
  v_rcp_f32 v96, v96
  v_rcp_f32 v104, v104
  v_mov_b32 v97, v96
  v_mov_b32 v105, v104
  v_mov_b32 v46, 0
  v_permlane32_swap_b32 v96, v97
  v_permlane32_swap_b32 v104, v105
  v_pk_mul_f32 v[52:53], v[52:53], v[96:97] op_sel_hi:[1,0]
  v_pk_mul_f32 v[76:77], v[76:77], v[96:97] op_sel:[0,1] op_sel_hi:[1,1]
  v_pk_mul_f32 v[54:55], v[54:55], v[96:97] op_sel_hi:[1,0]
  v_pk_mul_f32 v[78:79], v[78:79], v[96:97] op_sel:[0,1] op_sel_hi:[1,1]
  v_pk_mul_f32 v[56:57], v[56:57], v[96:97] op_sel_hi:[1,0]
  v_pk_mul_f32 v[80:81], v[80:81], v[96:97] op_sel:[0,1] op_sel_hi:[1,1]
  v_pk_mul_f32 v[58:59], v[58:59], v[96:97] op_sel_hi:[1,0]
  v_pk_mul_f32 v[82:83], v[82:83], v[96:97] op_sel:[0,1] op_sel_hi:[1,1]
  s_add_u32 m0, s13, 135168
  s_add_u32 s20, s20, 4096
  buffer_load_dwordx4 v2, s[60:63], s20 offen sc1 lds
  buffer_load_dword v111, v3, s[36:39], s17 offen sc1
  buffer_load_dword v108, v5, s[48:51], s16 offen sc1
  v_pk_mul_f32 v[60:61], v[60:61], v[96:97] op_sel_hi:[1,0]
  v_pk_mul_f32 v[84:85], v[84:85], v[96:97] op_sel:[0,1] op_sel_hi:[1,1]
  v_pk_mul_f32 v[64:65], v[64:65], v[104:105] op_sel_hi:[1,0]
  v_pk_mul_f32 v[86:87], v[86:87], v[104:105] op_sel:[0,1] op_sel_hi:[1,1]
  v_pk_mul_f32 v[66:67], v[66:67], v[104:105] op_sel_hi:[1,0]
  v_pk_mul_f32 v[88:89], v[88:89], v[104:105] op_sel:[0,1] op_sel_hi:[1,1]
  v_pk_mul_f32 v[68:69], v[68:69], v[104:105] op_sel_hi:[1,0]
  v_pk_mul_f32 v[90:91], v[90:91], v[104:105] op_sel:[0,1] op_sel_hi:[1,1]
  v_pk_mul_f32 v[70:71], v[70:71], v[104:105] op_sel_hi:[1,0]
  v_pk_mul_f32 v[92:93], v[92:93], v[104:105] op_sel:[0,1] op_sel_hi:[1,1]
  v_pk_mul_f32 v[72:73], v[72:73], v[104:105] op_sel_hi:[1,0]
  v_pk_mul_f32 v[94:95], v[94:95], v[104:105] op_sel:[0,1] op_sel_hi:[1,1]
  v_cvt_pk_bf16_f32 v24, v52, v53
  v_cvt_pk_bf16_f32 v25, v54, v55
  v_cvt_pk_bf16_f32 v26, v56, v57
  v_cvt_pk_bf16_f32 v27, v58, v59
  v_cvt_pk_bf16_f32 v28, v60, v61
  v_cvt_pk_bf16_f32 v29, v76, v77
  v_cvt_pk_bf16_f32 v30, v78, v79
  v_cvt_pk_bf16_f32 v31, v80, v81
  v_cvt_pk_bf16_f32 v32, v82, v83
  v_cvt_pk_bf16_f32 v33, v84, v85
  v_cvt_pk_bf16_f32 v36, v64, v65
  v_cvt_pk_bf16_f32 v37, v66, v67
  v_cvt_pk_bf16_f32 v38, v68, v69
  v_cvt_pk_bf16_f32 v39, v70, v71
  v_cvt_pk_bf16_f32 v40, v72, v73
  v_cvt_pk_bf16_f32 v41, v86, v87
  v_cvt_pk_bf16_f32 v42, v88, v89
  v_cvt_pk_bf16_f32 v43, v90, v91
  v_cvt_pk_bf16_f32 v44, v92, v93
  v_cvt_pk_bf16_f32 v45, v94, v95
  v_mov_b32 v47, 0
  s_branch L_Bsm
L_B2:
  s_add_u32 s76, s64, 0
  s_and_b32 s76, s76, 3
  s_mul_i32 s77, s76, 55296
  s_mul_i32 s78, s76, 20480
  v_add_u32 v6, s77, v2
  v_add_u32 v10, s78, v2
  s_add_u32 s76, s64, 1
  s_and_b32 s76, s76, 3
  s_mul_i32 s77, s76, 55296
  s_mul_i32 s78, s76, 20480
  v_add_u32 v7, s77, v2
  v_add_u32 v11, s78, v2
  s_lshl_b32 s76, s76, 10
  v_add_u32 v17, s76, v2
  s_add_u32 s76, s64, 2
  s_and_b32 s76, s76, 3
  s_mul_i32 s77, s76, 55296
  s_mul_i32 s78, s76, 20480
  v_add_u32 v8, s77, v2
  v_add_u32 v12, s78, v2
  s_lshl_b32 s76, s76, 10
  v_add_u32 v18, s76, v2
  s_add_u32 s76, s64, 3
  s_and_b32 s76, s76, 3
  s_mul_i32 s77, s76, 55296
  s_mul_i32 s78, s76, 20480
  v_add_u32 v9, s77, v2
  v_add_u32 v13, s78, v2
  s_lshl_b32 s76, s76, 10
  v_add_u32 v19, s76, v2
  s_mul_i32 s76, s65, 221184
  s_add_u32 s76, s76, 53248
  s_add_u32 s24, s22, s76
  s_addc_u32 s25, s23, 0
  s_and_b32 s26, s84, 221184
  s_mov_b32 s27, 0x20000
  s_waitcnt lgkmcnt(0)
  s_add_u32 s40, s6, 0
  s_addc_u32 s41, s7, 0
  s_and_b32 s42, s84, 2621440
  s_mov_b32 s43, 0x20000
  s_movk_i32 s76, 252
  v_cmp_gt_u32 s[6:7], s76, v0
  v_mul_u32_u24 v148, 5462, v0
  v_lshrrev_b32 v148, 16, v148
  v_mul_u32_u24 v149, 12, v148
  v_sub_u32 v149, v0, v149
  v_cmp_eq_u32 vcc, 9, v149
  v_cmp_eq_u32 s[18:19], 11, v149
  s_or_b64 vcc, vcc, s[18:19]
  v_cmp_le_u32 s[18:19], 21, v148
  s_or_b64 s[18:19], vcc, s[18:19]
  v_mul_u32_u24 v148, 96, v148
  v_lshl_add_u32 v100, v149, 3, v148
  v_and_b32 v148, 31, v1
  v_lshrrev_b32 v149, 3, v148
  v_lshlrev_b32 v149, 2, v149
  v_and_b32 v150, 3, v148
  v_add_u32 v149, v149, v150
  v_bfe_u32 v150, v148, 2, 1
  v_mul_u32_u24 v150, 10, v150
  v_add_u32 v150, v150, v149
  v_cmp_eq_u32 vcc, 10, v149
  s_nop 1
  v_cndmask_b32 v150, v150, 20, vcc
  v_cmp_lt_u32 vcc, 10, v149
  s_nop 1
  v_cndmask_b32 v150, v150, 21, vcc
  v_mul_u32_u24 v150, 96, v150
  v_lshrrev_b32 v151, 5, v1
  v_lshl_add_u32 v101, v151, 4, v150
  s_mul_i32 s76, s65, 81920
  s_add_u32 s76, s76, 7131136
  s_add_u32 s28, s22, s76
  s_addc_u32 s29, s23, 0
  s_and_b32 s30, s84, 81920
  s_mov_b32 s31, 0x20000
  s_add_u32 s52, s22, 7131136
  s_addc_u32 s53, s23, 0
  s_and_b32 s54, s84, 2621440
  s_mov_b32 s55, 0x20000
  s_add_u32 s32, s4, 0
  s_addc_u32 s33, s5, 0
  s_and_b32 s34, s84, 2621440
  s_mov_b32 s35, 0x20000
  v_and_b32 v144, 15, v1
  s_lshl_b32 s76, s64, 4
  v_add_u32 v144, s76, v144
  v_mul_u32_u24 v144, 1280, v144
  v_lshrrev_b32 v145, 4, v1
  v_lshl_add_u32 v14, v145, 3, v144
  v_lshl_add_u32 v15, v145, 4, v144
  s_mul_i32 s76, s64, 1024
  v_add_u32 v16, s76, v2
  s_mul_i32 s69, s65, 81920
  s_mul_i32 s76, s12, 160
  s_add_u32 s69, s69, s76
  v_and_b32 v144, 15, v1
  v_lshlrev_b32 v144, 4, v144
  v_bfe_u32 v145, v1, 4, 1
  v_mul_u32_u24 v145, 20480, v145
  v_add_u32 v144, v144, v145
  v_lshrrev_b32 v145, 5, v1
  v_lshl_add_u32 v20, v145, 8, v144
  v_lshl_add_u32 v21, v145, 2, v144
  s_lshr_b32 s76, s66, 1
  s_mul_i32 s76, s76, 5
  s_and_b32 s77, s66, 1
  s_lshl_b32 s78, s77, 1
  s_add_u32 s70, s76, s78
  s_lshl_b32 s70, s70, 8
  s_add_u32 s71, s76, 4
  s_lshl_b32 s71, s71, 8
  s_lshl_b32 s77, s77, 3
  s_add_u32 s71, s71, s77
  s_mul_i32 s76, s68, 40960
  s_add_u32 s70, s70, s76
  s_add_u32 s71, s71, s76
  s_mov_b32 s74, 0x358637bd
  s_mul_i32 s76, s64, 5120
  s_add_u32 s76, s76, 49152
  v_add_u32 v22, s76, v2
  v_add_u32 v23, 61440, v22
  buffer_load_dword v48, v5, s[48:51], s73 offen sc1
  s_waitcnt vmcnt(0)
  v_cmp_ne_u32 vcc, 1, v48
  s_and_b64 vcc, vcc, s[82:83]
  s_cbranch_vccnz L_BL_spin
L_BL_go:
  s_cbranch_execz L_nb6
  s_barrier
L_nb6:
  s_mul_i32 s76, s68, 1280
  buffer_load_dwordx4 v[160:163], v2, s[56:59], s76 offen offset:0 sc1
  buffer_load_dword v164, v5, s[56:59], s76 offen offset:1024 sc1
  buffer_load_dwordx4 v[166:169], v2, s[56:59], s76 offen offset:1280 sc1
  buffer_load_dword v170, v5, s[56:59], s76 offen offset:2304 sc1
  s_waitcnt vmcnt(3)
  v_and_b32 v53, 0xffff0000, v160
  v_lshlrev_b32 v52, 16, v160
  v_and_b32 v55, 0xffff0000, v161
  v_lshlrev_b32 v54, 16, v161
  v_and_b32 v57, 0xffff0000, v162
  v_lshlrev_b32 v56, 16, v162
  v_and_b32 v59, 0xffff0000, v163
  v_lshlrev_b32 v58, 16, v163
  s_waitcnt vmcnt(2)
  v_and_b32 v61, 0xffff0000, v164
  v_lshlrev_b32 v60, 16, v164
  s_waitcnt vmcnt(1)
  v_and_b32 v65, 0xffff0000, v166
  v_lshlrev_b32 v64, 16, v166
  v_and_b32 v67, 0xffff0000, v167
  v_lshlrev_b32 v66, 16, v167
  v_and_b32 v69, 0xffff0000, v168
  v_lshlrev_b32 v68, 16, v168
  v_and_b32 v71, 0xffff0000, v169
  v_lshlrev_b32 v70, 16, v169
  s_waitcnt vmcnt(0)
  v_and_b32 v73, 0xffff0000, v170
  v_lshlrev_b32 v72, 16, v170
  s_branch L_Bjoin
L_BA:
  s_add_u32 s20, s14, 184320
  s_cmp_ge_u32 s20, 266240
  s_cselect_b32 s21, 266240, 0
  s_sub_u32 s20, s20, s21
  s_add_u32 s20, s20, s13
  buffer_load_dwordx4 a[224:227], v2, s[60:63], s20 offen offset:0 sc1
  buffer_load_dwordx4 a[228:231], v2, s[60:63], s20 offen offset:1024 sc1
  buffer_load_dwordx4 a[232:235], v2, s[60:63], s20 offen offset:2048 sc1
  buffer_load_dwordx4 a[236:239], v2, s[60:63], s20 offen offset:3072 sc1
  s_add_u32 s20, s20, 4096
  buffer_load_dwordx4 a[240:243], v2, s[60:63], s20 offen sc1
  s_add_u32 m0, s13, 90112
  s_add_u32 s20, s14, 245760
  s_cmp_ge_u32 s20, 266240
  s_cselect_b32 s21, 266240, 0
  s_sub_u32 s20, s20, s21
  s_add_u32 s20, s20, s13
  buffer_load_dwordx4 v2, s[60:63], s20 offen offset:0 sc1 lds
  buffer_load_dwordx4 v2, s[60:63], s20 offen offset:1024 sc1 lds
  buffer_load_dwordx4 v2, s[60:63], s20 offen offset:2048 sc1 lds
  buffer_load_dwordx4 v2, s[60:63], s20 offen offset:3072 sc1 lds
  s_add_u32 m0, s13, 94208
  s_add_u32 s20, s20, 4096
  buffer_load_dwordx4 v2, s[60:63], s20 offen sc1 lds
  s_add_u32 m0, s13, 110592
  s_add_u32 s20, s13, 266240
  s_cmp_ge_u32 s64, 2
  s_cselect_b32 s20, 1073741824, s20
  buffer_load_dwordx4 v2, s[60:63], s20 offen offset:0 sc1 lds
  buffer_load_dwordx4 v2, s[60:63], s20 offen offset:1024 sc1 lds
  buffer_load_dwordx4 v2, s[60:63], s20 offen offset:2048 sc1 lds
  buffer_load_dwordx4 v2, s[60:63], s20 offen offset:3072 sc1 lds
  s_add_u32 m0, s13, 114688
  s_add_u32 s20, s20, 4096
  buffer_load_dwordx4 v2, s[60:63], s20 offen sc1 lds
  s_add_u32 m0, s13, 131072
  s_add_u32 s20, s13, 276480
  buffer_load_dwordx4 v2, s[60:63], s20 offen offset:0 sc1 lds
  buffer_load_dwordx4 v2, s[60:63], s20 offen offset:1024 sc1 lds
  buffer_load_dwordx4 v2, s[60:63], s20 offen offset:2048 sc1 lds
  buffer_load_dwordx4 v2, s[60:63], s20 offen offset:3072 sc1 lds
  s_add_u32 m0, s13, 135168
  s_add_u32 s20, s20, 4096
  buffer_load_dwordx4 v2, s[60:63], s20 offen sc1 lds
  s_waitcnt vmcnt(20)
  v_and_b32 v53, 0xffff0000, v160
  v_lshlrev_b32 v52, 16, v160
  v_and_b32 v55, 0xffff0000, v161
  v_lshlrev_b32 v54, 16, v161
  v_and_b32 v57, 0xffff0000, v162
  v_lshlrev_b32 v56, 16, v162
  v_and_b32 v59, 0xffff0000, v163
  v_lshlrev_b32 v58, 16, v163
  v_and_b32 v61, 0xffff0000, v164
  v_lshlrev_b32 v60, 16, v164
  v_and_b32 v65, 0xffff0000, v166
  v_lshlrev_b32 v64, 16, v166
  v_and_b32 v67, 0xffff0000, v167
  v_lshlrev_b32 v66, 16, v167
  v_and_b32 v69, 0xffff0000, v168
  v_lshlrev_b32 v68, 16, v168
  v_and_b32 v71, 0xffff0000, v169
  v_lshlrev_b32 v70, 16, v169
  v_and_b32 v73, 0xffff0000, v170
  v_lshlrev_b32 v72, 16, v170
L_Bjoin:
  buffer_load_dword v109, v3, s[36:39], s17 offen sc1
  v_max3_f32 v96, v52, v53, v54
  v_max3_f32 v97, -v52, -v53, -v54
  v_max3_f32 v104, v64, v65, v66
  v_max3_f32 v105, -v64, -v65, -v66
  v_max3_f32 v96, v96, v55, v56
  v_max3_f32 v97, v97, -v55, -v56
  v_max3_f32 v104, v104, v67, v68
  v_max3_f32 v105, v105, -v67, -v68
  v_max3_f32 v96, v96, v57, v58
  v_max3_f32 v97, v97, -v57, -v58
  v_max3_f32 v104, v104, v69, v70
  v_max3_f32 v105, v105, -v69, -v70
  v_max3_f32 v96, v96, v59, v60
  v_max3_f32 v97, v97, -v59, -v60
  v_max3_f32 v104, v104, v71, v72
  v_max3_f32 v105, v105, -v71, -v72
  v_max_f32 v96, v96, v61
  v_max_f32_e64 v97, v97, -v61
  v_max_f32 v104, v104, v73
  v_max_f32_e64 v105, v105, -v73
  v_permlane32_swap_b32 v96, v97
  s_nop 0
  v_permlane32_swap_b32 v104, v105
  v_max_f32 v96, v96, v97
  v_max_f32 v104, v104, v105
  v_mov_b32 v97, v96
  v_mov_b32 v105, v104
  v_mov_b32 v34, 0
  v_permlane32_swap_b32 v96, v97
  v_permlane32_swap_b32 v104, v105
  v_pk_add_f32 v[76:77], v[96:97], v[52:53] op_sel:[1,0] op_sel_hi:[1,1] neg_lo:[1,1] neg_hi:[1,1]
  v_pk_add_f32 v[78:79], v[96:97], v[54:55] op_sel:[1,0] op_sel_hi:[1,1] neg_lo:[1,1] neg_hi:[1,1]
  v_pk_add_f32 v[80:81], v[96:97], v[56:57] op_sel:[1,0] op_sel_hi:[1,1] neg_lo:[1,1] neg_hi:[1,1]
  v_pk_add_f32 v[82:83], v[96:97], v[58:59] op_sel:[1,0] op_sel_hi:[1,1] neg_lo:[1,1] neg_hi:[1,1]
  v_pk_add_f32 v[86:87], v[104:105], v[64:65] op_sel:[1,0] op_sel_hi:[1,1] neg_lo:[1,1] neg_hi:[1,1]
  v_pk_add_f32 v[88:89], v[104:105], v[66:67] op_sel:[1,0] op_sel_hi:[1,1] neg_lo:[1,1] neg_hi:[1,1]
  v_pk_add_f32 v[90:91], v[104:105], v[68:69] op_sel:[1,0] op_sel_hi:[1,1] neg_lo:[1,1] neg_hi:[1,1]
  v_pk_add_f32 v[92:93], v[104:105], v[70:71] op_sel:[1,0] op_sel_hi:[1,1] neg_lo:[1,1] neg_hi:[1,1]
  v_pk_add_f32 v[52:53], v[52:53], v[96:97] op_sel_hi:[1,0] neg_lo:[0,1] neg_hi:[0,1]
  v_pk_add_f32 v[54:55], v[54:55], v[96:97] op_sel_hi:[1,0] neg_lo:[0,1] neg_hi:[0,1]
  v_pk_add_f32 v[56:57], v[56:57], v[96:97] op_sel_hi:[1,0] neg_lo:[0,1] neg_hi:[0,1]
  v_pk_add_f32 v[58:59], v[58:59], v[96:97] op_sel_hi:[1,0] neg_lo:[0,1] neg_hi:[0,1]
  v_pk_add_f32 v[64:65], v[64:65], v[104:105] op_sel_hi:[1,0] neg_lo:[0,1] neg_hi:[0,1]
  v_pk_add_f32 v[66:67], v[66:67], v[104:105] op_sel_hi:[1,0] neg_lo:[0,1] neg_hi:[0,1]
  v_pk_add_f32 v[68:69], v[68:69], v[104:105] op_sel_hi:[1,0] neg_lo:[0,1] neg_hi:[0,1]
  v_pk_add_f32 v[70:71], v[70:71], v[104:105] op_sel_hi:[1,0] neg_lo:[0,1] neg_hi:[0,1]
  v_pk_add_f32 v[84:85], v[96:97], v[60:61] op_sel:[1,0] op_sel_hi:[1,1] neg_lo:[1,1] neg_hi:[1,1]
  v_exp_f32 v52, v52
  v_exp_f32 v53, v53
  v_exp_f32 v54, v54
  v_exp_f32 v55, v55
  v_exp_f32 v56, v56
  v_exp_f32 v57, v57
  v_exp_f32 v58, v58
  v_exp_f32 v59, v59
  v_pk_add_f32 v[94:95], v[104:105], v[72:73] op_sel:[1,0] op_sel_hi:[1,1] neg_lo:[1,1] neg_hi:[1,1]
  v_exp_f32 v64, v64
  v_exp_f32 v65, v65
  v_exp_f32 v66, v66
  v_exp_f32 v67, v67
  v_exp_f32 v68, v68
  v_exp_f32 v69, v69
  v_exp_f32 v70, v70
  v_exp_f32 v71, v71
  v_pk_add_f32 v[60:61], v[60:61], v[96:97] op_sel_hi:[1,0] neg_lo:[0,1] neg_hi:[0,1]
  buffer_load_dword v110, v3, s[36:39], s17 offen sc1
  v_pk_add_f32 v[72:73], v[72:73], v[104:105] op_sel_hi:[1,0] neg_lo:[0,1] neg_hi:[0,1]
  v_exp_f32 v60, v60
  v_exp_f32 v61, v61
  v_exp_f32 v72, v72
  v_exp_f32 v73, v73
  v_pk_add_f32 v[98:99], v[52:53], v[54:55]
  v_pk_add_f32 v[24:25], v[56:57], v[58:59]
  v_pk_add_f32 v[106:107], v[64:65], v[66:67]
  v_pk_add_f32 v[36:37], v[68:69], v[70:71]
  v_exp_f32 v76, v76
  v_exp_f32 v77, v77
  v_exp_f32 v78, v78
  v_exp_f32 v79, v79
  v_exp_f32 v80, v80
  v_exp_f32 v81, v81
  v_exp_f32 v82, v82
  v_exp_f32 v83, v83
  v_pk_add_f32 v[98:99], v[98:99], v[24:25]
  v_exp_f32 v86, v86
  v_exp_f32 v87, v87
  v_exp_f32 v88, v88
  v_exp_f32 v89, v89
  v_exp_f32 v90, v90
  v_exp_f32 v91, v91
  v_exp_f32 v92, v92
  v_exp_f32 v93, v93
  v_pk_add_f32 v[106:107], v[106:107], v[36:37]
  v_pk_add_f32 v[98:99], v[98:99], v[60:61]
  v_pk_add_f32 v[106:107], v[106:107], v[72:73]
  v_exp_f32 v84, v84
  v_exp_f32 v85, v85
  v_add_f32 v96, v98, v99
  v_exp_f32 v94, v94
  v_exp_f32 v95, v95
  v_add_f32 v104, v106, v107
  v_pk_add_f32 v[98:99], v[76:77], v[78:79]
  v_pk_add_f32 v[24:25], v[80:81], v[82:83]
  v_pk_add_f32 v[106:107], v[86:87], v[88:89]
  v_pk_add_f32 v[36:37], v[90:91], v[92:93]
  v_pk_add_f32 v[98:99], v[98:99], v[24:25]
  v_pk_add_f32 v[106:107], v[106:107], v[36:37]
  v_pk_add_f32 v[98:99], v[98:99], v[84:85]
  v_pk_add_f32 v[106:107], v[106:107], v[94:95]
  v_add_f32 v97, v98, v99
  v_add_f32 v105, v106, v107
  v_mov_b32 v35, 0
  v_permlane32_swap_b32 v96, v97
  v_permlane32_swap_b32 v104, v105
  v_add_f32 v96, v96, v97
  v_add_f32 v104, v104, v105
  v_rcp_f32 v96, v96
  v_rcp_f32 v104, v104
  v_mov_b32 v97, v96
  v_mov_b32 v105, v104
  v_mov_b32 v46, 0
  v_permlane32_swap_b32 v96, v97
  v_permlane32_swap_b32 v104, v105
  v_pk_mul_f32 v[52:53], v[52:53], v[96:97] op_sel_hi:[1,0]
  v_pk_mul_f32 v[76:77], v[76:77], v[96:97] op_sel:[0,1] op_sel_hi:[1,1]
  v_pk_mul_f32 v[54:55], v[54:55], v[96:97] op_sel_hi:[1,0]
  v_pk_mul_f32 v[78:79], v[78:79], v[96:97] op_sel:[0,1] op_sel_hi:[1,1]
  v_pk_mul_f32 v[56:57], v[56:57], v[96:97] op_sel_hi:[1,0]
  v_pk_mul_f32 v[80:81], v[80:81], v[96:97] op_sel:[0,1] op_sel_hi:[1,1]
  v_pk_mul_f32 v[58:59], v[58:59], v[96:97] op_sel_hi:[1,0]
  v_pk_mul_f32 v[82:83], v[82:83], v[96:97] op_sel:[0,1] op_sel_hi:[1,1]
  buffer_load_dword v111, v3, s[36:39], s17 offen sc1
  buffer_load_dword v108, v5, s[48:51], s16 offen sc1
  v_pk_mul_f32 v[60:61], v[60:61], v[96:97] op_sel_hi:[1,0]
  v_pk_mul_f32 v[84:85], v[84:85], v[96:97] op_sel:[0,1] op_sel_hi:[1,1]
  v_pk_mul_f32 v[64:65], v[64:65], v[104:105] op_sel_hi:[1,0]
  v_pk_mul_f32 v[86:87], v[86:87], v[104:105] op_sel:[0,1] op_sel_hi:[1,1]
  v_pk_mul_f32 v[66:67], v[66:67], v[104:105] op_sel_hi:[1,0]
  v_pk_mul_f32 v[88:89], v[88:89], v[104:105] op_sel:[0,1] op_sel_hi:[1,1]
  v_pk_mul_f32 v[68:69], v[68:69], v[104:105] op_sel_hi:[1,0]
  v_pk_mul_f32 v[90:91], v[90:91], v[104:105] op_sel:[0,1] op_sel_hi:[1,1]
  v_pk_mul_f32 v[70:71], v[70:71], v[104:105] op_sel_hi:[1,0]
  v_pk_mul_f32 v[92:93], v[92:93], v[104:105] op_sel:[0,1] op_sel_hi:[1,1]
  v_pk_mul_f32 v[72:73], v[72:73], v[104:105] op_sel_hi:[1,0]
  v_pk_mul_f32 v[94:95], v[94:95], v[104:105] op_sel:[0,1] op_sel_hi:[1,1]
  v_cvt_pk_bf16_f32 v24, v52, v53
  v_cvt_pk_bf16_f32 v25, v54, v55
  v_cvt_pk_bf16_f32 v26, v56, v57
  v_cvt_pk_bf16_f32 v27, v58, v59
  v_cvt_pk_bf16_f32 v28, v60, v61
  v_cvt_pk_bf16_f32 v29, v76, v77
  v_cvt_pk_bf16_f32 v30, v78, v79
  v_cvt_pk_bf16_f32 v31, v80, v81
  v_cvt_pk_bf16_f32 v32, v82, v83
  v_cvt_pk_bf16_f32 v33, v84, v85
  v_cvt_pk_bf16_f32 v36, v64, v65
  v_cvt_pk_bf16_f32 v37, v66, v67
  v_cvt_pk_bf16_f32 v38, v68, v69
  v_cvt_pk_bf16_f32 v39, v70, v71
  v_cvt_pk_bf16_f32 v40, v72, v73
  v_cvt_pk_bf16_f32 v41, v86, v87
  v_cvt_pk_bf16_f32 v42, v88, v89
  v_cvt_pk_bf16_f32 v43, v90, v91
  v_cvt_pk_bf16_f32 v44, v92, v93
  v_cvt_pk_bf16_f32 v45, v94, v95
  v_mov_b32 v47, 0
L_Bsm:
  s_waitcnt vmcnt(3)
  v_cmp_eq_u32 vcc, 0, v109
  s_and_b64 vcc, vcc, s[10:11]
  s_cbranch_vccz L_BK_go
  s_waitcnt vmcnt(2)
  v_cmp_eq_u32 vcc, 0, v110
  s_and_b64 vcc, vcc, s[10:11]
  s_cbranch_vccz L_BK_go
  s_waitcnt vmcnt(1)
  v_cmp_eq_u32 vcc, 0, v111
  s_and_b64 vcc, vcc, s[10:11]
  s_cbranch_vccnz L_BK_spin
L_BK_go:
  s_cbranch_execz L_nb7
  s_barrier
L_nb7:
  s_cmp_eq_u32 s80, 1
  s_cbranch_scc1 L_BkvA
  s_mov_b32 s75, 0
  buffer_load_dwordx4 v[48:51], v4, s[36:39], s75 offen sc1
  s_mov_b32 s75, 16384
  buffer_load_dwordx4 v[52:55], v4, s[36:39], s75 offen sc1
  s_mov_b32 s75, 32768
  buffer_load_dwordx4 v[56:59], v4, s[36:39], s75 offen sc1
  s_mov_b32 s75, 49152
  buffer_load_dwordx4 v[60:63], v4, s[36:39], s75 offen sc1
  s_mov_b32 s75, 65536
  buffer_load_dwordx4 v[64:67], v4, s[36:39], s75 offen sc1
  s_mov_b32 s75, 81920
  buffer_load_dwordx4 v[68:71], v4, s[36:39], s75 offen sc1
  s_mov_b32 s75, 98304
  buffer_load_dwordx4 v[72:75], v4, s[36:39], s75 offen sc1
  s_mov_b32 s75, 114688
  buffer_load_dwordx4 v[76:79], v4, s[36:39], s75 offen sc1
  s_mov_b32 s75, 131072
  buffer_load_dwordx4 v[80:83], v4, s[36:39], s75 offen sc1
  s_mov_b32 s75, 147456
  buffer_load_dwordx4 v[84:87], v4, s[36:39], s75 offen sc1
  s_mov_b32 s75, 163840
  buffer_load_dwordx4 v[88:91], v4, s[36:39], s75 offen sc1
  s_mov_b32 s75, 180224
  buffer_load_dwordx4 v[92:95], v4, s[36:39], s75 offen sc1
  s_mov_b32 s75, 196608
  buffer_load_dwordx4 v[96:99], v4, s[36:39], s75 offen sc1
  s_branch L_BkvJ
L_BkvA:
  s_mov_b32 s75, 0
  buffer_load_dwordx4 v[48:51], v4, s[36:39], s75 offen sc1
  s_add_u32 s76, s64, 0
  s_and_b32 s76, s76, 3
  s_mul_i32 s77, s76, 55296
  s_mul_i32 s78, s76, 20480
  v_add_u32 v6, s77, v2
  v_add_u32 v10, s78, v2
  s_add_u32 s76, s64, 1
  s_and_b32 s76, s76, 3
  s_mov_b32 s75, 16384
  buffer_load_dwordx4 v[52:55], v4, s[36:39], s75 offen sc1
  s_mul_i32 s77, s76, 55296
  s_mul_i32 s78, s76, 20480
  v_add_u32 v7, s77, v2
  v_add_u32 v11, s78, v2
  s_lshl_b32 s76, s76, 10
  v_add_u32 v17, s76, v2
  s_add_u32 s76, s64, 2
  s_and_b32 s76, s76, 3
  s_mov_b32 s75, 32768
  buffer_load_dwordx4 v[56:59], v4, s[36:39], s75 offen sc1
  s_mul_i32 s77, s76, 55296
  s_mul_i32 s78, s76, 20480
  v_add_u32 v8, s77, v2
  v_add_u32 v12, s78, v2
  s_lshl_b32 s76, s76, 10
  v_add_u32 v18, s76, v2
  s_add_u32 s76, s64, 3
  s_and_b32 s76, s76, 3
  s_mov_b32 s75, 49152
  buffer_load_dwordx4 v[60:63], v4, s[36:39], s75 offen sc1
  s_mul_i32 s77, s76, 55296
  s_mul_i32 s78, s76, 20480
  v_add_u32 v9, s77, v2
  v_add_u32 v13, s78, v2
  s_lshl_b32 s76, s76, 10
  v_add_u32 v19, s76, v2
  s_mul_i32 s76, s65, 221184
  s_add_u32 s76, s76, 53248
  s_mov_b32 s75, 65536
  buffer_load_dwordx4 v[64:67], v4, s[36:39], s75 offen sc1
  s_add_u32 s24, s22, s76
  s_addc_u32 s25, s23, 0
  s_and_b32 s26, s84, 221184
  s_mov_b32 s27, 0x20000
  s_waitcnt lgkmcnt(0)
  s_add_u32 s40, s6, 0
  s_addc_u32 s41, s7, 0
  s_and_b32 s42, s84, 2621440
  s_mov_b32 s75, 81920
  buffer_load_dwordx4 v[68:71], v4, s[36:39], s75 offen sc1
  s_mov_b32 s43, 0x20000
  s_movk_i32 s76, 252
  v_cmp_gt_u32 s[6:7], s76, v0
  v_mul_u32_u24 v148, 5462, v0
  v_lshrrev_b32 v148, 16, v148
  v_mul_u32_u24 v149, 12, v148
  v_sub_u32 v149, v0, v149
  v_cmp_eq_u32 vcc, 9, v149
  s_mov_b32 s75, 98304
  buffer_load_dwordx4 v[72:75], v4, s[36:39], s75 offen sc1
  v_cmp_eq_u32 s[18:19], 11, v149
  s_or_b64 vcc, vcc, s[18:19]
  v_cmp_le_u32 s[18:19], 21, v148
  s_or_b64 s[18:19], vcc, s[18:19]
  v_mul_u32_u24 v148, 96, v148
  v_lshl_add_u32 v100, v149, 3, v148
  v_and_b32 v148, 31, v1
  v_lshrrev_b32 v149, 3, v148
  s_mov_b32 s75, 114688
  buffer_load_dwordx4 v[76:79], v4, s[36:39], s75 offen sc1
  v_lshlrev_b32 v149, 2, v149
  v_and_b32 v150, 3, v148
  v_add_u32 v149, v149, v150
  v_bfe_u32 v150, v148, 2, 1
  v_mul_u32_u24 v150, 10, v150
  v_add_u32 v150, v150, v149
  v_cmp_eq_u32 vcc, 10, v149
  s_nop 1
  v_cndmask_b32 v150, v150, 20, vcc
  s_mov_b32 s75, 131072
  buffer_load_dwordx4 v[80:83], v4, s[36:39], s75 offen sc1
  v_cmp_lt_u32 vcc, 10, v149
  s_nop 1
  v_cndmask_b32 v150, v150, 21, vcc
  v_mul_u32_u24 v150, 96, v150
  v_lshrrev_b32 v151, 5, v1
  v_lshl_add_u32 v101, v151, 4, v150
  s_mul_i32 s76, s65, 81920
  s_add_u32 s76, s76, 7131136
  s_add_u32 s28, s22, s76
  s_mov_b32 s75, 147456
  buffer_load_dwordx4 v[84:87], v4, s[36:39], s75 offen sc1
  s_addc_u32 s29, s23, 0
  s_and_b32 s30, s84, 81920
  s_mov_b32 s31, 0x20000
  s_add_u32 s52, s22, 7131136
  s_addc_u32 s53, s23, 0
  s_and_b32 s54, s84, 2621440
  s_mov_b32 s55, 0x20000
  s_add_u32 s32, s4, 0
  s_mov_b32 s75, 163840
  buffer_load_dwordx4 v[88:91], v4, s[36:39], s75 offen sc1
  s_addc_u32 s33, s5, 0
  s_and_b32 s34, s84, 2621440
  s_mov_b32 s35, 0x20000
  v_and_b32 v144, 15, v1
  s_lshl_b32 s76, s64, 4
  v_add_u32 v144, s76, v144
  v_mul_u32_u24 v144, 1280, v144
  v_lshrrev_b32 v145, 4, v1
  s_mov_b32 s75, 180224
  buffer_load_dwordx4 v[92:95], v4, s[36:39], s75 offen sc1
  v_lshl_add_u32 v14, v145, 3, v144
  v_lshl_add_u32 v15, v145, 4, v144
  s_mul_i32 s76, s64, 1024
  v_add_u32 v16, s76, v2
  s_mul_i32 s69, s65, 81920
  s_mul_i32 s76, s12, 160
  s_add_u32 s69, s69, s76
  v_and_b32 v144, 15, v1
  s_mov_b32 s75, 196608
  buffer_load_dwordx4 v[96:99], v4, s[36:39], s75 offen sc1
  v_lshlrev_b32 v144, 4, v144
  v_bfe_u32 v145, v1, 4, 1
  v_mul_u32_u24 v145, 20480, v145
  v_add_u32 v144, v144, v145
  v_lshrrev_b32 v145, 5, v1
  v_lshl_add_u32 v20, v145, 8, v144
  v_lshl_add_u32 v21, v145, 2, v144
  s_lshr_b32 s76, s66, 1
  s_mul_i32 s76, s76, 5
  s_and_b32 s77, s66, 1
  s_lshl_b32 s78, s77, 1
  s_add_u32 s70, s76, s78
  s_lshl_b32 s70, s70, 8
  s_add_u32 s71, s76, 4
  s_lshl_b32 s71, s71, 8
  s_lshl_b32 s77, s77, 3
  s_add_u32 s71, s71, s77
  s_mul_i32 s76, s68, 40960
  s_add_u32 s70, s70, s76
  s_add_u32 s71, s71, s76
  s_mov_b32 s74, 0x358637bd
  s_mul_i32 s76, s64, 5120
  s_add_u32 s76, s76, 49152
  v_add_u32 v22, s76, v2
  v_add_u32 v23, 61440, v22
L_BkvJ:
  s_waitcnt vmcnt(13)
  v_cmp_ne_u32 vcc, 1, v108
  s_and_b64 vcc, vcc, s[8:9]
  s_cbranch_vccnz L_BH_spin
L_BH_go:
  s_cbranch_execz L_nb8
  s_barrier
L_nb8:
  s_add_u32 s75, s15, 0
  s_cmp_ge_u32 s75, 53248
  s_cselect_b32 s79, 53248, 0
  s_sub_u32 s75, s75, s79
  s_lshl_b32 s79, s64, 10
  s_add_u32 s75, s75, s79
  buffer_load_dwordx4 v[112:115], v6, s[24:27], s75 offen sc1
  buffer_load_dwordx4 v[116:119], v7, s[24:27], s75 offen sc1
  buffer_load_dwordx4 v[120:123], v8, s[24:27], s75 offen sc1
  buffer_load_dwordx4 v[124:127], v9, s[24:27], s75 offen sc1
  s_add_u32 s75, s15, 4096
  s_cmp_ge_u32 s75, 53248
  s_cselect_b32 s79, 53248, 0
  s_sub_u32 s75, s75, s79
  s_lshl_b32 s79, s64, 10
  s_add_u32 s75, s75, s79
  buffer_load_dwordx4 v[128:131], v6, s[24:27], s75 offen sc1
  buffer_load_dwordx4 v[132:135], v7, s[24:27], s75 offen sc1
  buffer_load_dwordx4 v[136:139], v8, s[24:27], s75 offen sc1
  buffer_load_dwordx4 v[140:143], v9, s[24:27], s75 offen sc1
  s_cbranch_execz L_dry_done
L_dry3:
  s_waitcnt vmcnt(20)
  v_min3_u32 v104, v48, v49, v50
  s_waitcnt vmcnt(19)
  v_min3_u32 v104, v104, v51, v52
  v_min3_u32 v104, v104, v53, v54
  s_waitcnt vmcnt(18)
  v_min3_u32 v104, v104, v55, v56
  v_min3_u32 v104, v104, v57, v58
  s_waitcnt vmcnt(17)
  v_min3_u32 v104, v104, v59, v60
  v_min3_u32 v104, v104, v61, v62
  s_waitcnt vmcnt(16)
  v_min3_u32 v104, v104, v63, v64
  v_min3_u32 v104, v104, v65, v66
  s_waitcnt vmcnt(15)
  v_min3_u32 v104, v104, v67, v68
  v_min3_u32 v104, v104, v69, v70
  s_waitcnt vmcnt(14)
  v_min3_u32 v104, v104, v71, v72
  v_min3_u32 v104, v104, v73, v74
  s_waitcnt vmcnt(13)
  v_min3_u32 v104, v104, v75, v76
  v_min3_u32 v104, v104, v77, v78
  s_waitcnt vmcnt(12)
  v_min3_u32 v104, v104, v79, v80
  v_min3_u32 v104, v104, v81, v82
  s_waitcnt vmcnt(11)
  v_min3_u32 v104, v104, v83, v84
  v_min3_u32 v104, v104, v85, v86
  s_waitcnt vmcnt(10)
  v_min3_u32 v104, v104, v87, v88
  v_min3_u32 v104, v104, v89, v90
  s_waitcnt vmcnt(9)
  v_min3_u32 v104, v104, v91, v92
  v_min3_u32 v104, v104, v93, v94
  s_waitcnt vmcnt(8)
  v_min3_u32 v104, v104, v95, v96
  v_min3_u32 v104, v104, v97, v98
  v_min_u32 v104, v104, v99
  v_cmp_eq_u32 vcc, 0, v104
  s_and_b64 vcc, vcc, s[6:7]
  s_cbranch_vccnz L_BV_retry
L_BV_ok:
  v_pk_add_f32 v[52:53], v[52:53], v[56:57]
  v_pk_add_f32 v[54:55], v[54:55], v[58:59]
  v_pk_add_f32 v[60:61], v[60:61], v[64:65]
  v_pk_add_f32 v[48:49], v[48:49], v[52:53]
  v_pk_add_f32 v[62:63], v[62:63], v[66:67]
  v_pk_add_f32 v[68:69], v[68:69], v[72:73]
  v_pk_add_f32 v[50:51], v[50:51], v[54:55]
  v_pk_add_f32 v[48:49], v[48:49], v[60:61]
  v_pk_add_f32 v[70:71], v[70:71], v[74:75]
  v_pk_add_f32 v[76:77], v[76:77], v[80:81]
  v_pk_add_f32 v[50:51], v[50:51], v[62:63]
  v_pk_add_f32 v[48:49], v[48:49], v[68:69]
  v_pk_add_f32 v[78:79], v[78:79], v[82:83]
  v_pk_add_f32 v[84:85], v[84:85], v[88:89]
  v_pk_add_f32 v[50:51], v[50:51], v[70:71]
  v_pk_add_f32 v[48:49], v[48:49], v[76:77]
  v_pk_add_f32 v[86:87], v[86:87], v[90:91]
  v_pk_add_f32 v[92:93], v[92:93], v[96:97]
  v_pk_add_f32 v[50:51], v[50:51], v[78:79]
  v_pk_add_f32 v[48:49], v[48:49], v[84:85]
  v_pk_add_f32 v[94:95], v[94:95], v[98:99]
  v_pk_add_f32 v[50:51], v[50:51], v[86:87]
  v_pk_add_f32 v[48:49], v[48:49], v[92:93]
  v_pk_add_f32 v[50:51], v[50:51], v[94:95]
  v_cndmask_b32 v48, v48, 0, s[18:19]
  v_cndmask_b32 v49, v49, 0, s[18:19]
  v_cndmask_b32 v50, v50, 0, s[18:19]
  v_cndmask_b32 v51, v51, 0, s[18:19]
  v_cvt_pk_bf16_f32 v48, v48, v49
  v_cvt_pk_bf16_f32 v49, v50, v51
  ds_write_b64 v100, v[48:49]
  v_mov_b32 v54, 0
  v_mov_b32 v55, 0
  v_and_b32 v53, 7, v1
  v_lshlrev_b32 v53, 3, v53
  v_add_u32 v53, 2048, v53
  ds_write_b64 v53, v[54:55]
  s_waitcnt lgkmcnt(0)
  s_cbranch_execz L_nb9
  s_barrier
L_nb9:
  ds_read_b128 v[56:59], v101 offset:0
  ds_read_b128 v[60:63], v101 offset:32
  ds_read_b128 v[64:67], v101 offset:64
  s_waitcnt lgkmcnt(0)
  s_cbranch_execz L_nb10
  s_barrier
L_nb10:
  v_mfma_f32_32x32x16_bf16 v[68:83], v[56:59], v[24:27], 0
  s_add_u32 s76, s70, 40960
  s_add_u32 s75, s15, 8192
  s_cmp_ge_u32 s75, 53248
  s_cselect_b32 s79, 53248, 0
  s_sub_u32 s75, s75, s79
  s_lshl_b32 s79, s64, 10
  s_add_u32 s75, s75, s79
  buffer_load_dwordx4 v[144:147], v6, s[24:27], s75 offen sc1
  s_add_u32 s77, s71, 40960
  v_mfma_f32_32x32x16_bf16 v[84:99], v[56:59], v[36:39], 0
  buffer_load_dwordx4 v[148:151], v7, s[24:27], s75 offen sc1
  v_mfma_f32_32x32x16_bf16 v[68:83], v[60:63], v[28:31], v[68:83]
  v_mfma_f32_32x32x16_bf16 v[84:99], v[60:63], v[40:43], v[84:99]
  buffer_load_dwordx4 v[152:155], v8, s[24:27], s75 offen sc1
  v_mfma_f32_32x32x16_bf16 v[68:83], v[64:67], v[32:35], v[68:83]
  v_mfma_f32_32x32x16_bf16 v[84:99], v[64:67], v[44:47], v[84:99]
  buffer_load_dwordx4 v[156:159], v9, s[24:27], s75 offen sc1
  s_nop 9
  v_add_f32 v48, s74, v78
  v_rcp_f32 v48, v48
  s_add_u32 s75, s15, 12288
  s_cmp_ge_u32 s75, 53248
  s_cselect_b32 s79, 53248, 0
  s_sub_u32 s75, s75, s79
  s_lshl_b32 s79, s64, 10
  s_add_u32 s75, s75, s79
  buffer_load_dwordx4 v[160:163], v6, s[24:27], s75 offen sc1
  v_pk_mul_f32 v[68:69], v[68:69], v[48:49] op_sel_hi:[1,0]
  v_pk_mul_f32 v[70:71], v[70:71], v[48:49] op_sel_hi:[1,0]
  buffer_load_dwordx4 v[164:167], v7, s[24:27], s75 offen sc1
  v_add_f32 v50, s74, v94
  v_rcp_f32 v50, v50
  buffer_load_dwordx4 v[168:171], v8, s[24:27], s75 offen sc1
  v_pk_mul_f32 v[72:73], v[72:73], v[48:49] op_sel_hi:[1,0]
  v_pk_mul_f32 v[74:75], v[74:75], v[48:49] op_sel_hi:[1,0]
  buffer_load_dwordx4 v[172:175], v9, s[24:27], s75 offen sc1
  v_pk_mul_f32 v[76:77], v[76:77], v[48:49] op_sel_hi:[1,0]
  v_pk_mul_f32 v[84:85], v[84:85], v[50:51] op_sel_hi:[1,0]
  s_add_u32 s75, s15, 16384
  s_cmp_ge_u32 s75, 53248
  s_cselect_b32 s79, 53248, 0
  s_sub_u32 s75, s75, s79
  s_lshl_b32 s79, s64, 10
  s_add_u32 s75, s75, s79
  buffer_load_dwordx4 a[180:183], v6, s[24:27], s75 offen sc1
  v_pk_mul_f32 v[86:87], v[86:87], v[50:51] op_sel_hi:[1,0]
  v_pk_mul_f32 v[88:89], v[88:89], v[50:51] op_sel_hi:[1,0]
  buffer_load_dwordx4 a[184:187], v7, s[24:27], s75 offen sc1
  v_pk_mul_f32 v[90:91], v[90:91], v[50:51] op_sel_hi:[1,0]
  v_pk_mul_f32 v[92:93], v[92:93], v[50:51] op_sel_hi:[1,0]
  buffer_load_dwordx4 a[188:191], v8, s[24:27], s75 offen sc1
  v_cvt_pk_bf16_f32 v24, v68, v69
  v_cvt_pk_bf16_f32 v25, v70, v71
  buffer_load_dwordx4 a[192:195], v9, s[24:27], s75 offen sc1
  v_cvt_pk_bf16_f32 v26, v72, v73
  v_cvt_pk_bf16_f32 v27, v74, v75
  s_add_u32 s75, s15, 20480
  s_cmp_ge_u32 s75, 53248
  s_cselect_b32 s79, 53248, 0
  s_sub_u32 s75, s75, s79
  s_lshl_b32 s79, s64, 10
  s_add_u32 s75, s75, s79
  buffer_load_dwordx4 a[196:199], v6, s[24:27], s75 offen sc1
  v_cvt_pk_bf16_f32 v28, v76, v77
  v_cvt_pk_bf16_f32 v36, v84, v85
  buffer_load_dwordx4 a[200:203], v7, s[24:27], s75 offen sc1
  v_cvt_pk_bf16_f32 v37, v86, v87
  v_cvt_pk_bf16_f32 v38, v88, v89
  buffer_load_dwordx4 a[204:207], v8, s[24:27], s75 offen sc1
  v_cvt_pk_bf16_f32 v39, v90, v91
  v_cvt_pk_bf16_f32 v40, v92, v93
  buffer_load_dwordx4 a[208:211], v9, s[24:27], s75 offen sc1
  v_max_u32 v24, 1, v24
  v_max_u32 v25, 1, v25
  v_max_u32 v26, 1, v26
  v_max_u32 v27, 1, v27
  v_max_u32 v28, 1, v28
  v_max_u32 v36, 1, v36
  v_max_u32 v37, 1, v37
  v_max_u32 v38, 1, v38
  v_max_u32 v39, 1, v39
  v_max_u32 v40, 1, v40
  buffer_store_dwordx4 v[24:27], v20, s[52:55], s70 offen sc1
  buffer_store_dword v28, v21, s[52:55], s71 offen sc1
  buffer_store_dwordx4 v[36:39], v20, s[52:55], s76 offen sc1
  buffer_store_dword v40, v21, s[52:55], s77 offen sc1
  s_waitcnt vmcnt(27)
  v_mfma_f32_16x16x32_bf16 v[176:179], a[0:3], v[112:115], 0
  s_waitcnt vmcnt(26)
  v_mfma_f32_16x16x32_bf16 v[180:183], a[0:3], v[116:119], 0
  s_waitcnt vmcnt(25)
  v_mfma_f32_16x16x32_bf16 v[184:187], a[0:3], v[120:123], 0
  s_waitcnt vmcnt(24)
  v_mfma_f32_16x16x32_bf16 v[188:191], a[0:3], v[124:127], 0
  v_mfma_f32_16x16x32_bf16 v[192:195], a[4:7], v[112:115], 0
  v_mfma_f32_16x16x32_bf16 v[196:199], a[4:7], v[116:119], 0
  v_mfma_f32_16x16x32_bf16 v[200:203], a[4:7], v[120:123], 0
  v_mfma_f32_16x16x32_bf16 v[204:207], a[4:7], v[124:127], 0
  v_mfma_f32_16x16x32_bf16 v[208:211], a[8:11], v[112:115], 0
  v_mfma_f32_16x16x32_bf16 v[212:215], a[8:11], v[116:119], 0
  v_mfma_f32_16x16x32_bf16 v[216:219], a[8:11], v[120:123], 0
  v_mfma_f32_16x16x32_bf16 v[220:223], a[8:11], v[124:127], 0
  v_mfma_f32_16x16x32_bf16 v[224:227], a[12:15], v[112:115], 0
  v_mfma_f32_16x16x32_bf16 v[228:231], a[12:15], v[116:119], 0
  v_mfma_f32_16x16x32_bf16 v[232:235], a[12:15], v[120:123], 0
  v_mfma_f32_16x16x32_bf16 v[236:239], a[12:15], v[124:127], 0
  v_mfma_f32_16x16x32_bf16 v[240:243], a[16:19], v[112:115], 0
  v_mfma_f32_16x16x32_bf16 v[244:247], a[16:19], v[116:119], 0
  v_mfma_f32_16x16x32_bf16 v[248:251], a[16:19], v[120:123], 0
  v_mfma_f32_16x16x32_bf16 v[252:255], a[16:19], v[124:127], 0
  s_waitcnt vmcnt(23)
  v_mfma_f32_16x16x32_bf16 v[176:179], a[20:23], v[128:131], v[176:179]
  s_waitcnt vmcnt(22)
  v_mfma_f32_16x16x32_bf16 v[180:183], a[20:23], v[132:135], v[180:183]
  s_waitcnt vmcnt(21)
  v_mfma_f32_16x16x32_bf16 v[184:187], a[20:23], v[136:139], v[184:187]
  s_waitcnt vmcnt(20)
  v_mfma_f32_16x16x32_bf16 v[188:191], a[20:23], v[140:143], v[188:191]
  v_mfma_f32_16x16x32_bf16 v[192:195], a[24:27], v[128:131], v[192:195]
  s_add_u32 s75, s15, 24576
  s_cmp_ge_u32 s75, 53248
  s_cselect_b32 s79, 53248, 0
  s_sub_u32 s75, s75, s79
  s_lshl_b32 s79, s64, 10
  s_add_u32 s75, s75, s79
  buffer_load_dwordx4 a[0:3], v6, s[24:27], s75 offen sc1
  v_mfma_f32_16x16x32_bf16 v[196:199], a[24:27], v[132:135], v[196:199]
  v_mfma_f32_16x16x32_bf16 v[200:203], a[24:27], v[136:139], v[200:203]
  v_mfma_f32_16x16x32_bf16 v[204:207], a[24:27], v[140:143], v[204:207]
  v_mfma_f32_16x16x32_bf16 v[208:211], a[28:31], v[128:131], v[208:211]
  v_mfma_f32_16x16x32_bf16 v[212:215], a[28:31], v[132:135], v[212:215]
  buffer_load_dwordx4 a[4:7], v7, s[24:27], s75 offen sc1
  v_mfma_f32_16x16x32_bf16 v[216:219], a[28:31], v[136:139], v[216:219]
  v_mfma_f32_16x16x32_bf16 v[220:223], a[28:31], v[140:143], v[220:223]
  v_mfma_f32_16x16x32_bf16 v[224:227], a[32:35], v[128:131], v[224:227]
  v_mfma_f32_16x16x32_bf16 v[228:231], a[32:35], v[132:135], v[228:231]
  v_mfma_f32_16x16x32_bf16 v[232:235], a[32:35], v[136:139], v[232:235]
  buffer_load_dwordx4 a[8:11], v8, s[24:27], s75 offen sc1
  v_mfma_f32_16x16x32_bf16 v[236:239], a[32:35], v[140:143], v[236:239]
  v_mfma_f32_16x16x32_bf16 v[240:243], a[36:39], v[128:131], v[240:243]
  v_mfma_f32_16x16x32_bf16 v[244:247], a[36:39], v[132:135], v[244:247]
  v_mfma_f32_16x16x32_bf16 v[248:251], a[36:39], v[136:139], v[248:251]
  v_mfma_f32_16x16x32_bf16 v[252:255], a[36:39], v[140:143], v[252:255]
  buffer_load_dwordx4 a[12:15], v9, s[24:27], s75 offen sc1
  s_waitcnt vmcnt(23)
  v_mfma_f32_16x16x32_bf16 v[176:179], a[40:43], v[144:147], v[176:179]
  s_waitcnt vmcnt(22)
  v_mfma_f32_16x16x32_bf16 v[180:183], a[40:43], v[148:151], v[180:183]
  s_waitcnt vmcnt(21)
  v_mfma_f32_16x16x32_bf16 v[184:187], a[40:43], v[152:155], v[184:187]
  s_waitcnt vmcnt(20)
  v_mfma_f32_16x16x32_bf16 v[188:191], a[40:43], v[156:159], v[188:191]
  v_mfma_f32_16x16x32_bf16 v[192:195], a[44:47], v[144:147], v[192:195]
  s_add_u32 s75, s15, 28672
  s_cmp_ge_u32 s75, 53248
  s_cselect_b32 s79, 53248, 0
  s_sub_u32 s75, s75, s79
  s_lshl_b32 s79, s64, 10
  s_add_u32 s75, s75, s79
  buffer_load_dwordx4 a[20:23], v6, s[24:27], s75 offen sc1
  v_mfma_f32_16x16x32_bf16 v[196:199], a[44:47], v[148:151], v[196:199]
  v_mfma_f32_16x16x32_bf16 v[200:203], a[44:47], v[152:155], v[200:203]
  v_mfma_f32_16x16x32_bf16 v[204:207], a[44:47], v[156:159], v[204:207]
  v_mfma_f32_16x16x32_bf16 v[208:211], a[48:51], v[144:147], v[208:211]
  v_mfma_f32_16x16x32_bf16 v[212:215], a[48:51], v[148:151], v[212:215]
  buffer_load_dwordx4 a[24:27], v7, s[24:27], s75 offen sc1
  v_mfma_f32_16x16x32_bf16 v[216:219], a[48:51], v[152:155], v[216:219]
  v_mfma_f32_16x16x32_bf16 v[220:223], a[48:51], v[156:159], v[220:223]
  v_mfma_f32_16x16x32_bf16 v[224:227], a[52:55], v[144:147], v[224:227]
  v_mfma_f32_16x16x32_bf16 v[228:231], a[52:55], v[148:151], v[228:231]
  v_mfma_f32_16x16x32_bf16 v[232:235], a[52:55], v[152:155], v[232:235]
  buffer_load_dwordx4 a[28:31], v8, s[24:27], s75 offen sc1
  v_mfma_f32_16x16x32_bf16 v[236:239], a[52:55], v[156:159], v[236:239]
  v_mfma_f32_16x16x32_bf16 v[240:243], a[56:59], v[144:147], v[240:243]
  v_mfma_f32_16x16x32_bf16 v[244:247], a[56:59], v[148:151], v[244:247]
  v_mfma_f32_16x16x32_bf16 v[248:251], a[56:59], v[152:155], v[248:251]
  v_mfma_f32_16x16x32_bf16 v[252:255], a[56:59], v[156:159], v[252:255]
  buffer_load_dwordx4 a[32:35], v9, s[24:27], s75 offen sc1
  s_waitcnt vmcnt(23)
  v_mfma_f32_16x16x32_bf16 v[176:179], a[60:63], v[160:163], v[176:179]
  s_waitcnt vmcnt(22)
  v_mfma_f32_16x16x32_bf16 v[180:183], a[60:63], v[164:167], v[180:183]
  s_waitcnt vmcnt(21)
  v_mfma_f32_16x16x32_bf16 v[184:187], a[60:63], v[168:171], v[184:187]
  s_waitcnt vmcnt(20)
  v_mfma_f32_16x16x32_bf16 v[188:191], a[60:63], v[172:175], v[188:191]
  v_mfma_f32_16x16x32_bf16 v[192:195], a[64:67], v[160:163], v[192:195]
  s_add_u32 s75, s15, 32768
  s_cmp_ge_u32 s75, 53248
  s_cselect_b32 s79, 53248, 0
  s_sub_u32 s75, s75, s79
  s_lshl_b32 s79, s64, 10
  s_add_u32 s75, s75, s79
  buffer_load_dwordx4 a[40:43], v6, s[24:27], s75 offen sc1
  v_mfma_f32_16x16x32_bf16 v[196:199], a[64:67], v[164:167], v[196:199]
  v_mfma_f32_16x16x32_bf16 v[200:203], a[64:67], v[168:171], v[200:203]
  v_mfma_f32_16x16x32_bf16 v[204:207], a[64:67], v[172:175], v[204:207]
  v_mfma_f32_16x16x32_bf16 v[208:211], a[68:71], v[160:163], v[208:211]
  v_mfma_f32_16x16x32_bf16 v[212:215], a[68:71], v[164:167], v[212:215]
  buffer_load_dwordx4 a[44:47], v7, s[24:27], s75 offen sc1
  v_mfma_f32_16x16x32_bf16 v[216:219], a[68:71], v[168:171], v[216:219]
  v_mfma_f32_16x16x32_bf16 v[220:223], a[68:71], v[172:175], v[220:223]
  v_mfma_f32_16x16x32_bf16 v[224:227], a[72:75], v[160:163], v[224:227]
  v_mfma_f32_16x16x32_bf16 v[228:231], a[72:75], v[164:167], v[228:231]
  v_mfma_f32_16x16x32_bf16 v[232:235], a[72:75], v[168:171], v[232:235]
  buffer_load_dwordx4 a[48:51], v8, s[24:27], s75 offen sc1
  v_mfma_f32_16x16x32_bf16 v[236:239], a[72:75], v[172:175], v[236:239]
  v_mfma_f32_16x16x32_bf16 v[240:243], a[76:79], v[160:163], v[240:243]
  v_mfma_f32_16x16x32_bf16 v[244:247], a[76:79], v[164:167], v[244:247]
  v_mfma_f32_16x16x32_bf16 v[248:251], a[76:79], v[168:171], v[248:251]
  v_mfma_f32_16x16x32_bf16 v[252:255], a[76:79], v[172:175], v[252:255]
  buffer_load_dwordx4 a[52:55], v9, s[24:27], s75 offen sc1
  s_waitcnt vmcnt(23)
  v_mfma_f32_16x16x32_bf16 v[176:179], a[80:83], a[180:183], v[176:179]
  s_waitcnt vmcnt(22)
  v_mfma_f32_16x16x32_bf16 v[180:183], a[80:83], a[184:187], v[180:183]
  s_waitcnt vmcnt(21)
  v_mfma_f32_16x16x32_bf16 v[184:187], a[80:83], a[188:191], v[184:187]
  s_waitcnt vmcnt(20)
  v_mfma_f32_16x16x32_bf16 v[188:191], a[80:83], a[192:195], v[188:191]
  v_mfma_f32_16x16x32_bf16 v[192:195], a[84:87], a[180:183], v[192:195]
  s_add_u32 s75, s15, 36864
  s_cmp_ge_u32 s75, 53248
  s_cselect_b32 s79, 53248, 0
  s_sub_u32 s75, s75, s79
  s_lshl_b32 s79, s64, 10
  s_add_u32 s75, s75, s79
  buffer_load_dwordx4 v[128:131], v6, s[24:27], s75 offen sc1
  v_mfma_f32_16x16x32_bf16 v[196:199], a[84:87], a[184:187], v[196:199]
  v_mfma_f32_16x16x32_bf16 v[200:203], a[84:87], a[188:191], v[200:203]
  v_mfma_f32_16x16x32_bf16 v[204:207], a[84:87], a[192:195], v[204:207]
  v_mfma_f32_16x16x32_bf16 v[208:211], a[88:91], a[180:183], v[208:211]
  v_mfma_f32_16x16x32_bf16 v[212:215], a[88:91], a[184:187], v[212:215]
  buffer_load_dwordx4 v[132:135], v7, s[24:27], s75 offen sc1
  v_mfma_f32_16x16x32_bf16 v[216:219], a[88:91], a[188:191], v[216:219]
  v_mfma_f32_16x16x32_bf16 v[220:223], a[88:91], a[192:195], v[220:223]
  v_mfma_f32_16x16x32_bf16 v[224:227], a[92:95], a[180:183], v[224:227]
  v_mfma_f32_16x16x32_bf16 v[228:231], a[92:95], a[184:187], v[228:231]
  v_mfma_f32_16x16x32_bf16 v[232:235], a[92:95], a[188:191], v[232:235]
  buffer_load_dwordx4 v[136:139], v8, s[24:27], s75 offen sc1
  v_mfma_f32_16x16x32_bf16 v[236:239], a[92:95], a[192:195], v[236:239]
  v_mfma_f32_16x16x32_bf16 v[240:243], a[96:99], a[180:183], v[240:243]
  v_mfma_f32_16x16x32_bf16 v[244:247], a[96:99], a[184:187], v[244:247]
  v_mfma_f32_16x16x32_bf16 v[248:251], a[96:99], a[188:191], v[248:251]
  v_mfma_f32_16x16x32_bf16 v[252:255], a[96:99], a[192:195], v[252:255]
  buffer_load_dwordx4 v[140:143], v9, s[24:27], s75 offen sc1
  s_waitcnt vmcnt(23)
  v_mfma_f32_16x16x32_bf16 v[176:179], a[100:103], a[196:199], v[176:179]
  s_waitcnt vmcnt(22)
  v_mfma_f32_16x16x32_bf16 v[180:183], a[100:103], a[200:203], v[180:183]
  s_waitcnt vmcnt(21)
  v_mfma_f32_16x16x32_bf16 v[184:187], a[100:103], a[204:207], v[184:187]
  s_waitcnt vmcnt(20)
  v_mfma_f32_16x16x32_bf16 v[188:191], a[100:103], a[208:211], v[188:191]
  v_mfma_f32_16x16x32_bf16 v[192:195], a[104:107], a[196:199], v[192:195]
  s_add_u32 s75, s15, 40960
  s_cmp_ge_u32 s75, 53248
  s_cselect_b32 s79, 53248, 0
  s_sub_u32 s75, s75, s79
  s_lshl_b32 s79, s64, 10
  s_add_u32 s75, s75, s79
  buffer_load_dwordx4 v[144:147], v6, s[24:27], s75 offen sc1
  v_mfma_f32_16x16x32_bf16 v[196:199], a[104:107], a[200:203], v[196:199]
  v_mfma_f32_16x16x32_bf16 v[200:203], a[104:107], a[204:207], v[200:203]
  v_mfma_f32_16x16x32_bf16 v[204:207], a[104:107], a[208:211], v[204:207]
  v_mfma_f32_16x16x32_bf16 v[208:211], a[108:111], a[196:199], v[208:211]
  v_mfma_f32_16x16x32_bf16 v[212:215], a[108:111], a[200:203], v[212:215]
  buffer_load_dwordx4 v[148:151], v7, s[24:27], s75 offen sc1
  v_mfma_f32_16x16x32_bf16 v[216:219], a[108:111], a[204:207], v[216:219]
  v_mfma_f32_16x16x32_bf16 v[220:223], a[108:111], a[208:211], v[220:223]
  v_mfma_f32_16x16x32_bf16 v[224:227], a[112:115], a[196:199], v[224:227]
  v_mfma_f32_16x16x32_bf16 v[228:231], a[112:115], a[200:203], v[228:231]
  v_mfma_f32_16x16x32_bf16 v[232:235], a[112:115], a[204:207], v[232:235]
  buffer_load_dwordx4 v[152:155], v8, s[24:27], s75 offen sc1
  v_mfma_f32_16x16x32_bf16 v[236:239], a[112:115], a[208:211], v[236:239]
  v_mfma_f32_16x16x32_bf16 v[240:243], a[116:119], a[196:199], v[240:243]
  v_mfma_f32_16x16x32_bf16 v[244:247], a[116:119], a[200:203], v[244:247]
  v_mfma_f32_16x16x32_bf16 v[248:251], a[116:119], a[204:207], v[248:251]
  v_mfma_f32_16x16x32_bf16 v[252:255], a[116:119], a[208:211], v[252:255]
  buffer_load_dwordx4 v[156:159], v9, s[24:27], s75 offen sc1
  s_waitcnt vmcnt(19)
  v_mfma_f32_16x16x32_bf16 v[176:179], a[120:123], a[0:3], v[176:179]
  s_waitcnt vmcnt(18)
  v_mfma_f32_16x16x32_bf16 v[180:183], a[120:123], a[4:7], v[180:183]
  s_waitcnt vmcnt(17)
  v_mfma_f32_16x16x32_bf16 v[184:187], a[120:123], a[8:11], v[184:187]
  s_waitcnt vmcnt(16)
  v_mfma_f32_16x16x32_bf16 v[188:191], a[120:123], a[12:15], v[188:191]
  v_mfma_f32_16x16x32_bf16 v[192:195], a[124:127], a[0:3], v[192:195]
  s_add_u32 s75, s15, 45056
  s_cmp_ge_u32 s75, 53248
  s_cselect_b32 s79, 53248, 0
  s_sub_u32 s75, s75, s79
  s_lshl_b32 s79, s64, 10
  s_add_u32 s75, s75, s79
  buffer_load_dwordx4 v[160:163], v6, s[24:27], s75 offen sc1
  v_mfma_f32_16x16x32_bf16 v[196:199], a[124:127], a[4:7], v[196:199]
  v_mfma_f32_16x16x32_bf16 v[200:203], a[124:127], a[8:11], v[200:203]
  v_mfma_f32_16x16x32_bf16 v[204:207], a[124:127], a[12:15], v[204:207]
  v_mfma_f32_16x16x32_bf16 v[208:211], a[128:131], a[0:3], v[208:211]
  v_mfma_f32_16x16x32_bf16 v[212:215], a[128:131], a[4:7], v[212:215]
  buffer_load_dwordx4 v[164:167], v7, s[24:27], s75 offen sc1
  v_mfma_f32_16x16x32_bf16 v[216:219], a[128:131], a[8:11], v[216:219]
  v_mfma_f32_16x16x32_bf16 v[220:223], a[128:131], a[12:15], v[220:223]
  v_mfma_f32_16x16x32_bf16 v[224:227], a[132:135], a[0:3], v[224:227]
  v_mfma_f32_16x16x32_bf16 v[228:231], a[132:135], a[4:7], v[228:231]
  v_mfma_f32_16x16x32_bf16 v[232:235], a[132:135], a[8:11], v[232:235]
  buffer_load_dwordx4 v[168:171], v8, s[24:27], s75 offen sc1
  v_mfma_f32_16x16x32_bf16 v[236:239], a[132:135], a[12:15], v[236:239]
  v_mfma_f32_16x16x32_bf16 v[240:243], a[136:139], a[0:3], v[240:243]
  v_mfma_f32_16x16x32_bf16 v[244:247], a[136:139], a[4:7], v[244:247]
  v_mfma_f32_16x16x32_bf16 v[248:251], a[136:139], a[8:11], v[248:251]
  v_mfma_f32_16x16x32_bf16 v[252:255], a[136:139], a[12:15], v[252:255]
  buffer_load_dwordx4 v[172:175], v9, s[24:27], s75 offen sc1
  s_waitcnt vmcnt(19)
  v_mfma_f32_16x16x32_bf16 v[176:179], a[140:143], a[20:23], v[176:179]
  s_waitcnt vmcnt(18)
  v_mfma_f32_16x16x32_bf16 v[180:183], a[140:143], a[24:27], v[180:183]
  s_waitcnt vmcnt(17)
  v_mfma_f32_16x16x32_bf16 v[184:187], a[140:143], a[28:31], v[184:187]
  s_waitcnt vmcnt(16)
  v_mfma_f32_16x16x32_bf16 v[188:191], a[140:143], a[32:35], v[188:191]
  v_mfma_f32_16x16x32_bf16 v[192:195], a[144:147], a[20:23], v[192:195]
  s_add_u32 s75, s15, 49152
  s_cmp_ge_u32 s75, 53248
  s_cselect_b32 s79, 53248, 0
  s_sub_u32 s75, s75, s79
  s_lshl_b32 s79, s64, 10
  s_add_u32 s75, s75, s79
  buffer_load_dwordx4 v[112:115], v6, s[24:27], s75 offen sc1
  v_mfma_f32_16x16x32_bf16 v[196:199], a[144:147], a[24:27], v[196:199]
  v_mfma_f32_16x16x32_bf16 v[200:203], a[144:147], a[28:31], v[200:203]
  v_mfma_f32_16x16x32_bf16 v[204:207], a[144:147], a[32:35], v[204:207]
  v_mfma_f32_16x16x32_bf16 v[208:211], a[148:151], a[20:23], v[208:211]
  v_mfma_f32_16x16x32_bf16 v[212:215], a[148:151], a[24:27], v[212:215]
  buffer_load_dwordx4 v[116:119], v7, s[24:27], s75 offen sc1
  v_mfma_f32_16x16x32_bf16 v[216:219], a[148:151], a[28:31], v[216:219]
  v_mfma_f32_16x16x32_bf16 v[220:223], a[148:151], a[32:35], v[220:223]
  v_mfma_f32_16x16x32_bf16 v[224:227], a[152:155], a[20:23], v[224:227]
  v_mfma_f32_16x16x32_bf16 v[228:231], a[152:155], a[24:27], v[228:231]
  v_mfma_f32_16x16x32_bf16 v[232:235], a[152:155], a[28:31], v[232:235]
  buffer_load_dwordx4 v[120:123], v8, s[24:27], s75 offen sc1
  v_mfma_f32_16x16x32_bf16 v[236:239], a[152:155], a[32:35], v[236:239]
  v_mfma_f32_16x16x32_bf16 v[240:243], a[156:159], a[20:23], v[240:243]
  v_mfma_f32_16x16x32_bf16 v[244:247], a[156:159], a[24:27], v[244:247]
  v_mfma_f32_16x16x32_bf16 v[248:251], a[156:159], a[28:31], v[248:251]
  v_mfma_f32_16x16x32_bf16 v[252:255], a[156:159], a[32:35], v[252:255]
  buffer_load_dwordx4 v[124:127], v9, s[24:27], s75 offen sc1
  s_waitcnt vmcnt(19)
  v_mfma_f32_16x16x32_bf16 v[176:179], a[160:163], a[40:43], v[176:179]
  s_waitcnt vmcnt(18)
  v_mfma_f32_16x16x32_bf16 v[180:183], a[160:163], a[44:47], v[180:183]
  s_waitcnt vmcnt(17)
  v_mfma_f32_16x16x32_bf16 v[184:187], a[160:163], a[48:51], v[184:187]
  s_waitcnt vmcnt(16)
  v_mfma_f32_16x16x32_bf16 v[188:191], a[160:163], a[52:55], v[188:191]
  v_mfma_f32_16x16x32_bf16 v[192:195], a[164:167], a[40:43], v[192:195]
  s_lshl_b32 s75, s64, 10
  s_add_u32 s75, s75, 53248
  s_cmp_ge_u32 s64, 2
  s_cselect_b32 s75, 1073741824, s75
  buffer_load_dwordx4 v[68:71], v6, s[24:27], s75 offen sc1
  v_mfma_f32_16x16x32_bf16 v[196:199], a[164:167], a[44:47], v[196:199]
  v_mfma_f32_16x16x32_bf16 v[200:203], a[164:167], a[48:51], v[200:203]
  v_mfma_f32_16x16x32_bf16 v[204:207], a[164:167], a[52:55], v[204:207]
  v_mfma_f32_16x16x32_bf16 v[208:211], a[168:171], a[40:43], v[208:211]
  v_mfma_f32_16x16x32_bf16 v[212:215], a[168:171], a[44:47], v[212:215]
  buffer_load_dwordx4 v[72:75], v7, s[24:27], s75 offen sc1
  v_mfma_f32_16x16x32_bf16 v[216:219], a[168:171], a[48:51], v[216:219]
  v_mfma_f32_16x16x32_bf16 v[220:223], a[168:171], a[52:55], v[220:223]
  v_mfma_f32_16x16x32_bf16 v[224:227], a[172:175], a[40:43], v[224:227]
  v_mfma_f32_16x16x32_bf16 v[228:231], a[172:175], a[44:47], v[228:231]
  v_mfma_f32_16x16x32_bf16 v[232:235], a[172:175], a[48:51], v[232:235]
  buffer_load_dwordx4 v[76:79], v8, s[24:27], s75 offen sc1
  v_mfma_f32_16x16x32_bf16 v[236:239], a[172:175], a[52:55], v[236:239]
  v_mfma_f32_16x16x32_bf16 v[240:243], a[176:179], a[40:43], v[240:243]
  v_mfma_f32_16x16x32_bf16 v[244:247], a[176:179], a[44:47], v[244:247]
  v_mfma_f32_16x16x32_bf16 v[248:251], a[176:179], a[48:51], v[248:251]
  v_mfma_f32_16x16x32_bf16 v[252:255], a[176:179], a[52:55], v[252:255]
  buffer_load_dwordx4 v[80:83], v9, s[24:27], s75 offen sc1
  s_waitcnt vmcnt(19)
  v_mfma_f32_16x16x32_bf16 v[176:179], a[224:227], v[128:131], v[176:179]
  s_waitcnt vmcnt(18)
  v_mfma_f32_16x16x32_bf16 v[180:183], a[224:227], v[132:135], v[180:183]
  ds_read_b128 a[0:3], v22 offset:0
  s_waitcnt vmcnt(17)
  v_mfma_f32_16x16x32_bf16 v[184:187], a[224:227], v[136:139], v[184:187]
  s_waitcnt vmcnt(16)
  v_mfma_f32_16x16x32_bf16 v[188:191], a[224:227], v[140:143], v[188:191]
  ds_read_b128 a[4:7], v22 offset:1024
  v_mfma_f32_16x16x32_bf16 v[192:195], a[228:231], v[128:131], v[192:195]
  v_mfma_f32_16x16x32_bf16 v[196:199], a[228:231], v[132:135], v[196:199]
  ds_read_b128 a[8:11], v22 offset:2048
  v_mfma_f32_16x16x32_bf16 v[200:203], a[228:231], v[136:139], v[200:203]
  v_mfma_f32_16x16x32_bf16 v[204:207], a[228:231], v[140:143], v[204:207]
  ds_read_b128 a[12:15], v22 offset:3072
  v_mfma_f32_16x16x32_bf16 v[208:211], a[232:235], v[128:131], v[208:211]
  v_mfma_f32_16x16x32_bf16 v[212:215], a[232:235], v[132:135], v[212:215]
  ds_read_b128 a[16:19], v22 offset:4096
  v_mfma_f32_16x16x32_bf16 v[216:219], a[232:235], v[136:139], v[216:219]
  v_mfma_f32_16x16x32_bf16 v[220:223], a[232:235], v[140:143], v[220:223]
  s_add_u32 s20, s13, 296960
  buffer_load_dwordx4 a[100:103], v2, s[60:63], s20 offen offset:0 sc1
  v_mfma_f32_16x16x32_bf16 v[224:227], a[236:239], v[128:131], v[224:227]
  v_mfma_f32_16x16x32_bf16 v[228:231], a[236:239], v[132:135], v[228:231]
  buffer_load_dwordx4 a[104:107], v2, s[60:63], s20 offen offset:1024 sc1
  v_mfma_f32_16x16x32_bf16 v[232:235], a[236:239], v[136:139], v[232:235]
  v_mfma_f32_16x16x32_bf16 v[236:239], a[236:239], v[140:143], v[236:239]
  buffer_load_dwordx4 a[108:111], v2, s[60:63], s20 offen offset:2048 sc1
  v_mfma_f32_16x16x32_bf16 v[240:243], a[240:243], v[128:131], v[240:243]
  v_mfma_f32_16x16x32_bf16 v[244:247], a[240:243], v[132:135], v[244:247]
  buffer_load_dwordx4 a[112:115], v2, s[60:63], s20 offen offset:3072 sc1
  v_mfma_f32_16x16x32_bf16 v[248:251], a[240:243], v[136:139], v[248:251]
  v_mfma_f32_16x16x32_bf16 v[252:255], a[240:243], v[140:143], v[252:255]
  s_add_u32 s20, s20, 4096
  buffer_load_dwordx4 a[116:119], v2, s[60:63], s20 offen sc1
  s_waitcnt vmcnt(20) lgkmcnt(4)
  v_mfma_f32_16x16x32_bf16 v[176:179], a[0:3], v[144:147], v[176:179]
  ds_read_b128 a[20:23], v22 offset:20480
  s_waitcnt vmcnt(19)
  v_mfma_f32_16x16x32_bf16 v[180:183], a[0:3], v[148:151], v[180:183]
  ds_read_b128 a[24:27], v22 offset:21504
  s_waitcnt vmcnt(18)
  v_mfma_f32_16x16x32_bf16 v[184:187], a[0:3], v[152:155], v[184:187]
  ds_read_b128 a[28:31], v22 offset:22528
  s_waitcnt vmcnt(17)
  v_mfma_f32_16x16x32_bf16 v[188:191], a[0:3], v[156:159], v[188:191]
  ds_read_b128 a[32:35], v22 offset:23552
  s_waitcnt lgkmcnt(7)
  v_mfma_f32_16x16x32_bf16 v[192:195], a[4:7], v[144:147], v[192:195]
  ds_read_b128 a[36:39], v22 offset:24576
  v_mfma_f32_16x16x32_bf16 v[196:199], a[4:7], v[148:151], v[196:199]
  s_add_u32 s20, s13, 317440
  buffer_load_dwordx4 a[120:123], v2, s[60:63], s20 offen offset:0 sc1
  v_mfma_f32_16x16x32_bf16 v[200:203], a[4:7], v[152:155], v[200:203]
  buffer_load_dwordx4 a[124:127], v2, s[60:63], s20 offen offset:1024 sc1
  v_mfma_f32_16x16x32_bf16 v[204:207], a[4:7], v[156:159], v[204:207]
  buffer_load_dwordx4 a[128:131], v2, s[60:63], s20 offen offset:2048 sc1
  s_waitcnt lgkmcnt(7)
  v_mfma_f32_16x16x32_bf16 v[208:211], a[8:11], v[144:147], v[208:211]
  buffer_load_dwordx4 a[132:135], v2, s[60:63], s20 offen offset:3072 sc1
  v_mfma_f32_16x16x32_bf16 v[212:215], a[8:11], v[148:151], v[212:215]
  s_add_u32 s20, s20, 4096
  buffer_load_dwordx4 a[136:139], v2, s[60:63], s20 offen sc1
  v_mfma_f32_16x16x32_bf16 v[216:219], a[8:11], v[152:155], v[216:219]
  s_add_u32 s20, s13, 337920
  buffer_load_dwordx4 a[140:143], v2, s[60:63], s20 offen offset:0 sc1
  v_mfma_f32_16x16x32_bf16 v[220:223], a[8:11], v[156:159], v[220:223]
  buffer_load_dwordx4 a[144:147], v2, s[60:63], s20 offen offset:1024 sc1
  s_waitcnt lgkmcnt(6)
  v_mfma_f32_16x16x32_bf16 v[224:227], a[12:15], v[144:147], v[224:227]
  buffer_load_dwordx4 a[148:151], v2, s[60:63], s20 offen offset:2048 sc1
  v_mfma_f32_16x16x32_bf16 v[228:231], a[12:15], v[148:151], v[228:231]
  buffer_load_dwordx4 a[152:155], v2, s[60:63], s20 offen offset:3072 sc1
  v_mfma_f32_16x16x32_bf16 v[232:235], a[12:15], v[152:155], v[232:235]
  s_add_u32 s20, s20, 4096
  buffer_load_dwordx4 a[156:159], v2, s[60:63], s20 offen sc1
  v_mfma_f32_16x16x32_bf16 v[236:239], a[12:15], v[156:159], v[236:239]
  s_waitcnt lgkmcnt(5)
  v_mfma_f32_16x16x32_bf16 v[240:243], a[16:19], v[144:147], v[240:243]
  v_mfma_f32_16x16x32_bf16 v[244:247], a[16:19], v[148:151], v[244:247]
  v_mfma_f32_16x16x32_bf16 v[248:251], a[16:19], v[152:155], v[248:251]
  v_mfma_f32_16x16x32_bf16 v[252:255], a[16:19], v[156:159], v[252:255]
  s_waitcnt vmcnt(26) lgkmcnt(4)
  v_mfma_f32_16x16x32_bf16 v[176:179], a[20:23], v[160:163], v[176:179]
  s_waitcnt vmcnt(25)
  v_mfma_f32_16x16x32_bf16 v[180:183], a[20:23], v[164:167], v[180:183]
  ds_read_b128 a[40:43], v22 offset:40960
  s_waitcnt vmcnt(24)
  v_mfma_f32_16x16x32_bf16 v[184:187], a[20:23], v[168:171], v[184:187]
  s_waitcnt vmcnt(23)
  v_mfma_f32_16x16x32_bf16 v[188:191], a[20:23], v[172:175], v[188:191]
  ds_read_b128 a[44:47], v22 offset:41984
  s_waitcnt lgkmcnt(5)
  v_mfma_f32_16x16x32_bf16 v[192:195], a[24:27], v[160:163], v[192:195]
  v_mfma_f32_16x16x32_bf16 v[196:199], a[24:27], v[164:167], v[196:199]
  ds_read_b128 a[48:51], v22 offset:43008
  v_mfma_f32_16x16x32_bf16 v[200:203], a[24:27], v[168:171], v[200:203]
  v_mfma_f32_16x16x32_bf16 v[204:207], a[24:27], v[172:175], v[204:207]
  ds_read_b128 a[52:55], v22 offset:44032
  s_waitcnt lgkmcnt(6)
  v_mfma_f32_16x16x32_bf16 v[208:211], a[28:31], v[160:163], v[208:211]
  v_mfma_f32_16x16x32_bf16 v[212:215], a[28:31], v[164:167], v[212:215]
  ds_read_b128 a[56:59], v22 offset:45056
  v_mfma_f32_16x16x32_bf16 v[216:219], a[28:31], v[168:171], v[216:219]
  v_mfma_f32_16x16x32_bf16 v[220:223], a[28:31], v[172:175], v[220:223]
  s_lshl_b32 s75, s64, 10
  s_add_u32 s75, s75, 0
  buffer_load_dwordx4 v[84:87], v10, s[28:31], s75 offen sc1
  s_waitcnt lgkmcnt(6)
  v_mfma_f32_16x16x32_bf16 v[224:227], a[32:35], v[160:163], v[224:227]
  v_mfma_f32_16x16x32_bf16 v[228:231], a[32:35], v[164:167], v[228:231]
  buffer_load_dwordx4 v[88:91], v11, s[28:31], s75 offen sc1
  v_mfma_f32_16x16x32_bf16 v[232:235], a[32:35], v[168:171], v[232:235]
  v_mfma_f32_16x16x32_bf16 v[236:239], a[32:35], v[172:175], v[236:239]
  buffer_load_dwordx4 v[92:95], v12, s[28:31], s75 offen sc1
  s_waitcnt lgkmcnt(5)
  v_mfma_f32_16x16x32_bf16 v[240:243], a[36:39], v[160:163], v[240:243]
  v_mfma_f32_16x16x32_bf16 v[244:247], a[36:39], v[164:167], v[244:247]
  buffer_load_dwordx4 v[96:99], v13, s[28:31], s75 offen sc1
  v_mfma_f32_16x16x32_bf16 v[248:251], a[36:39], v[168:171], v[248:251]
  v_mfma_f32_16x16x32_bf16 v[252:255], a[36:39], v[172:175], v[252:255]
  s_waitcnt vmcnt(26) lgkmcnt(4)
  v_mfma_f32_16x16x32_bf16 v[176:179], a[40:43], v[112:115], v[176:179]
  s_waitcnt vmcnt(25)
  v_mfma_f32_16x16x32_bf16 v[180:183], a[40:43], v[116:119], v[180:183]
  ds_read_b128 a[60:63], v23 offset:0
  s_waitcnt vmcnt(24)
  v_mfma_f32_16x16x32_bf16 v[184:187], a[40:43], v[120:123], v[184:187]
  s_waitcnt vmcnt(23)
  v_mfma_f32_16x16x32_bf16 v[188:191], a[40:43], v[124:127], v[188:191]
  ds_read_b128 a[64:67], v23 offset:1024
  s_waitcnt lgkmcnt(5)
  v_mfma_f32_16x16x32_bf16 v[192:195], a[44:47], v[112:115], v[192:195]
  v_mfma_f32_16x16x32_bf16 v[196:199], a[44:47], v[116:119], v[196:199]
  ds_read_b128 a[68:71], v23 offset:2048
  v_mfma_f32_16x16x32_bf16 v[200:203], a[44:47], v[120:123], v[200:203]
  v_mfma_f32_16x16x32_bf16 v[204:207], a[44:47], v[124:127], v[204:207]
  ds_read_b128 a[72:75], v23 offset:3072
  s_waitcnt lgkmcnt(6)
  v_mfma_f32_16x16x32_bf16 v[208:211], a[48:51], v[112:115], v[208:211]
  v_mfma_f32_16x16x32_bf16 v[212:215], a[48:51], v[116:119], v[212:215]
  ds_read_b128 a[76:79], v23 offset:4096
  v_mfma_f32_16x16x32_bf16 v[216:219], a[48:51], v[120:123], v[216:219]
  v_mfma_f32_16x16x32_bf16 v[220:223], a[48:51], v[124:127], v[220:223]
  s_lshl_b32 s75, s64, 10
  s_add_u32 s75, s75, 4096
  buffer_load_dwordx4 v[128:131], v10, s[28:31], s75 offen sc1
  s_waitcnt lgkmcnt(6)
  v_mfma_f32_16x16x32_bf16 v[224:227], a[52:55], v[112:115], v[224:227]
  v_mfma_f32_16x16x32_bf16 v[228:231], a[52:55], v[116:119], v[228:231]
  buffer_load_dwordx4 v[132:135], v11, s[28:31], s75 offen sc1
  v_mfma_f32_16x16x32_bf16 v[232:235], a[52:55], v[120:123], v[232:235]
  v_mfma_f32_16x16x32_bf16 v[236:239], a[52:55], v[124:127], v[236:239]
  buffer_load_dwordx4 v[136:139], v12, s[28:31], s75 offen sc1
  s_waitcnt lgkmcnt(5)
  v_mfma_f32_16x16x32_bf16 v[240:243], a[56:59], v[112:115], v[240:243]
  v_mfma_f32_16x16x32_bf16 v[244:247], a[56:59], v[116:119], v[244:247]
  buffer_load_dwordx4 v[140:143], v13, s[28:31], s75 offen sc1
  v_mfma_f32_16x16x32_bf16 v[248:251], a[56:59], v[120:123], v[248:251]
  v_mfma_f32_16x16x32_bf16 v[252:255], a[56:59], v[124:127], v[252:255]
  s_waitcnt vmcnt(26) lgkmcnt(4)
  v_mfma_f32_16x16x32_bf16 v[176:179], a[60:63], v[68:71], v[176:179]
  ds_read_b128 a[80:83], v23 offset:20480
  s_waitcnt vmcnt(25)
  v_mfma_f32_16x16x32_bf16 v[180:183], a[60:63], v[72:75], v[180:183]
  ds_read_b128 a[84:87], v23 offset:21504
  s_waitcnt vmcnt(24)
  v_mfma_f32_16x16x32_bf16 v[184:187], a[60:63], v[76:79], v[184:187]
  ds_read_b128 a[88:91], v23 offset:22528
  s_waitcnt vmcnt(23)
  v_mfma_f32_16x16x32_bf16 v[188:191], a[60:63], v[80:83], v[188:191]
  ds_read_b128 a[92:95], v23 offset:23552
  s_waitcnt lgkmcnt(7)
  v_mfma_f32_16x16x32_bf16 v[192:195], a[64:67], v[68:71], v[192:195]
  ds_read_b128 a[96:99], v23 offset:24576
  v_mfma_f32_16x16x32_bf16 v[196:199], a[64:67], v[72:75], v[196:199]
  s_lshl_b32 s75, s64, 10
  s_add_u32 s75, s75, 8192
  buffer_load_dwordx4 v[144:147], v10, s[28:31], s75 offen sc1
  v_mfma_f32_16x16x32_bf16 v[200:203], a[64:67], v[76:79], v[200:203]
  buffer_load_dwordx4 v[148:151], v11, s[28:31], s75 offen sc1
  v_mfma_f32_16x16x32_bf16 v[204:207], a[64:67], v[80:83], v[204:207]
  buffer_load_dwordx4 v[152:155], v12, s[28:31], s75 offen sc1
  s_waitcnt lgkmcnt(7)
  v_mfma_f32_16x16x32_bf16 v[208:211], a[68:71], v[68:71], v[208:211]
  buffer_load_dwordx4 v[156:159], v13, s[28:31], s75 offen sc1
  v_mfma_f32_16x16x32_bf16 v[212:215], a[68:71], v[72:75], v[212:215]
  s_add_u32 s20, s13, 358400
  buffer_load_dwordx4 a[160:163], v2, s[60:63], s20 offen offset:0 sc1
  v_mfma_f32_16x16x32_bf16 v[216:219], a[68:71], v[76:79], v[216:219]
  buffer_load_dwordx4 a[164:167], v2, s[60:63], s20 offen offset:1024 sc1
  v_mfma_f32_16x16x32_bf16 v[220:223], a[68:71], v[80:83], v[220:223]
  buffer_load_dwordx4 a[168:171], v2, s[60:63], s20 offen offset:2048 sc1
  s_waitcnt lgkmcnt(6)
  v_mfma_f32_16x16x32_bf16 v[224:227], a[72:75], v[68:71], v[224:227]
  buffer_load_dwordx4 a[172:175], v2, s[60:63], s20 offen offset:3072 sc1
  v_mfma_f32_16x16x32_bf16 v[228:231], a[72:75], v[72:75], v[228:231]
  s_add_u32 s20, s20, 4096
  buffer_load_dwordx4 a[176:179], v2, s[60:63], s20 offen sc1
  s_waitcnt vmcnt(16)
  v_min3_u32 v48, v84, v85, v86
  s_waitcnt vmcnt(15)
  v_min3_u32 v48, v48, v87, v88
  v_min3_u32 v48, v48, v89, v90
  s_waitcnt vmcnt(14)
  v_min3_u32 v48, v48, v91, v92
  v_min3_u32 v48, v48, v93, v94
  s_waitcnt vmcnt(13)
  v_min3_u32 v48, v48, v95, v96
  v_min3_u32 v48, v48, v97, v98
  v_min_u32 v48, v48, v99
  v_cmp_eq_u32 vcc, 0, v48
  s_nop 0
  s_cbranch_vccnz L_Bo14_retry
L_Bo14_ok:
  v_mfma_f32_16x16x32_bf16 v[232:235], a[72:75], v[76:79], v[232:235]
  v_mfma_f32_16x16x32_bf16 v[236:239], a[72:75], v[80:83], v[236:239]
  s_waitcnt lgkmcnt(5)
  v_mfma_f32_16x16x32_bf16 v[240:243], a[76:79], v[68:71], v[240:243]
  v_mfma_f32_16x16x32_bf16 v[244:247], a[76:79], v[72:75], v[244:247]
  v_mfma_f32_16x16x32_bf16 v[248:251], a[76:79], v[76:79], v[248:251]
  v_mfma_f32_16x16x32_bf16 v[252:255], a[76:79], v[80:83], v[252:255]
  s_waitcnt lgkmcnt(4)
  v_mfma_f32_16x16x32_bf16 v[176:179], a[80:83], v[84:87], v[176:179]
  v_mfma_f32_16x16x32_bf16 v[180:183], a[80:83], v[88:91], v[180:183]
  v_mfma_f32_16x16x32_bf16 v[184:187], a[80:83], v[92:95], v[184:187]
  s_lshl_b32 s75, s64, 10
  s_add_u32 s75, s75, 12288
  buffer_load_dwordx4 v[160:163], v10, s[28:31], s75 offen sc1
  v_mfma_f32_16x16x32_bf16 v[188:191], a[80:83], v[96:99], v[188:191]
  s_waitcnt lgkmcnt(3)
  v_mfma_f32_16x16x32_bf16 v[192:195], a[84:87], v[84:87], v[192:195]
  v_mfma_f32_16x16x32_bf16 v[196:199], a[84:87], v[88:91], v[196:199]
  buffer_load_dwordx4 v[164:167], v11, s[28:31], s75 offen sc1
  v_mfma_f32_16x16x32_bf16 v[200:203], a[84:87], v[92:95], v[200:203]
  v_mfma_f32_16x16x32_bf16 v[204:207], a[84:87], v[96:99], v[204:207]
  s_waitcnt lgkmcnt(2)
  v_mfma_f32_16x16x32_bf16 v[208:211], a[88:91], v[84:87], v[208:211]
  buffer_load_dwordx4 v[168:171], v12, s[28:31], s75 offen sc1
  v_mfma_f32_16x16x32_bf16 v[212:215], a[88:91], v[88:91], v[212:215]
  v_mfma_f32_16x16x32_bf16 v[216:219], a[88:91], v[92:95], v[216:219]
  v_mfma_f32_16x16x32_bf16 v[220:223], a[88:91], v[96:99], v[220:223]
  buffer_load_dwordx4 v[172:175], v13, s[28:31], s75 offen sc1
  s_waitcnt lgkmcnt(1)
  v_mfma_f32_16x16x32_bf16 v[224:227], a[92:95], v[84:87], v[224:227]
  v_mfma_f32_16x16x32_bf16 v[228:231], a[92:95], v[88:91], v[228:231]
  s_waitcnt vmcnt(16)
  v_min3_u32 v48, v128, v129, v130
  s_waitcnt vmcnt(15)
  v_min3_u32 v48, v48, v131, v132
  v_min3_u32 v48, v48, v133, v134
  s_waitcnt vmcnt(14)
  v_min3_u32 v48, v48, v135, v136
  v_min3_u32 v48, v48, v137, v138
  s_waitcnt vmcnt(13)
  v_min3_u32 v48, v48, v139, v140
  v_min3_u32 v48, v48, v141, v142
  v_min_u32 v48, v48, v143
  v_cmp_eq_u32 vcc, 0, v48
  s_nop 0
  s_cbranch_vccnz L_Bo15_retry
L_Bo15_ok:
  v_mfma_f32_16x16x32_bf16 v[232:235], a[92:95], v[92:95], v[232:235]
  v_mfma_f32_16x16x32_bf16 v[236:239], a[92:95], v[96:99], v[236:239]
  s_waitcnt lgkmcnt(0)
  v_mfma_f32_16x16x32_bf16 v[240:243], a[96:99], v[84:87], v[240:243]
  v_mfma_f32_16x16x32_bf16 v[244:247], a[96:99], v[88:91], v[244:247]
  v_mfma_f32_16x16x32_bf16 v[248:251], a[96:99], v[92:95], v[248:251]
  v_mfma_f32_16x16x32_bf16 v[252:255], a[96:99], v[96:99], v[252:255]
  v_mfma_f32_16x16x32_bf16 v[176:179], a[100:103], v[128:131], v[176:179]
  v_mfma_f32_16x16x32_bf16 v[180:183], a[100:103], v[132:135], v[180:183]
  v_mfma_f32_16x16x32_bf16 v[184:187], a[100:103], v[136:139], v[184:187]
  s_lshl_b32 s75, s64, 10
  s_add_u32 s75, s75, 16384
  buffer_load_dwordx4 v[112:115], v10, s[28:31], s75 offen sc1
  v_mfma_f32_16x16x32_bf16 v[188:191], a[100:103], v[140:143], v[188:191]
  v_mfma_f32_16x16x32_bf16 v[192:195], a[104:107], v[128:131], v[192:195]
  v_mfma_f32_16x16x32_bf16 v[196:199], a[104:107], v[132:135], v[196:199]
  buffer_load_dwordx4 v[116:119], v11, s[28:31], s75 offen sc1
  v_mfma_f32_16x16x32_bf16 v[200:203], a[104:107], v[136:139], v[200:203]
  v_mfma_f32_16x16x32_bf16 v[204:207], a[104:107], v[140:143], v[204:207]
  v_mfma_f32_16x16x32_bf16 v[208:211], a[108:111], v[128:131], v[208:211]
  buffer_load_dwordx4 v[120:123], v12, s[28:31], s75 offen sc1
  v_mfma_f32_16x16x32_bf16 v[212:215], a[108:111], v[132:135], v[212:215]
  v_mfma_f32_16x16x32_bf16 v[216:219], a[108:111], v[136:139], v[216:219]
  v_mfma_f32_16x16x32_bf16 v[220:223], a[108:111], v[140:143], v[220:223]
  buffer_load_dwordx4 v[124:127], v13, s[28:31], s75 offen sc1
  v_mfma_f32_16x16x32_bf16 v[224:227], a[112:115], v[128:131], v[224:227]
  v_mfma_f32_16x16x32_bf16 v[228:231], a[112:115], v[132:135], v[228:231]
  s_waitcnt vmcnt(16)
  v_min3_u32 v48, v144, v145, v146
  s_waitcnt vmcnt(15)
  v_min3_u32 v48, v48, v147, v148
  v_min3_u32 v48, v48, v149, v150
  s_waitcnt vmcnt(14)
  v_min3_u32 v48, v48, v151, v152
  v_min3_u32 v48, v48, v153, v154
  s_waitcnt vmcnt(13)
  v_min3_u32 v48, v48, v155, v156
  v_min3_u32 v48, v48, v157, v158
  v_min_u32 v48, v48, v159
  v_cmp_eq_u32 vcc, 0, v48
  s_nop 0
  s_cbranch_vccnz L_Bo16_retry
L_Bo16_ok:
  v_mfma_f32_16x16x32_bf16 v[232:235], a[112:115], v[136:139], v[232:235]
  v_mfma_f32_16x16x32_bf16 v[236:239], a[112:115], v[140:143], v[236:239]
  v_mfma_f32_16x16x32_bf16 v[240:243], a[116:119], v[128:131], v[240:243]
  v_mfma_f32_16x16x32_bf16 v[244:247], a[116:119], v[132:135], v[244:247]
  v_mfma_f32_16x16x32_bf16 v[248:251], a[116:119], v[136:139], v[248:251]
  v_mfma_f32_16x16x32_bf16 v[252:255], a[116:119], v[140:143], v[252:255]
  v_mfma_f32_16x16x32_bf16 v[176:179], a[120:123], v[144:147], v[176:179]
  v_mfma_f32_16x16x32_bf16 v[180:183], a[120:123], v[148:151], v[180:183]
  v_mfma_f32_16x16x32_bf16 v[184:187], a[120:123], v[152:155], v[184:187]
  v_mfma_f32_16x16x32_bf16 v[188:191], a[120:123], v[156:159], v[188:191]
  buffer_load_dwordx4 v[56:59], v15, s[32:35], s69 offen offset:0
  v_mfma_f32_16x16x32_bf16 v[192:195], a[124:127], v[144:147], v[192:195]
  v_mfma_f32_16x16x32_bf16 v[196:199], a[124:127], v[148:151], v[196:199]
  v_mfma_f32_16x16x32_bf16 v[200:203], a[124:127], v[152:155], v[200:203]
  v_mfma_f32_16x16x32_bf16 v[204:207], a[124:127], v[156:159], v[204:207]
  buffer_load_dwordx4 v[60:63], v15, s[32:35], s69 offen offset:64
  v_mfma_f32_16x16x32_bf16 v[208:211], a[128:131], v[144:147], v[208:211]
  v_mfma_f32_16x16x32_bf16 v[212:215], a[128:131], v[148:151], v[212:215]
  v_mfma_f32_16x16x32_bf16 v[216:219], a[128:131], v[152:155], v[216:219]
  v_mfma_f32_16x16x32_bf16 v[220:223], a[128:131], v[156:159], v[220:223]
  buffer_load_dwordx2 v[64:65], v14, s[32:35], s69 offen offset:128
  v_mfma_f32_16x16x32_bf16 v[224:227], a[132:135], v[144:147], v[224:227]
  v_mfma_f32_16x16x32_bf16 v[228:231], a[132:135], v[148:151], v[228:231]
  s_waitcnt vmcnt(10)
  v_min3_u32 v48, v160, v161, v162
  s_waitcnt vmcnt(9)
  v_min3_u32 v48, v48, v163, v164
  v_min3_u32 v48, v48, v165, v166
  s_waitcnt vmcnt(8)
  v_min3_u32 v48, v48, v167, v168
  v_min3_u32 v48, v48, v169, v170
  s_waitcnt vmcnt(7)
  v_min3_u32 v48, v48, v171, v172
  v_min3_u32 v48, v48, v173, v174
  v_min_u32 v48, v48, v175
  v_cmp_eq_u32 vcc, 0, v48
  s_nop 0
  s_cbranch_vccnz L_Bo17_retry
L_Bo17_ok:
  v_mfma_f32_16x16x32_bf16 v[232:235], a[132:135], v[152:155], v[232:235]
  v_mfma_f32_16x16x32_bf16 v[236:239], a[132:135], v[156:159], v[236:239]
  v_mfma_f32_16x16x32_bf16 v[240:243], a[136:139], v[144:147], v[240:243]
  v_mfma_f32_16x16x32_bf16 v[244:247], a[136:139], v[148:151], v[244:247]
  v_mfma_f32_16x16x32_bf16 v[248:251], a[136:139], v[152:155], v[248:251]
  v_mfma_f32_16x16x32_bf16 v[252:255], a[136:139], v[156:159], v[252:255]
  v_mfma_f32_16x16x32_bf16 v[176:179], a[140:143], v[160:163], v[176:179]
  v_mfma_f32_16x16x32_bf16 v[180:183], a[140:143], v[164:167], v[180:183]
  v_mfma_f32_16x16x32_bf16 v[184:187], a[140:143], v[168:171], v[184:187]
  v_mfma_f32_16x16x32_bf16 v[188:191], a[140:143], v[172:175], v[188:191]
  v_mfma_f32_16x16x32_bf16 v[192:195], a[144:147], v[160:163], v[192:195]
  v_mfma_f32_16x16x32_bf16 v[196:199], a[144:147], v[164:167], v[196:199]
  v_mfma_f32_16x16x32_bf16 v[200:203], a[144:147], v[168:171], v[200:203]
  v_mfma_f32_16x16x32_bf16 v[204:207], a[144:147], v[172:175], v[204:207]
  v_mfma_f32_16x16x32_bf16 v[208:211], a[148:151], v[160:163], v[208:211]
  v_mfma_f32_16x16x32_bf16 v[212:215], a[148:151], v[164:167], v[212:215]
  v_mfma_f32_16x16x32_bf16 v[216:219], a[148:151], v[168:171], v[216:219]
  v_mfma_f32_16x16x32_bf16 v[220:223], a[148:151], v[172:175], v[220:223]
  v_mfma_f32_16x16x32_bf16 v[224:227], a[152:155], v[160:163], v[224:227]
  v_mfma_f32_16x16x32_bf16 v[228:231], a[152:155], v[164:167], v[228:231]
  s_waitcnt vmcnt(6)
  v_min3_u32 v48, v112, v113, v114
  s_waitcnt vmcnt(5)
  v_min3_u32 v48, v48, v115, v116
  v_min3_u32 v48, v48, v117, v118
  s_waitcnt vmcnt(4)
  v_min3_u32 v48, v48, v119, v120
  v_min3_u32 v48, v48, v121, v122
  s_waitcnt vmcnt(3)
  v_min3_u32 v48, v48, v123, v124
  v_min3_u32 v48, v48, v125, v126
  v_min_u32 v48, v48, v127
  v_cmp_eq_u32 vcc, 0, v48
  s_nop 0
  s_cbranch_vccnz L_Bo18_retry
L_Bo18_ok:
  v_mfma_f32_16x16x32_bf16 v[232:235], a[152:155], v[168:171], v[232:235]
  v_mfma_f32_16x16x32_bf16 v[236:239], a[152:155], v[172:175], v[236:239]
  v_mfma_f32_16x16x32_bf16 v[240:243], a[156:159], v[160:163], v[240:243]
  v_mfma_f32_16x16x32_bf16 v[244:247], a[156:159], v[164:167], v[244:247]
  v_mfma_f32_16x16x32_bf16 v[248:251], a[156:159], v[168:171], v[248:251]
  v_mfma_f32_16x16x32_bf16 v[252:255], a[156:159], v[172:175], v[252:255]
  v_add_u32 v50, 151552, v19
  v_add_u32 v51, 151552, v16
  v_mfma_f32_16x16x32_bf16 v[180:183], a[160:163], v[116:119], v[180:183]
  v_mfma_f32_16x16x32_bf16 v[196:199], a[164:167], v[116:119], v[196:199]
  v_mfma_f32_16x16x32_bf16 v[212:215], a[168:171], v[116:119], v[212:215]
  v_mfma_f32_16x16x32_bf16 v[228:231], a[172:175], v[116:119], v[228:231]
  v_mfma_f32_16x16x32_bf16 v[244:247], a[176:179], v[116:119], v[244:247]
  s_nop 3
  ds_write_b128 v17, v[180:183] offset:0
  v_mfma_f32_16x16x32_bf16 v[184:187], a[160:163], v[120:123], v[184:187]
  ds_write_b128 v17, v[196:199] offset:4096
  v_mfma_f32_16x16x32_bf16 v[200:203], a[164:167], v[120:123], v[200:203]
  ds_write_b128 v17, v[212:215] offset:8192
  v_mfma_f32_16x16x32_bf16 v[216:219], a[168:171], v[120:123], v[216:219]
  ds_write_b128 v17, v[228:231] offset:12288
  v_mfma_f32_16x16x32_bf16 v[232:235], a[172:175], v[120:123], v[232:235]
  ds_write_b128 v17, v[244:247] offset:16384
  v_mfma_f32_16x16x32_bf16 v[248:251], a[176:179], v[120:123], v[248:251]
  ds_write_b128 v18, v[184:187] offset:20480
  v_mfma_f32_16x16x32_bf16 v[188:191], a[160:163], v[124:127], v[188:191]
  ds_write_b128 v18, v[200:203] offset:24576
  v_mfma_f32_16x16x32_bf16 v[204:207], a[164:167], v[124:127], v[204:207]
  ds_write_b128 v18, v[216:219] offset:28672
  v_mfma_f32_16x16x32_bf16 v[220:223], a[168:171], v[124:127], v[220:223]
  ds_write_b128 v18, v[232:235] offset:32768
  v_mfma_f32_16x16x32_bf16 v[236:239], a[172:175], v[124:127], v[236:239]
  ds_write_b128 v18, v[248:251] offset:36864
  v_mfma_f32_16x16x32_bf16 v[252:255], a[176:179], v[124:127], v[252:255]
  ds_write_b128 v19, v[188:191] offset:40960
  v_mfma_f32_16x16x32_bf16 v[176:179], a[160:163], v[112:115], v[176:179]
  ds_write_b128 v19, v[204:207] offset:45056
  v_mfma_f32_16x16x32_bf16 v[192:195], a[164:167], v[112:115], v[192:195]
  ds_write_b128 v50, v[220:223] offset:0
  v_mfma_f32_16x16x32_bf16 v[208:211], a[168:171], v[112:115], v[208:211]
  ds_write_b128 v50, v[236:239] offset:4096
  v_mfma_f32_16x16x32_bf16 v[224:227], a[172:175], v[112:115], v[224:227]
  ds_write_b128 v50, v[252:255] offset:8192
  v_mfma_f32_16x16x32_bf16 v[240:243], a[176:179], v[112:115], v[240:243]
  s_waitcnt vmcnt(2)
  v_permlane16_swap_b32 v56, v58
  v_permlane16_swap_b32 v57, v59
  s_nop 0
  v_permlane32_swap_b32 v56, v58
  v_permlane32_swap_b32 v57, v59
  s_waitcnt vmcnt(1)
  v_permlane16_swap_b32 v60, v62
  v_permlane16_swap_b32 v61, v63
  s_nop 0
  v_permlane32_swap_b32 v60, v62
  v_permlane32_swap_b32 v61, v63
  v_lshlrev_b32 v84, 16, v56
  v_and_b32 v85, 0xffff0000, v56
  v_lshlrev_b32 v86, 16, v57
  v_and_b32 v87, 0xffff0000, v57
  v_lshlrev_b32 v88, 16, v58
  v_and_b32 v89, 0xffff0000, v58
  v_lshlrev_b32 v90, 16, v59
  v_and_b32 v91, 0xffff0000, v59
  v_lshlrev_b32 v92, 16, v60
  v_and_b32 v93, 0xffff0000, v60
  v_lshlrev_b32 v94, 16, v61
  v_and_b32 v95, 0xffff0000, v61
  v_lshlrev_b32 v96, 16, v62
  v_and_b32 v97, 0xffff0000, v62
  v_lshlrev_b32 v98, 16, v63
  v_and_b32 v99, 0xffff0000, v63
  s_waitcnt vmcnt(0)
  v_lshlrev_b32 v100, 16, v64
  v_and_b32 v101, 0xffff0000, v64
  v_lshlrev_b32 v102, 16, v65
  v_and_b32 v103, 0xffff0000, v65
  v_pk_add_f32 v[176:177], v[176:177], v[84:85]
  v_pk_add_f32 v[178:179], v[178:179], v[86:87]
  v_pk_add_f32 v[192:193], v[192:193], v[88:89]
  v_pk_add_f32 v[194:195], v[194:195], v[90:91]
  v_pk_add_f32 v[208:209], v[208:209], v[92:93]
  v_pk_add_f32 v[210:211], v[210:211], v[94:95]
  v_pk_add_f32 v[224:225], v[224:225], v[96:97]
  v_pk_add_f32 v[226:227], v[226:227], v[98:99]
  v_pk_add_f32 v[240:241], v[240:241], v[100:101]
  v_pk_add_f32 v[242:243], v[242:243], v[102:103]
  s_waitcnt lgkmcnt(0)
  s_cbranch_execz L_nb11
  s_barrier
L_nb11:
  ds_read_b128 v[112:115], v16 offset:0
  ds_read_b128 v[116:119], v16 offset:20480
  ds_read_b128 v[120:123], v16 offset:40960
  ds_read_b128 v[124:127], v16 offset:4096
  ds_read_b128 v[128:131], v16 offset:24576
  ds_read_b128 v[132:135], v16 offset:45056
  ds_read_b128 v[136:139], v16 offset:8192
  ds_read_b128 v[140:143], v16 offset:28672
  ds_read_b128 v[144:147], v51 offset:0
  ds_read_b128 v[148:151], v16 offset:12288
  ds_read_b128 v[152:155], v16 offset:32768
  ds_read_b128 v[156:159], v51 offset:4096
  ds_read_b128 v[160:163], v16 offset:16384
  ds_read_b128 v[164:167], v16 offset:36864
  ds_read_b128 v[168:171], v51 offset:8192
  s_waitcnt lgkmcnt(13)
  v_pk_add_f32 v[112:113], v[112:113], v[116:117]
  s_waitcnt lgkmcnt(12)
  v_pk_add_f32 v[176:177], v[176:177], v[120:121]
  v_pk_add_f32 v[114:115], v[114:115], v[118:119]
  v_pk_add_f32 v[178:179], v[178:179], v[122:123]
  s_waitcnt lgkmcnt(10)
  v_pk_add_f32 v[124:125], v[124:125], v[128:129]
  s_waitcnt lgkmcnt(9)
  v_pk_add_f32 v[192:193], v[192:193], v[132:133]
  v_pk_add_f32 v[126:127], v[126:127], v[130:131]
  v_pk_add_f32 v[194:195], v[194:195], v[134:135]
  s_waitcnt lgkmcnt(7)
  v_pk_add_f32 v[136:137], v[136:137], v[140:141]
  s_waitcnt lgkmcnt(6)
  v_pk_add_f32 v[208:209], v[208:209], v[144:145]
  v_pk_add_f32 v[138:139], v[138:139], v[142:143]
  v_pk_add_f32 v[210:211], v[210:211], v[146:147]
  s_waitcnt lgkmcnt(4)
  v_pk_add_f32 v[148:149], v[148:149], v[152:153]
  s_waitcnt lgkmcnt(3)
  v_pk_add_f32 v[224:225], v[224:225], v[156:157]
  v_pk_add_f32 v[150:151], v[150:151], v[154:155]
  v_pk_add_f32 v[226:227], v[226:227], v[158:159]
  v_pk_add_f32 v[176:177], v[176:177], v[112:113]
  v_pk_add_f32 v[178:179], v[178:179], v[114:115]
  v_pk_add_f32 v[192:193], v[192:193], v[124:125]
  v_pk_add_f32 v[194:195], v[194:195], v[126:127]
  v_pk_add_f32 v[208:209], v[208:209], v[136:137]
  v_pk_add_f32 v[210:211], v[210:211], v[138:139]
  v_pk_add_f32 v[224:225], v[224:225], v[148:149]
  v_pk_add_f32 v[226:227], v[226:227], v[150:151]
  v_cvt_pk_bf16_f32 v72, v176, v177
  v_cvt_pk_bf16_f32 v73, v178, v179
  v_cvt_pk_bf16_f32 v74, v192, v193
  v_cvt_pk_bf16_f32 v75, v194, v195
  v_cvt_pk_bf16_f32 v76, v208, v209
  v_cvt_pk_bf16_f32 v77, v210, v211
  v_cvt_pk_bf16_f32 v78, v224, v225
  v_cvt_pk_bf16_f32 v79, v226, v227
  v_permlane32_swap_b32 v72, v74
  v_permlane32_swap_b32 v73, v75
  v_permlane32_swap_b32 v76, v78
  v_permlane32_swap_b32 v77, v79
  s_waitcnt lgkmcnt(1)
  v_pk_add_f32 v[160:161], v[160:161], v[164:165]
  s_waitcnt lgkmcnt(0)
  v_pk_add_f32 v[240:241], v[240:241], v[168:169]
  v_pk_add_f32 v[162:163], v[162:163], v[166:167]
  v_pk_add_f32 v[242:243], v[242:243], v[170:171]
  v_pk_add_f32 v[240:241], v[240:241], v[160:161]
  v_pk_add_f32 v[242:243], v[242:243], v[162:163]
  v_permlane16_swap_b32 v72, v74
  v_permlane16_swap_b32 v73, v75
  v_permlane16_swap_b32 v76, v78
  v_permlane16_swap_b32 v77, v79
  v_cvt_pk_bf16_f32 v80, v240, v241
  v_cvt_pk_bf16_f32 v81, v242, v243
  buffer_store_dwordx4 v[72:75], v15, s[40:43], s69 offen offset:0
  buffer_store_dwordx4 v[76:79], v15, s[40:43], s69 offen offset:64
  buffer_store_dwordx2 v[80:81], v14, s[40:43], s69 offen offset:128
  s_cmp_lg_u32 s84, 0
  s_cbranch_scc1 L_km_fin
L_dry_done:
  s_mov_b64 exec, -1
  s_mov_b32 s84, -1
  s_mov_b32 s85, -1
  s_waitcnt vmcnt(0) lgkmcnt(0)
  s_barrier
  s_add_u32 s44, s22, 40960
  s_addc_u32 s45, s23, 0
  s_mov_b32 s46, 12288
  s_mov_b32 s47, 0x20000
  v_lshlrev_b32 v32, 2, v1
  v_lshlrev_b32 v33, 4, v1
  s_cmp_eq_u32 s64, 0
  s_cselect_b32 s80, 4096, 1073741824
  buffer_load_dwordx4 v[60:63], v33, s[44:47], s80 offen sc1
  s_cmp_eq_u32 s64, 0
  s_cselect_b64 s[76:77], -1, 0
  s_waitcnt vmcnt(0)
  v_and_b32 v60, v60, v61
  v_and_b32 v62, v62, v63
  v_and_b32 v60, v60, v62
  v_cmp_ne_u32 vcc, 1, v60
  s_and_b64 vcc, vcc, s[76:77]
  s_cbranch_vccnz L_spin_spare
L_spin_spare_go:
  s_barrier
  s_mul_i32 s76, s12, 378880
  s_add_u32 s76, s76, 9752576
  s_add_u32 s60, s22, s76
  s_addc_u32 s61, s23, 0
  s_and_b32 s62, s84, 378880
  s_mov_b32 s63, 0x20000
  v_lshlrev_b32 v2, 4, v1
  s_add_u32 s20, s14, 0
  s_cmp_ge_u32 s20, 266240
  s_cselect_b32 s21, 266240, 0
  s_sub_u32 s20, s20, s21
  s_add_u32 s20, s20, s13
  buffer_load_dwordx4 a[0:3], v2, s[60:63], s20 offen offset:0 sc1
  buffer_load_dwordx4 a[4:7], v2, s[60:63], s20 offen offset:1024 sc1
  buffer_load_dwordx4 a[8:11], v2, s[60:63], s20 offen offset:2048 sc1
  buffer_load_dwordx4 a[12:15], v2, s[60:63], s20 offen offset:3072 sc1
  s_add_u32 s20, s20, 4096
  buffer_load_dwordx4 a[16:19], v2, s[60:63], s20 offen sc1
  s_add_u32 s20, s14, 20480
  s_cmp_ge_u32 s20, 266240
  s_cselect_b32 s21, 266240, 0
  s_sub_u32 s20, s20, s21
  s_add_u32 s20, s20, s13
  buffer_load_dwordx4 a[20:23], v2, s[60:63], s20 offen offset:0 sc1
  buffer_load_dwordx4 a[24:27], v2, s[60:63], s20 offen offset:1024 sc1
  buffer_load_dwordx4 a[28:31], v2, s[60:63], s20 offen offset:2048 sc1
  buffer_load_dwordx4 a[32:35], v2, s[60:63], s20 offen offset:3072 sc1
  s_add_u32 s20, s20, 4096
  buffer_load_dwordx4 a[36:39], v2, s[60:63], s20 offen sc1
  s_add_u32 s20, s14, 40960
  s_cmp_ge_u32 s20, 266240
  s_cselect_b32 s21, 266240, 0
  s_sub_u32 s20, s20, s21
  s_add_u32 s20, s20, s13
  buffer_load_dwordx4 a[40:43], v2, s[60:63], s20 offen offset:0 sc1
  buffer_load_dwordx4 a[44:47], v2, s[60:63], s20 offen offset:1024 sc1
  buffer_load_dwordx4 a[48:51], v2, s[60:63], s20 offen offset:2048 sc1
  buffer_load_dwordx4 a[52:55], v2, s[60:63], s20 offen offset:3072 sc1
  s_add_u32 s20, s20, 4096
  buffer_load_dwordx4 a[56:59], v2, s[60:63], s20 offen sc1
  s_add_u32 s20, s14, 61440
  s_cmp_ge_u32 s20, 266240
  s_cselect_b32 s21, 266240, 0
  s_sub_u32 s20, s20, s21
  s_add_u32 s20, s20, s13
  buffer_load_dwordx4 a[60:63], v2, s[60:63], s20 offen offset:0 sc1
  buffer_load_dwordx4 a[64:67], v2, s[60:63], s20 offen offset:1024 sc1
  buffer_load_dwordx4 a[68:71], v2, s[60:63], s20 offen offset:2048 sc1
  buffer_load_dwordx4 a[72:75], v2, s[60:63], s20 offen offset:3072 sc1
  s_add_u32 s20, s20, 4096
  buffer_load_dwordx4 a[76:79], v2, s[60:63], s20 offen sc1
  s_add_u32 s20, s14, 81920
  s_cmp_ge_u32 s20, 266240
  s_cselect_b32 s21, 266240, 0
  s_sub_u32 s20, s20, s21
  s_add_u32 s20, s20, s13
  buffer_load_dwordx4 a[80:83], v2, s[60:63], s20 offen offset:0 sc1
  buffer_load_dwordx4 a[84:87], v2, s[60:63], s20 offen offset:1024 sc1
  buffer_load_dwordx4 a[88:91], v2, s[60:63], s20 offen offset:2048 sc1
  buffer_load_dwordx4 a[92:95], v2, s[60:63], s20 offen offset:3072 sc1
  s_add_u32 s20, s20, 4096
  buffer_load_dwordx4 a[96:99], v2, s[60:63], s20 offen sc1
  s_add_u32 s20, s14, 102400
  s_cmp_ge_u32 s20, 266240
  s_cselect_b32 s21, 266240, 0
  s_sub_u32 s20, s20, s21
  s_add_u32 s20, s20, s13
  buffer_load_dwordx4 a[100:103], v2, s[60:63], s20 offen offset:0 sc1
  buffer_load_dwordx4 a[104:107], v2, s[60:63], s20 offen offset:1024 sc1
  buffer_load_dwordx4 a[108:111], v2, s[60:63], s20 offen offset:2048 sc1
  buffer_load_dwordx4 a[112:115], v2, s[60:63], s20 offen offset:3072 sc1
  s_add_u32 s20, s20, 4096
  buffer_load_dwordx4 a[116:119], v2, s[60:63], s20 offen sc1
  s_add_u32 s20, s14, 122880
  s_cmp_ge_u32 s20, 266240
  s_cselect_b32 s21, 266240, 0
  s_sub_u32 s20, s20, s21
  s_add_u32 s20, s20, s13
  buffer_load_dwordx4 a[120:123], v2, s[60:63], s20 offen offset:0 sc1
  buffer_load_dwordx4 a[124:127], v2, s[60:63], s20 offen offset:1024 sc1
  buffer_load_dwordx4 a[128:131], v2, s[60:63], s20 offen offset:2048 sc1
  buffer_load_dwordx4 a[132:135], v2, s[60:63], s20 offen offset:3072 sc1
  s_add_u32 s20, s20, 4096
  buffer_load_dwordx4 a[136:139], v2, s[60:63], s20 offen sc1
  s_add_u32 s20, s14, 143360
  s_cmp_ge_u32 s20, 266240
  s_cselect_b32 s21, 266240, 0
  s_sub_u32 s20, s20, s21
  s_add_u32 s20, s20, s13
  buffer_load_dwordx4 a[140:143], v2, s[60:63], s20 offen offset:0 sc1
  buffer_load_dwordx4 a[144:147], v2, s[60:63], s20 offen offset:1024 sc1
  buffer_load_dwordx4 a[148:151], v2, s[60:63], s20 offen offset:2048 sc1
  buffer_load_dwordx4 a[152:155], v2, s[60:63], s20 offen offset:3072 sc1
  s_add_u32 s20, s20, 4096
  buffer_load_dwordx4 a[156:159], v2, s[60:63], s20 offen sc1
  s_add_u32 s20, s14, 163840
  s_cmp_ge_u32 s20, 266240
  s_cselect_b32 s21, 266240, 0
  s_sub_u32 s20, s20, s21
  s_add_u32 s20, s20, s13
  buffer_load_dwordx4 a[160:163], v2, s[60:63], s20 offen offset:0 sc1
  buffer_load_dwordx4 a[164:167], v2, s[60:63], s20 offen offset:1024 sc1
  buffer_load_dwordx4 a[168:171], v2, s[60:63], s20 offen offset:2048 sc1
  buffer_load_dwordx4 a[172:175], v2, s[60:63], s20 offen offset:3072 sc1
  s_add_u32 s20, s20, 4096
  buffer_load_dwordx4 a[176:179], v2, s[60:63], s20 offen sc1
  s_add_u32 s20, s14, 184320
  s_cmp_ge_u32 s20, 266240
  s_cselect_b32 s21, 266240, 0
  s_sub_u32 s20, s20, s21
  s_add_u32 s20, s20, s13
  buffer_load_dwordx4 a[224:227], v2, s[60:63], s20 offen offset:0 sc1
  buffer_load_dwordx4 a[228:231], v2, s[60:63], s20 offen offset:1024 sc1
  buffer_load_dwordx4 a[232:235], v2, s[60:63], s20 offen offset:2048 sc1
  buffer_load_dwordx4 a[236:239], v2, s[60:63], s20 offen offset:3072 sc1
  s_add_u32 s20, s20, 4096
  buffer_load_dwordx4 a[240:243], v2, s[60:63], s20 offen sc1
  s_add_u32 m0, s13, 49152
  s_add_u32 s20, s14, 204800
  s_cmp_ge_u32 s20, 266240
  s_cselect_b32 s21, 266240, 0
  s_sub_u32 s20, s20, s21
  s_add_u32 s20, s20, s13
  buffer_load_dwordx4 v2, s[60:63], s20 offen offset:0 sc1 lds
  buffer_load_dwordx4 v2, s[60:63], s20 offen offset:1024 sc1 lds
  buffer_load_dwordx4 v2, s[60:63], s20 offen offset:2048 sc1 lds
  buffer_load_dwordx4 v2, s[60:63], s20 offen offset:3072 sc1 lds
  s_add_u32 m0, s13, 53248
  s_add_u32 s20, s20, 4096
  buffer_load_dwordx4 v2, s[60:63], s20 offen sc1 lds
  s_add_u32 m0, s13, 69632
  s_add_u32 s20, s14, 225280
  s_cmp_ge_u32 s20, 266240
  s_cselect_b32 s21, 266240, 0
  s_sub_u32 s20, s20, s21
  s_add_u32 s20, s20, s13
  buffer_load_dwordx4 v2, s[60:63], s20 offen offset:0 sc1 lds
  buffer_load_dwordx4 v2, s[60:63], s20 offen offset:1024 sc1 lds
  buffer_load_dwordx4 v2, s[60:63], s20 offen offset:2048 sc1 lds
  buffer_load_dwordx4 v2, s[60:63], s20 offen offset:3072 sc1 lds
  s_add_u32 m0, s13, 73728
  s_add_u32 s20, s20, 4096
  buffer_load_dwordx4 v2, s[60:63], s20 offen sc1 lds
  s_add_u32 m0, s13, 90112
  s_add_u32 s20, s14, 245760
  s_cmp_ge_u32 s20, 266240
  s_cselect_b32 s21, 266240, 0
  s_sub_u32 s20, s20, s21
  s_add_u32 s20, s20, s13
  buffer_load_dwordx4 v2, s[60:63], s20 offen offset:0 sc1 lds
  buffer_load_dwordx4 v2, s[60:63], s20 offen offset:1024 sc1 lds
  buffer_load_dwordx4 v2, s[60:63], s20 offen offset:2048 sc1 lds
  buffer_load_dwordx4 v2, s[60:63], s20 offen offset:3072 sc1 lds
  s_add_u32 m0, s13, 94208
  s_add_u32 s20, s20, 4096
  buffer_load_dwordx4 v2, s[60:63], s20 offen sc1 lds
  s_add_u32 m0, s13, 110592
  s_add_u32 s20, s13, 266240
  s_cmp_ge_u32 s64, 2
  s_cselect_b32 s20, 1073741824, s20
  buffer_load_dwordx4 v2, s[60:63], s20 offen offset:0 sc1 lds
  buffer_load_dwordx4 v2, s[60:63], s20 offen offset:1024 sc1 lds
  buffer_load_dwordx4 v2, s[60:63], s20 offen offset:2048 sc1 lds
  buffer_load_dwordx4 v2, s[60:63], s20 offen offset:3072 sc1 lds
  s_add_u32 m0, s13, 114688
  s_add_u32 s20, s20, 4096
  buffer_load_dwordx4 v2, s[60:63], s20 offen sc1 lds
  s_add_u32 m0, s13, 131072
  s_add_u32 s20, s13, 276480
  buffer_load_dwordx4 v2, s[60:63], s20 offen offset:0 sc1 lds
  buffer_load_dwordx4 v2, s[60:63], s20 offen offset:1024 sc1 lds
  buffer_load_dwordx4 v2, s[60:63], s20 offen offset:2048 sc1 lds
  buffer_load_dwordx4 v2, s[60:63], s20 offen offset:3072 sc1 lds
  s_add_u32 m0, s13, 135168
  s_add_u32 s20, s20, 4096
  buffer_load_dwordx4 v2, s[60:63], s20 offen sc1 lds
  s_mov_b32 s80, 2
  s_mov_b32 s81, 1073741824
  s_branch L_Bpre
L_km_fin:
L_km_end:
  s_endpgm
L_km_ffn:
  s_lshr_b32 s65, s3, 4
  s_and_b32 s66, s3, 15
  s_lshl_b32 s67, s66, 2
  s_mul_i32 s68, s67, 5
  s_lshr_b32 s68, s68, 6
  s_lshl_b32 s68, s68, 1
  s_mov_b32 s3, 0
  s_waitcnt lgkmcnt(0)
  s_add_u32 s24, s4, 0
  s_addc_u32 s25, s5, 0
  s_and_b32 s26, s84, 2621440
  s_mov_b32 s27, 0x20000
  s_cmp_ge_u32 s64, 2
  s_cselect_b32 s28, s14, s12
  s_cselect_b32 s29, s15, s13
  s_and_b32 s30, s84, 2211840
  s_mov_b32 s31, 0x20000
  s_mul_i32 s76, s65, 384
  s_mul_i32 s69, s68, 221184
  s_add_u32 s69, s69, s76
  s_add_u32 s70, s76, 2211840
  s_mul_i32 s76, s67, 40960
  s_lshl_b32 s71, s68, 7
  s_add_u32 s71, s71, s76
  s_add_u32 s72, s76, 1280
  v_lshrrev_b32 v64, 3, v1
  s_lshl_b32 s76, s64, 3
  v_add_u32 v64, s76, v64
  v_lshrrev_b32 v65, 1, v64
  v_xor_b32 v65, v65, v1
  v_and_b32 v65, 7, v65
  v_lshlrev_b32 v65, 4, v65
  v_mul_u32_u24 v64, 1280, v64
  v_add_u32 v2, v64, v65
  s_and_b32 s76, s64, 1
  s_lshl_b32 s76, s76, 3
  s_lshr_b32 s77, s64, 1
  s_lshl_b32 s77, s77, 2
  v_add_u32 v64, 0, v1
  v_mul_u32_u24 v65, 2731, v64
  v_lshrrev_b32 v65, 16, v65
  v_mul_u32_u24 v66, 24, v65
  v_sub_u32 v66, v64, v66
  v_and_b32 v67, 2, v65
  v_or_b32 v67, s77, v67
  v_xor_b32 v66, v66, v67
  v_add_u32 v65, s76, v65
  v_mul_u32_u24 v65, 3456, v65
  v_lshl_add_u32 v65, v66, 4, v65
  v_mov_b32 v3, v65
  v_add_u32 v64, 64, v1
  v_mul_u32_u24 v65, 2731, v64
  v_lshrrev_b32 v65, 16, v65
  v_mul_u32_u24 v66, 24, v65
  v_sub_u32 v66, v64, v66
  v_and_b32 v67, 2, v65
  v_or_b32 v67, s77, v67
  v_xor_b32 v66, v66, v67
  v_add_u32 v65, s76, v65
  v_mul_u32_u24 v65, 3456, v65
  v_lshl_add_u32 v65, v66, 4, v65
  v_subrev_u32 v4, 1024, v65
  v_add_u32 v64, 128, v1
  v_mul_u32_u24 v65, 2731, v64
  v_lshrrev_b32 v65, 16, v65
  v_mul_u32_u24 v66, 24, v65
  v_sub_u32 v66, v64, v66
  v_and_b32 v67, 2, v65
  v_or_b32 v67, s77, v67
  v_xor_b32 v66, v66, v67
  v_add_u32 v65, s76, v65
  v_mul_u32_u24 v65, 3456, v65
  v_lshl_add_u32 v65, v66, 4, v65
  v_subrev_u32 v5, 2048, v65
  s_mul_i32 s73, s64, 3072
  s_lshl_b32 s74, s64, 10
  s_add_u32 m0, s74, 0
  s_add_u32 s75, s71, 0
  buffer_load_dwordx4 v2, s[24:27], s75 offen lds
  s_add_u32 m0, s74, 4096
  s_add_u32 s75, s71, 40960
  buffer_load_dwordx4 v2, s[24:27], s75 offen lds
  s_add_u32 m0, s74, 8192
  s_add_u32 s75, s71, 81920
  buffer_load_dwordx4 v2, s[24:27], s75 offen lds
  s_add_u32 m0, s74, 12288
  s_add_u32 s75, s71, 122880
  buffer_load_dwordx4 v2, s[24:27], s75 offen lds
  s_add_u32 m0, s73, 49152
  s_add_u32 s75, s69, 0
  buffer_load_dwordx4 v3, s[28:31], s75 offen offset:0 lds
  buffer_load_dwordx4 v4, s[28:31], s75 offen offset:1024 lds
  buffer_load_dwordx4 v5, s[28:31], s75 offen offset:2048 lds
  s_add_u32 m0, s73, 61440
  s_add_u32 s75, s69, 55296
  buffer_load_dwordx4 v3, s[28:31], s75 offen offset:0 lds
  buffer_load_dwordx4 v4, s[28:31], s75 offen offset:1024 lds
  buffer_load_dwordx4 v5, s[28:31], s75 offen offset:2048 lds
  s_add_u32 s32, s22, 0
  s_addc_u32 s33, s23, 0
  s_mov_b32 s34, 16384
  s_mov_b32 s35, 0x20000
  s_add_u32 s44, s22, 40960
  s_addc_u32 s45, s23, 0
  s_mov_b32 s46, 12288
  s_mov_b32 s47, 0x20000
  s_add_u32 s52, s4, 0
  s_addc_u32 s53, s5, 0
  s_mov_b32 s54, 2621440
  s_mov_b32 s55, 0x20000
  s_add_u32 s40, s22, 7131136
  s_addc_u32 s41, s23, 0
  s_mov_b32 s42, 10371072
  s_mov_b32 s43, 0x20000
  s_mov_b32 s48, s20
  s_mov_b32 s49, s21
  s_mov_b32 s50, 256
  s_mov_b32 s51, 0x20000
  s_lshl_b32 s76, s65, 2
  s_add_u32 s76, s76, s64
  s_mul_i32 s76, s76, 3840
  s_add_u32 s76, s76, 17567744
  s_add_u32 s36, s22, s76
  s_addc_u32 s37, s23, 0
  s_and_b32 s38, s84, 3840
  s_mov_b32 s39, 0x20000
  v_and_b32 v74, 31, v1
  v_lshrrev_b32 v75, 1, v74
  v_lshrrev_b32 v76, 5, v1
  v_xor_b32 v75, v75, v76
  v_and_b32 v75, 7, v75
  v_lshlrev_b32 v75, 4, v75
  v_lshl_add_u32 v75, v74, 7, v75
  v_xor_b32 v6, 0, v75
  v_xor_b32 v7, 32, v75
  v_xor_b32 v8, 64, v75
  v_xor_b32 v9, 96, v75
  v_lshlrev_b32 v18, 3, v74
  v_bfe_u32 v64, v1, 2, 2
  v_lshrrev_b32 v65, 5, v1
  v_lshl_add_u32 v65, v65, 3, v64
  v_bfe_u32 v66, v1, 4, 1
  v_and_b32 v67, 1, v1
  v_bfe_u32 v68, v1, 1, 1
  v_and_b32 v69, 2, v64
  v_lshl_or_b32 v69, v66, 2, v69
  v_mul_u32_u24 v70, 6144, v66
  v_mul_u32_u24 v71, 384, v65
  v_add_u32 v70, v70, v71
  v_lshl_add_u32 v70, v68, 3, v70
  v_add_u32 v70, 49152, v70
  s_mul_i32 s76, s64, 6
  s_add_u32 s76, s76, 0
  v_add_u32 v71, s76, v67
  v_xor_b32 v71, v71, v69
  v_lshl_add_u32 v10, v71, 4, v70
  v_add_u32 v11, 61440, v10
  s_mul_i32 s76, s64, 6
  s_add_u32 s76, s76, 2
  v_add_u32 v71, s76, v67
  v_xor_b32 v71, v71, v69
  v_lshl_add_u32 v12, v71, 4, v70
  v_add_u32 v13, 61440, v12
  s_mul_i32 s76, s64, 6
  s_add_u32 s76, s76, 4
  v_add_u32 v71, s76, v67
  v_xor_b32 v71, v71, v69
  v_lshl_add_u32 v14, v71, 4, v70
  v_add_u32 v15, 61440, v14
  v_bfe_u32 v65, v1, 4, 1
  v_mul_u32_u24 v65, 55296, v65
  v_lshrrev_b32 v66, 5, v1
  v_lshl_add_u32 v65, v66, 8, v65
  v_and_b32 v66, 15, v1
  v_lshl_add_u32 v16, v66, 4, v65
  s_mul_i32 s81, s65, 6144
  s_mul_i32 s76, s64, 1536
  s_add_u32 s81, s81, s76
  v_and_b32 v64, 31, v1
  v_cmp_eq_u32 vcc, 0, v1
  v_cmp_eq_u32 s[76:77], 32, v1
  s_or_b64 vcc, vcc, s[76:77]
  v_cmp_eq_u32 s[76:77], 20, v64
  s_or_b64 vcc, vcc, s[76:77]
  v_mov_b32 v64, 0x3f803f80
  v_cndmask_b32 v64, 0, v64, vcc
  v_accvgpr_write_b32 a64, v64
  v_accvgpr_write_b32 a65, v64
  v_accvgpr_write_b32 a66, v64
  v_accvgpr_write_b32 a67, v64
  s_and_b32 s76, s2, 1
  s_lshl_b32 s76, s76, 2
  s_lshr_b32 s12, s2, 6
  s_add_u32 s12, s12, s76
  s_mul_i32 s13, s64, 5120
  s_lshr_b32 s76, s2, 3
  s_and_b32 s76, s76, 7
  s_lshl_b32 s76, s76, 1
  s_lshr_b32 s77, s2, 6
  s_mul_i32 s77, s77, 0
  s_add_u32 s76, s76, s77
  s_cmp_ge_u32 s76, 13
  s_cselect_b32 s77, 13, 0
  s_sub_u32 s76, s76, s77
  s_mul_i32 s14, s76, 20480
  s_lshl_b32 s15, s76, 12
  s_lshl_b32 s76, s64, 8
  s_add_u32 s76, s76, s2
  s_mul_hi_u32 s82, s76, 0x1999999a
  s_mul_i32 s83, s82, 10
  s_sub_u32 s83, s76, s83
  s_cmp_ge_u32 s82, 54
  s_cselect_b32 s56, s10, s16
  s_cselect_b32 s57, s11, s17
  s_mov_b32 s58, 2211840
  s_cselect_b32 s58, 819200, s58
  s_mov_b32 s59, 0x20000
  s_cmp_ge_u32 s76, 740
  s_cselect_b32 s58, 0, s58
  v_lshrrev_b32 v96, 3, v1
  v_and_b32 v97, 7, v1
  v_lshlrev_b32 v97, 4, v97
  s_lshl_b32 s77, s83, 7
  v_add_u32 v97, s77, v97
  v_lshrrev_b32 v98, 2, v96
  v_mul_u32_u24 v98, 20, v98
  v_bfe_u32 v99, v96, 1, 1
  v_mul_u32_u24 v99, 10, v99
  v_add_u32 v98, v98, v99
  v_and_b32 v99, 1, v96
  v_add3_u32 v98, v98, v99, 8
  s_sub_u32 s76, s82, 54
  s_lshl_b32 s76, s76, 2
  s_add_u32 s76, s76, 0
  s_mul_hi_u32 s77, s76, 0x33333334
  s_mul_i32 s78, s77, 5
  s_sub_u32 s78, s76, s78
  s_mul_i32 s77, s77, 40
  s_lshr_b32 s76, s78, 1
  s_mul_i32 s76, s76, 20
  s_add_u32 s76, s76, s77
  s_and_b32 s79, s78, 1
  s_mul_i32 s79, s79, 10
  s_add_u32 s76, s76, s79
  s_cmp_eq_u32 s78, 4
  s_cselect_b32 s76, s77, s76
  s_cselect_b64 vcc, -1, 0
  v_cndmask_b32 v100, v96, v98, vcc
  s_lshl_b32 s77, s82, 5
  s_add_u32 s77, s77, 0
  s_cmp_ge_u32 s82, 54
  s_cselect_b32 s76, s76, s77
  s_cselect_b64 vcc, -1, 0
  v_cndmask_b32 v100, v96, v100, vcc
  v_add_u32 v100, s76, v100
  v_mul_u32_u24 v100, 1280, v100
  v_add_u32 v100, v100, v97
  v_accvgpr_write_b32 a128, v100
  s_sub_u32 s76, s82, 54
  s_lshl_b32 s76, s76, 2
  s_add_u32 s76, s76, 1
  s_mul_hi_u32 s77, s76, 0x33333334
  s_mul_i32 s78, s77, 5
  s_sub_u32 s78, s76, s78
  s_mul_i32 s77, s77, 40
  s_lshr_b32 s76, s78, 1
  s_mul_i32 s76, s76, 20
  s_add_u32 s76, s76, s77
  s_and_b32 s79, s78, 1
  s_mul_i32 s79, s79, 10
  s_add_u32 s76, s76, s79
  s_cmp_eq_u32 s78, 4
  s_cselect_b32 s76, s77, s76
  s_cselect_b64 vcc, -1, 0
  v_cndmask_b32 v100, v96, v98, vcc
  s_lshl_b32 s77, s82, 5
  s_add_u32 s77, s77, 8
  s_cmp_ge_u32 s82, 54
  s_cselect_b32 s76, s76, s77
  s_cselect_b64 vcc, -1, 0
  v_cndmask_b32 v100, v96, v100, vcc
  v_add_u32 v100, s76, v100
  v_mul_u32_u24 v100, 1280, v100
  v_add_u32 v100, v100, v97
  v_accvgpr_write_b32 a129, v100
  s_sub_u32 s76, s82, 54
  s_lshl_b32 s76, s76, 2
  s_add_u32 s76, s76, 2
  s_mul_hi_u32 s77, s76, 0x33333334
  s_mul_i32 s78, s77, 5
  s_sub_u32 s78, s76, s78
  s_mul_i32 s77, s77, 40
  s_lshr_b32 s76, s78, 1
  s_mul_i32 s76, s76, 20
  s_add_u32 s76, s76, s77
  s_and_b32 s79, s78, 1
  s_mul_i32 s79, s79, 10
  s_add_u32 s76, s76, s79
  s_cmp_eq_u32 s78, 4
  s_cselect_b32 s76, s77, s76
  s_cselect_b64 vcc, -1, 0
  v_cndmask_b32 v100, v96, v98, vcc
  s_lshl_b32 s77, s82, 5
  s_add_u32 s77, s77, 16
  s_cmp_ge_u32 s82, 54
  s_cselect_b32 s76, s76, s77
  s_cselect_b64 vcc, -1, 0
  v_cndmask_b32 v100, v96, v100, vcc
  v_add_u32 v100, s76, v100
  v_mul_u32_u24 v100, 1280, v100
  v_add_u32 v100, v100, v97
  v_accvgpr_write_b32 a130, v100
  s_sub_u32 s76, s82, 54
  s_lshl_b32 s76, s76, 2
  s_add_u32 s76, s76, 3
  s_mul_hi_u32 s77, s76, 0x33333334
  s_mul_i32 s78, s77, 5
  s_sub_u32 s78, s76, s78
  s_mul_i32 s77, s77, 40
  s_lshr_b32 s76, s78, 1
  s_mul_i32 s76, s76, 20
  s_add_u32 s76, s76, s77
  s_and_b32 s79, s78, 1
  s_mul_i32 s79, s79, 10
  s_add_u32 s76, s76, s79
  s_cmp_eq_u32 s78, 4
  s_cselect_b32 s76, s77, s76
  s_cselect_b64 vcc, -1, 0
  v_cndmask_b32 v100, v96, v98, vcc
  s_lshl_b32 s77, s82, 5
  s_add_u32 s77, s77, 24
  s_cmp_ge_u32 s82, 54
  s_cselect_b32 s76, s76, s77
  s_cselect_b64 vcc, -1, 0
  v_cndmask_b32 v100, v96, v100, vcc
  v_add_u32 v100, s76, v100
  v_mul_u32_u24 v100, 1280, v100
  v_add_u32 v100, v100, v97
  v_accvgpr_write_b32 a131, v100
  v_lshrrev_b32 v19, 4, v1
  v_lshlrev_b32 v19, 3, v19
  v_bfe_u32 v96, v1, 2, 2
  v_add_u32 v19, v19, v96
  v_lshlrev_b32 v19, 7, v19
  v_and_b32 v96, 3, v1
  v_lshl_add_u32 v19, v96, 3, v19
  s_lshl_b32 s76, s64, 12
  s_add_u32 s76, s76, 147456
  v_add_u32 v19, s76, v19
  v_lshlrev_b32 v20, 4, v1
  s_lshl_b32 s76, s2, 3
  s_lshl_b32 s77, s64, 1
  s_add_u32 s76, s76, s77
  v_lshrrev_b32 v60, 5, v1
  v_add_u32 v60, s76, v60
  v_and_b32 v36, 31, v1
  v_mul_u32_u24 v37, 1280, v60
  v_lshl_add_u32 v37, v36, 4, v37
  v_add_u32 v38, 1024, v37
  v_cmp_gt_u32 vcc, 16, v36
  v_mov_b32 v39, 1073741824
  s_nop 0
  v_cndmask_b32 v38, v39, v38, vcc
  v_cndmask_b32 v61, 0, 1.0, vcc
  s_mov_b32 s18, -1
  s_mov_b32 s19, 0
  s_mov_b32 s16, 1
  s_mov_b32 s17, 0
  s_add_u32 m0, s73, 73728
  s_add_u32 s75, s69, 110592
  buffer_load_dwordx4 v3, s[28:31], s75 offen offset:0 lds
  buffer_load_dwordx4 v4, s[28:31], s75 offen offset:1024 lds
  buffer_load_dwordx4 v5, s[28:31], s75 offen offset:2048 lds
  s_waitcnt vmcnt(3)
  s_barrier
  ds_read_b128 a[224:227], v6 offset:0
  ds_read_b64_tr_b16 a[200:201], v10 offset:0
  ds_read_b64_tr_b16 a[202:203], v10 offset:1536
  ds_read_b128 a[228:231], v6 offset:4096
  ds_read_b128 a[232:235], v6 offset:8192
  ds_read_b128 a[236:239], v6 offset:12288
  ds_read_b64_tr_b16 a[204:205], v12 offset:0
  ds_read_b64_tr_b16 a[206:207], v12 offset:1536
  ds_read_b64_tr_b16 a[208:209], v14 offset:0
  ds_read_b64_tr_b16 a[210:211], v14 offset:1536
  s_waitcnt lgkmcnt(7)
  v_mfma_f32_32x32x16_bf16 v[64:79], a[200:203], a[224:227], 0
  ds_read_b128 a[240:243], v7 offset:0
  s_add_u32 m0, s73, 86016
  s_add_u32 s75, s69, 165888
  buffer_load_dwordx4 v3, s[28:31], s75 offen offset:0 lds
  s_waitcnt lgkmcnt(7)
  v_mfma_f32_32x32x16_bf16 v[112:127], a[200:203], a[228:231], 0
  ds_read_b64_tr_b16 a[212:213], v10 offset:12288
  buffer_load_dwordx4 v4, s[28:31], s75 offen offset:1024 lds
  s_waitcnt lgkmcnt(7)
  v_mfma_f32_32x32x16_bf16 v[160:175], a[200:203], a[232:235], 0
  ds_read_b64_tr_b16 a[214:215], v10 offset:13824
  s_waitcnt lgkmcnt(7)
  v_mfma_f32_32x32x16_bf16 v[208:223], a[200:203], a[236:239], 0
  ds_read_b128 a[244:247], v7 offset:4096
  buffer_load_dwordx4 v5, s[28:31], s75 offen offset:2048 lds
  v_mfma_f32_16x16x32_bf16 a[68:71], a[64:67], a[200:203], 0
  ds_read_b128 a[248:251], v7 offset:8192
  s_waitcnt lgkmcnt(7)
  v_mfma_f32_32x32x16_bf16 v[80:95], a[204:207], a[224:227], 0
  ds_read_b128 a[252:255], v7 offset:12288
  s_add_u32 s71, s71, 128
  s_cmp_ge_u32 s71, s72
  s_cselect_b32 s79, 1280, 0
  s_sub_u32 s71, s71, s79
  s_add_u32 m0, s74, 16384
  s_add_u32 s75, s71, 0
  buffer_load_dwordx4 v2, s[24:27], s75 offen lds
  v_mfma_f32_32x32x16_bf16 v[128:143], a[204:207], a[228:231], 0
  ds_read_b64_tr_b16 a[216:217], v12 offset:12288
  v_mfma_f32_32x32x16_bf16 v[176:191], a[204:207], a[232:235], 0
  ds_read_b64_tr_b16 a[218:219], v12 offset:13824
  s_add_u32 m0, s74, 20480
  s_add_u32 s75, s71, 40960
  buffer_load_dwordx4 v2, s[24:27], s75 offen lds
  v_mfma_f32_32x32x16_bf16 v[224:239], a[204:207], a[236:239], 0
  ds_read_b64_tr_b16 a[220:221], v14 offset:12288
  v_mfma_f32_16x16x32_bf16 a[72:75], a[64:67], a[204:207], 0
  ds_read_b64_tr_b16 a[222:223], v14 offset:13824
  s_add_u32 m0, s74, 24576
  s_add_u32 s75, s71, 81920
  buffer_load_dwordx4 v2, s[24:27], s75 offen lds
  s_waitcnt lgkmcnt(10)
  v_mfma_f32_32x32x16_bf16 v[96:111], a[208:211], a[224:227], 0
  s_add_u32 m0, s74, 28672
  s_add_u32 s75, s71, 122880
  buffer_load_dwordx4 v2, s[24:27], s75 offen lds
  v_mfma_f32_32x32x16_bf16 v[144:159], a[208:211], a[228:231], 0
  v_mfma_f32_32x32x16_bf16 v[192:207], a[208:211], a[232:235], 0
  s_add_u32 s69, s69, 221184
  s_cmp_ge_u32 s69, s70
  s_cselect_b32 s79, 2211840, 0
  s_sub_u32 s69, s69, s79
  s_add_u32 m0, s73, 98304
  s_add_u32 s75, s69, 0
  buffer_load_dwordx4 v3, s[28:31], s75 offen offset:0 lds
  v_mfma_f32_32x32x16_bf16 v[240:255], a[208:211], a[236:239], 0
  v_mfma_f32_16x16x32_bf16 a[76:79], a[64:67], a[208:211], 0
  buffer_load_dwordx4 v4, s[28:31], s75 offen offset:1024 lds
  s_waitcnt vmcnt(9)
  s_barrier
  s_waitcnt lgkmcnt(7)
  v_mfma_f32_32x32x16_bf16 v[64:79], a[212:215], a[240:243], v[64:79]
  ds_read_b128 a[224:227], v8 offset:0
  s_waitcnt lgkmcnt(7)
  v_mfma_f32_32x32x16_bf16 v[112:127], a[212:215], a[244:247], v[112:127]
  ds_read_b64_tr_b16 a[200:201], v10 offset:24576
  buffer_load_dwordx4 v5, s[28:31], s75 offen offset:2048 lds
  s_waitcnt lgkmcnt(7)
  v_mfma_f32_32x32x16_bf16 v[160:175], a[212:215], a[248:251], v[160:175]
  ds_read_b64_tr_b16 a[202:203], v10 offset:26112
  s_waitcnt lgkmcnt(7)
  v_mfma_f32_32x32x16_bf16 v[208:223], a[212:215], a[252:255], v[208:223]
  ds_read_b128 a[228:231], v8 offset:4096
  s_add_u32 m0, s73, 110592
  s_add_u32 s75, s69, 55296
  buffer_load_dwordx4 v3, s[28:31], s75 offen offset:0 lds
  v_mfma_f32_16x16x32_bf16 a[68:71], a[64:67], a[212:215], a[68:71]
  ds_read_b128 a[232:235], v8 offset:8192
  buffer_load_dwordx4 v4, s[28:31], s75 offen offset:1024 lds
  s_waitcnt lgkmcnt(7)
  v_mfma_f32_32x32x16_bf16 v[80:95], a[216:219], a[240:243], v[80:95]
  ds_read_b128 a[236:239], v8 offset:12288
  v_mfma_f32_32x32x16_bf16 v[128:143], a[216:219], a[244:247], v[128:143]
  ds_read_b64_tr_b16 a[204:205], v12 offset:24576
  buffer_load_dwordx4 v5, s[28:31], s75 offen offset:2048 lds
  v_mfma_f32_32x32x16_bf16 v[176:191], a[216:219], a[248:251], v[176:191]
  ds_read_b64_tr_b16 a[206:207], v12 offset:26112
  v_mfma_f32_32x32x16_bf16 v[224:239], a[216:219], a[252:255], v[224:239]
  ds_read_b64_tr_b16 a[208:209], v14 offset:24576
  s_add_u32 m0, s73, 122880
  s_add_u32 s75, s69, 110592
  buffer_load_dwordx4 v3, s[28:31], s75 offen offset:0 lds
  v_mfma_f32_16x16x32_bf16 a[72:75], a[64:67], a[216:219], a[72:75]
  ds_read_b64_tr_b16 a[210:211], v14 offset:26112
  s_waitcnt lgkmcnt(10)
  v_mfma_f32_32x32x16_bf16 v[96:111], a[220:223], a[240:243], v[96:111]
  buffer_load_dwordx4 v4, s[28:31], s75 offen offset:1024 lds
  v_mfma_f32_32x32x16_bf16 v[144:159], a[220:223], a[244:247], v[144:159]
  v_mfma_f32_32x32x16_bf16 v[192:207], a[220:223], a[248:251], v[192:207]
  buffer_load_dwordx4 v5, s[28:31], s75 offen offset:2048 lds
  v_mfma_f32_32x32x16_bf16 v[240:255], a[220:223], a[252:255], v[240:255]
  v_mfma_f32_16x16x32_bf16 a[76:79], a[64:67], a[220:223], a[76:79]
  s_add_u32 s71, s71, 128
  s_cmp_ge_u32 s71, s72
  s_cselect_b32 s79, 1280, 0
  s_sub_u32 s71, s71, s79
  s_add_u32 m0, s74, 32768
  s_add_u32 s75, s71, 0
  buffer_load_dwordx4 v2, s[24:27], s75 offen lds
  s_waitcnt vmcnt(7)
  s_barrier
  s_waitcnt lgkmcnt(7)
  v_mfma_f32_32x32x16_bf16 v[64:79], a[200:203], a[224:227], v[64:79]
  ds_read_b128 a[240:243], v9 offset:0
  s_add_u32 m0, s74, 36864
  s_add_u32 s75, s71, 40960
  buffer_load_dwordx4 v2, s[24:27], s75 offen lds
  s_waitcnt lgkmcnt(7)
  v_mfma_f32_32x32x16_bf16 v[112:127], a[200:203], a[228:231], v[112:127]
  ds_read_b64_tr_b16 a[212:213], v10 offset:36864
  s_waitcnt lgkmcnt(7)
  v_mfma_f32_32x32x16_bf16 v[160:175], a[200:203], a[232:235], v[160:175]
  ds_read_b64_tr_b16 a[214:215], v10 offset:38400
  s_add_u32 m0, s74, 40960
  s_add_u32 s75, s71, 81920
  buffer_load_dwordx4 v2, s[24:27], s75 offen lds
  s_waitcnt lgkmcnt(7)
  v_mfma_f32_32x32x16_bf16 v[208:223], a[200:203], a[236:239], v[208:223]
  ds_read_b128 a[244:247], v9 offset:4096
  v_mfma_f32_16x16x32_bf16 a[68:71], a[64:67], a[200:203], a[68:71]
  ds_read_b128 a[248:251], v9 offset:8192
  s_add_u32 m0, s74, 45056
  s_add_u32 s75, s71, 122880
  buffer_load_dwordx4 v2, s[24:27], s75 offen lds
  s_waitcnt lgkmcnt(7)
  v_mfma_f32_32x32x16_bf16 v[80:95], a[204:207], a[224:227], v[80:95]
  ds_read_b128 a[252:255], v9 offset:12288
  v_mfma_f32_32x32x16_bf16 v[128:143], a[204:207], a[228:231], v[128:143]
  ds_read_b64_tr_b16 a[216:217], v12 offset:36864
  s_add_u32 m0, s73, 135168
  s_add_u32 s75, s69, 165888
  buffer_load_dwordx4 v3, s[28:31], s75 offen offset:0 lds
  v_mfma_f32_32x32x16_bf16 v[176:191], a[204:207], a[232:235], v[176:191]
  ds_read_b64_tr_b16 a[218:219], v12 offset:38400
  v_mfma_f32_32x32x16_bf16 v[224:239], a[204:207], a[236:239], v[224:239]
  ds_read_b64_tr_b16 a[220:221], v14 offset:36864
  buffer_load_dwordx4 v4, s[28:31], s75 offen offset:1024 lds
  v_mfma_f32_16x16x32_bf16 a[72:75], a[64:67], a[204:207], a[72:75]
  ds_read_b64_tr_b16 a[222:223], v14 offset:38400
  s_waitcnt lgkmcnt(10)
  v_mfma_f32_32x32x16_bf16 v[96:111], a[208:211], a[224:227], v[96:111]
  buffer_load_dwordx4 v5, s[28:31], s75 offen offset:2048 lds
  s_add_u32 s69, s69, 221184
  s_cmp_ge_u32 s69, s70
  s_cselect_b32 s79, 2211840, 0
  s_sub_u32 s69, s69, s79
  s_add_u32 m0, s73, 49152
  s_add_u32 s75, s69, 0
  buffer_load_dwordx4 v3, s[28:31], s75 offen offset:0 lds
  v_mfma_f32_32x32x16_bf16 v[144:159], a[208:211], a[228:231], v[144:159]
  v_mfma_f32_32x32x16_bf16 v[192:207], a[208:211], a[232:235], v[192:207]
  buffer_load_dwordx4 v4, s[28:31], s75 offen offset:1024 lds
  v_mfma_f32_32x32x16_bf16 v[240:255], a[208:211], a[236:239], v[240:255]
  v_mfma_f32_16x16x32_bf16 a[76:79], a[64:67], a[208:211], a[76:79]
  buffer_load_dwordx4 v5, s[28:31], s75 offen offset:2048 lds
  s_waitcnt lgkmcnt(7)
  v_mfma_f32_32x32x16_bf16 v[64:79], a[212:215], a[240:243], v[64:79]
  ds_read_b128 a[224:227], v6 offset:16384
  s_waitcnt lgkmcnt(7)
  v_mfma_f32_32x32x16_bf16 v[112:127], a[212:215], a[244:247], v[112:127]
  ds_read_b64_tr_b16 a[200:201], v10 offset:49152
  s_waitcnt lgkmcnt(7)
  v_mfma_f32_32x32x16_bf16 v[160:175], a[212:215], a[248:251], v[160:175]
  ds_read_b64_tr_b16 a[202:203], v10 offset:50688
  s_add_u32 m0, s73, 61440
  s_add_u32 s75, s69, 55296
  buffer_load_dwordx4 v3, s[28:31], s75 offen offset:0 lds
  s_waitcnt lgkmcnt(7)
  v_mfma_f32_32x32x16_bf16 v[208:223], a[212:215], a[252:255], v[208:223]
  ds_read_b128 a[228:231], v6 offset:20480
  v_mfma_f32_16x16x32_bf16 a[68:71], a[64:67], a[212:215], a[68:71]
  ds_read_b128 a[232:235], v6 offset:24576
  buffer_load_dwordx4 v4, s[28:31], s75 offen offset:1024 lds
  s_waitcnt lgkmcnt(7)
  v_mfma_f32_32x32x16_bf16 v[80:95], a[216:219], a[240:243], v[80:95]
  ds_read_b128 a[236:239], v6 offset:28672
  v_mfma_f32_32x32x16_bf16 v[128:143], a[216:219], a[244:247], v[128:143]
  ds_read_b64_tr_b16 a[204:205], v12 offset:49152
  buffer_load_dwordx4 v5, s[28:31], s75 offen offset:2048 lds
  v_mfma_f32_32x32x16_bf16 v[176:191], a[216:219], a[248:251], v[176:191]
  ds_read_b64_tr_b16 a[206:207], v12 offset:50688
  v_mfma_f32_32x32x16_bf16 v[224:239], a[216:219], a[252:255], v[224:239]
  ds_read_b64_tr_b16 a[208:209], v14 offset:49152
  v_mfma_f32_16x16x32_bf16 a[72:75], a[64:67], a[216:219], a[72:75]
  ds_read_b64_tr_b16 a[210:211], v14 offset:50688
  s_waitcnt lgkmcnt(10)
  v_mfma_f32_32x32x16_bf16 v[96:111], a[220:223], a[240:243], v[96:111]
  v_mfma_f32_32x32x16_bf16 v[144:159], a[220:223], a[244:247], v[144:159]
  v_mfma_f32_32x32x16_bf16 v[192:207], a[220:223], a[248:251], v[192:207]
  v_mfma_f32_32x32x16_bf16 v[240:255], a[220:223], a[252:255], v[240:255]
  v_mfma_f32_16x16x32_bf16 a[76:79], a[64:67], a[220:223], a[76:79]
  s_waitcnt vmcnt(13)
  s_barrier
  s_waitcnt lgkmcnt(7)
  v_mfma_f32_32x32x16_bf16 v[64:79], a[200:203], a[224:227], v[64:79]
  ds_read_b128 a[240:243], v7 offset:16384
  s_add_u32 m0, s73, 73728
  s_add_u32 s75, s69, 110592
  buffer_load_dwordx4 v3, s[28:31], s75 offen offset:0 lds
  s_waitcnt lgkmcnt(7)
  v_mfma_f32_32x32x16_bf16 v[112:127], a[200:203], a[228:231], v[112:127]
  ds_read_b64_tr_b16 a[212:213], v11 offset:0
  buffer_load_dwordx4 v4, s[28:31], s75 offen offset:1024 lds
  s_waitcnt lgkmcnt(7)
  v_mfma_f32_32x32x16_bf16 v[160:175], a[200:203], a[232:235], v[160:175]
  ds_read_b64_tr_b16 a[214:215], v11 offset:1536
  s_waitcnt lgkmcnt(7)
  v_mfma_f32_32x32x16_bf16 v[208:223], a[200:203], a[236:239], v[208:223]
  ds_read_b128 a[244:247], v7 offset:20480
  buffer_load_dwordx4 v5, s[28:31], s75 offen offset:2048 lds
  v_mfma_f32_16x16x32_bf16 a[68:71], a[64:67], a[200:203], a[68:71]
  ds_read_b128 a[248:251], v7 offset:24576
  s_add_u32 m0, s73, 86016
  s_add_u32 s75, s69, 165888
  buffer_load_dwordx4 v3, s[28:31], s75 offen offset:0 lds
  s_waitcnt lgkmcnt(7)
  v_mfma_f32_32x32x16_bf16 v[80:95], a[204:207], a[224:227], v[80:95]
  ds_read_b128 a[252:255], v7 offset:28672
  v_mfma_f32_32x32x16_bf16 v[128:143], a[204:207], a[228:231], v[128:143]
  ds_read_b64_tr_b16 a[216:217], v13 offset:0
  buffer_load_dwordx4 v4, s[28:31], s75 offen offset:1024 lds
  v_mfma_f32_32x32x16_bf16 v[176:191], a[204:207], a[232:235], v[176:191]
  ds_read_b64_tr_b16 a[218:219], v13 offset:1536
  v_mfma_f32_32x32x16_bf16 v[224:239], a[204:207], a[236:239], v[224:239]
  ds_read_b64_tr_b16 a[220:221], v15 offset:0
  buffer_load_dwordx4 v5, s[28:31], s75 offen offset:2048 lds
  v_mfma_f32_16x16x32_bf16 a[72:75], a[64:67], a[204:207], a[72:75]
  ds_read_b64_tr_b16 a[222:223], v15 offset:1536
  s_add_u32 s71, s71, 128
  s_cmp_ge_u32 s71, s72
  s_cselect_b32 s79, 1280, 0
  s_sub_u32 s71, s71, s79
  s_add_u32 m0, s74, 0
  s_add_u32 s75, s71, 0
  buffer_load_dwordx4 v2, s[24:27], s75 offen lds
  s_waitcnt lgkmcnt(10)
  v_mfma_f32_32x32x16_bf16 v[96:111], a[208:211], a[224:227], v[96:111]
  v_mfma_f32_32x32x16_bf16 v[144:159], a[208:211], a[228:231], v[144:159]
  s_add_u32 m0, s74, 4096
  s_add_u32 s75, s71, 40960
  buffer_load_dwordx4 v2, s[24:27], s75 offen lds
  v_mfma_f32_32x32x16_bf16 v[192:207], a[208:211], a[232:235], v[192:207]
  buffer_load_dwordx4 v[24:27], v37, s[52:55], 0 offen
  v_mfma_f32_32x32x16_bf16 v[240:255], a[208:211], a[236:239], v[240:255]
  v_mfma_f32_16x16x32_bf16 a[76:79], a[64:67], a[208:211], a[76:79]
  buffer_load_dwordx4 v[28:31], v37, s[52:55], 0 offen offset:512
  s_waitcnt lgkmcnt(7)
  v_mfma_f32_32x32x16_bf16 v[64:79], a[212:215], a[240:243], v[64:79]
  ds_read_b128 a[224:227], v8 offset:16384
  s_lshl_b32 s76, s83, 2
  s_mul_hi_u32 s77, s76, 0x33333334
  s_mul_i32 s78, s77, 5
  s_waitcnt lgkmcnt(7)
  v_mfma_f32_32x32x16_bf16 v[112:127], a[212:215], a[244:247], v[112:127]
  ds_read_b64_tr_b16 a[200:201], v11 offset:12288
  buffer_load_dwordx4 v[32:35], v38, s[52:55], 0 offen
  s_sub_u32 s78, s76, s78
  s_mul_i32 s77, s77, 74
  s_waitcnt lgkmcnt(7)
  v_mfma_f32_32x32x16_bf16 v[160:175], a[212:215], a[248:251], v[160:175]
  ds_read_b64_tr_b16 a[202:203], v11 offset:13824
  v_accvgpr_read_b32 v46, a128
  s_lshl_b32 s75, s64, 12
  s_add_u32 m0, s75, 147456
  s_nop 0
  buffer_load_dwordx4 v46, s[56:59], 0 offen nt lds
  s_waitcnt lgkmcnt(7)
  v_mfma_f32_32x32x16_bf16 v[208:223], a[212:215], a[252:255], v[208:223]
  ds_read_b128 a[228:231], v8 offset:20480
  s_add_u32 s77, s77, s82
  s_mul_i32 s77, s77, 5120
  s_lshl_b32 s76, s78, 10
  v_mfma_f32_16x16x32_bf16 a[68:71], a[64:67], a[212:215], a[68:71]
  ds_read_b128 a[232:235], v8 offset:24576
  v_accvgpr_read_b32 v47, a129
  s_lshl_b32 s75, s64, 12
  s_add_u32 m0, s75, 148480
  s_nop 0
  buffer_load_dwordx4 v47, s[56:59], 0 offen nt lds
  s_waitcnt lgkmcnt(7)
  v_mfma_f32_32x32x16_bf16 v[80:95], a[216:219], a[240:243], v[80:95]
  ds_read_b128 a[236:239], v8 offset:28672
  v_accvgpr_read_b32 v46, a130
  s_lshl_b32 s75, s64, 12
  s_add_u32 m0, s75, 149504
  s_nop 0
  buffer_load_dwordx4 v46, s[56:59], 0 offen nt lds
  v_mfma_f32_32x32x16_bf16 v[128:143], a[216:219], a[244:247], v[128:143]
  ds_read_b64_tr_b16 a[204:205], v13 offset:12288
  s_add_u32 s77, s77, s76
  s_add_u32 s6, s77, 2621440
  s_cmp_ge_u32 s82, 74
  s_cselect_b32 s6, 1073741824, s6
  v_mfma_f32_32x32x16_bf16 v[176:191], a[216:219], a[248:251], v[176:191]
  ds_read_b64_tr_b16 a[206:207], v13 offset:13824
  v_accvgpr_read_b32 v47, a131
  s_lshl_b32 s75, s64, 12
  s_add_u32 m0, s75, 150528
  s_nop 0
  buffer_load_dwordx4 v47, s[56:59], 0 offen nt lds
  v_mfma_f32_32x32x16_bf16 v[224:239], a[216:219], a[252:255], v[224:239]
  ds_read_b64_tr_b16 a[208:209], v15 offset:12288
  s_cmp_eq_u32 s78, 4
  s_cselect_b32 s76, 373760, 0
  s_add_u32 s7, s6, s76
  v_mfma_f32_16x16x32_bf16 a[72:75], a[64:67], a[216:219], a[72:75]
  ds_read_b64_tr_b16 a[210:211], v15 offset:13824
  s_waitcnt lgkmcnt(10)
  v_mfma_f32_32x32x16_bf16 v[96:111], a[220:223], a[240:243], v[96:111]
  s_cmp_eq_u32 s78, 3
  s_cselect_b32 s76, 373760, 0
  s_add_u32 s10, s7, s76
  s_cmp_eq_u32 s78, 2
  s_cselect_b32 s76, 373760, 0
  s_add_u32 s11, s10, s76
  v_mfma_f32_32x32x16_bf16 v[144:159], a[220:223], a[244:247], v[144:159]
  v_mfma_f32_32x32x16_bf16 v[192:207], a[220:223], a[248:251], v[192:207]
  v_mfma_f32_32x32x16_bf16 v[240:255], a[220:223], a[252:255], v[240:255]
  v_mfma_f32_16x16x32_bf16 a[76:79], a[64:67], a[220:223], a[76:79]
  s_waitcnt vmcnt(18)
  s_barrier
  s_waitcnt lgkmcnt(7)
  v_mfma_f32_32x32x16_bf16 v[64:79], a[200:203], a[224:227], v[64:79]
  ds_read_b128 a[240:243], v9 offset:16384
  s_add_u32 s69, s69, 221184
  s_cmp_ge_u32 s69, s70
  s_cselect_b32 s79, 2211840, 0
  s_sub_u32 s69, s69, s79
  s_add_u32 m0, s73, 98304
  s_add_u32 s75, s69, 0
  buffer_load_dwordx4 v3, s[28:31], s75 offen offset:0 lds
  s_waitcnt lgkmcnt(7)
  v_mfma_f32_32x32x16_bf16 v[112:127], a[200:203], a[228:231], v[112:127]
  ds_read_b64_tr_b16 a[212:213], v11 offset:24576
  s_waitcnt lgkmcnt(7)
  v_mfma_f32_32x32x16_bf16 v[160:175], a[200:203], a[232:235], v[160:175]
  ds_read_b64_tr_b16 a[214:215], v11 offset:26112
  s_waitcnt lgkmcnt(7)
  v_mfma_f32_32x32x16_bf16 v[208:223], a[200:203], a[236:239], v[208:223]
  ds_read_b128 a[244:247], v9 offset:20480
  buffer_load_dwordx4 v4, s[28:31], s75 offen offset:1024 lds
  v_mfma_f32_16x16x32_bf16 a[68:71], a[64:67], a[200:203], a[68:71]
  ds_read_b128 a[248:251], v9 offset:24576
  s_waitcnt lgkmcnt(7)
  v_mfma_f32_32x32x16_bf16 v[80:95], a[204:207], a[224:227], v[80:95]
  ds_read_b128 a[252:255], v9 offset:28672
  v_mfma_f32_32x32x16_bf16 v[128:143], a[204:207], a[228:231], v[128:143]
  ds_read_b64_tr_b16 a[216:217], v13 offset:24576
  buffer_load_dwordx4 v5, s[28:31], s75 offen offset:2048 lds
  v_mfma_f32_32x32x16_bf16 v[176:191], a[204:207], a[232:235], v[176:191]
  ds_read_b64_tr_b16 a[218:219], v13 offset:26112
  v_mfma_f32_32x32x16_bf16 v[224:239], a[204:207], a[236:239], v[224:239]
  ds_read_b64_tr_b16 a[220:221], v15 offset:24576
  v_mfma_f32_16x16x32_bf16 a[72:75], a[64:67], a[204:207], a[72:75]
  ds_read_b64_tr_b16 a[222:223], v15 offset:26112
  s_add_u32 m0, s73, 110592
  s_add_u32 s75, s69, 55296
  buffer_load_dwordx4 v3, s[28:31], s75 offen offset:0 lds
  s_waitcnt lgkmcnt(10)
  v_mfma_f32_32x32x16_bf16 v[96:111], a[208:211], a[224:227], v[96:111]
  v_mfma_f32_32x32x16_bf16 v[144:159], a[208:211], a[228:231], v[144:159]
  v_mfma_f32_32x32x16_bf16 v[192:207], a[208:211], a[232:235], v[192:207]
  buffer_load_dwordx4 v4, s[28:31], s75 offen offset:1024 lds
  v_mfma_f32_32x32x16_bf16 v[240:255], a[208:211], a[236:239], v[240:255]
  v_mfma_f32_16x16x32_bf16 a[76:79], a[64:67], a[208:211], a[76:79]
  s_waitcnt lgkmcnt(7)
  v_mfma_f32_32x32x16_bf16 v[64:79], a[212:215], a[240:243], v[64:79]
  ds_read_b128 a[224:227], v6 offset:32768
  buffer_load_dwordx4 v5, s[28:31], s75 offen offset:2048 lds
  s_waitcnt lgkmcnt(7)
  v_mfma_f32_32x32x16_bf16 v[112:127], a[212:215], a[244:247], v[112:127]
  ds_read_b64_tr_b16 a[200:201], v10 offset:0
  s_waitcnt lgkmcnt(7)
  v_mfma_f32_32x32x16_bf16 v[160:175], a[212:215], a[248:251], v[160:175]
  ds_read_b64_tr_b16 a[202:203], v10 offset:1536
  s_waitcnt lgkmcnt(7)
  v_mfma_f32_32x32x16_bf16 v[208:223], a[212:215], a[252:255], v[208:223]
  ds_read_b128 a[228:231], v6 offset:36864
  s_add_u32 m0, s74, 8192
  s_add_u32 s75, s71, 81920
  buffer_load_dwordx4 v2, s[24:27], s75 offen lds
  v_mfma_f32_16x16x32_bf16 a[68:71], a[64:67], a[212:215], a[68:71]
  ds_read_b128 a[232:235], v6 offset:40960
  s_waitcnt lgkmcnt(7)
  v_mfma_f32_32x32x16_bf16 v[80:95], a[216:219], a[240:243], v[80:95]
  ds_read_b128 a[236:239], v6 offset:45056
  v_mfma_f32_32x32x16_bf16 v[128:143], a[216:219], a[244:247], v[128:143]
  ds_read_b64_tr_b16 a[204:205], v12 offset:0
  s_add_u32 m0, s74, 12288
  s_add_u32 s75, s71, 122880
  buffer_load_dwordx4 v2, s[24:27], s75 offen lds
  v_mfma_f32_32x32x16_bf16 v[176:191], a[216:219], a[248:251], v[176:191]
  ds_read_b64_tr_b16 a[206:207], v12 offset:1536
  v_mfma_f32_32x32x16_bf16 v[224:239], a[216:219], a[252:255], v[224:239]
  ds_read_b64_tr_b16 a[208:209], v14 offset:0
  v_mfma_f32_16x16x32_bf16 a[72:75], a[64:67], a[216:219], a[72:75]
  ds_read_b64_tr_b16 a[210:211], v14 offset:1536
  s_waitcnt lgkmcnt(10)
  v_mfma_f32_32x32x16_bf16 v[96:111], a[220:223], a[240:243], v[96:111]
  v_mfma_f32_32x32x16_bf16 v[144:159], a[220:223], a[244:247], v[144:159]
  v_mfma_f32_32x32x16_bf16 v[192:207], a[220:223], a[248:251], v[192:207]
  v_mfma_f32_32x32x16_bf16 v[240:255], a[220:223], a[252:255], v[240:255]
  v_mfma_f32_16x16x32_bf16 a[76:79], a[64:67], a[220:223], a[76:79]
  s_waitcnt vmcnt(20)
  s_barrier
  s_waitcnt lgkmcnt(7)
  v_mfma_f32_32x32x16_bf16 v[64:79], a[200:203], a[224:227], v[64:79]
  ds_read_b128 a[240:243], v7 offset:32768
  s_add_u32 m0, s73, 122880
  s_add_u32 s75, s69, 110592
  buffer_load_dwordx4 v3, s[28:31], s75 offen offset:0 lds
  s_waitcnt lgkmcnt(7)
  v_mfma_f32_32x32x16_bf16 v[112:127], a[200:203], a[228:231], v[112:127]
  ds_read_b64_tr_b16 a[212:213], v10 offset:12288
  v_mov_b32 v58, 0
  s_cmp_eq_u32 s64, 0
  s_cselect_b32 s80, 0, 1073741824
  buffer_load_dword v59, v58, s[48:51], s80 offen sc1
  s_waitcnt lgkmcnt(7)
  v_mfma_f32_32x32x16_bf16 v[160:175], a[200:203], a[232:235], v[160:175]
  ds_read_b64_tr_b16 a[214:215], v10 offset:13824
  s_waitcnt lgkmcnt(7)
  v_mfma_f32_32x32x16_bf16 v[208:223], a[200:203], a[236:239], v[208:223]
  ds_read_b128 a[244:247], v7 offset:36864
  buffer_load_dwordx4 v4, s[28:31], s75 offen offset:1024 lds
  s_waitcnt lgkmcnt(6)
  v_mfma_f32_32x32x16_bf16 v[80:95], a[204:207], a[224:227], v[80:95]
  ds_read_b128 a[248:251], v7 offset:40960
  v_mfma_f32_32x32x16_bf16 v[128:143], a[204:207], a[228:231], v[128:143]
  ds_read_b128 a[252:255], v7 offset:45056
  v_mfma_f32_32x32x16_bf16 v[176:191], a[204:207], a[232:235], v[176:191]
  ds_read_b64_tr_b16 a[216:217], v12 offset:12288
  buffer_load_dwordx4 v5, s[28:31], s75 offen offset:2048 lds
  v_mfma_f32_32x32x16_bf16 v[224:239], a[204:207], a[236:239], v[224:239]
  ds_read_b64_tr_b16 a[218:219], v12 offset:13824
  s_waitcnt lgkmcnt(8)
  v_mfma_f32_32x32x16_bf16 v[96:111], a[208:211], a[224:227], v[96:111]
  ds_read_b64_tr_b16 a[220:221], v14 offset:12288
  v_mfma_f32_32x32x16_bf16 v[144:159], a[208:211], a[228:231], v[144:159]
  ds_read_b64_tr_b16 a[222:223], v14 offset:13824
  s_add_u32 m0, s73, 135168
  s_add_u32 s75, s69, 165888
  buffer_load_dwordx4 v3, s[28:31], s75 offen offset:0 lds
  v_mfma_f32_32x32x16_bf16 v[192:207], a[208:211], a[232:235], v[192:207]
  v_mfma_f32_32x32x16_bf16 v[240:255], a[208:211], a[236:239], v[240:255]
  s_waitcnt lgkmcnt(7)
  v_mfma_f32_32x32x16_bf16 v[64:79], a[212:215], a[240:243], v[64:79]
  ds_read_b128 a[224:227], v8 offset:32768
  buffer_load_dwordx4 v4, s[28:31], s75 offen offset:1024 lds
  s_waitcnt lgkmcnt(7)
  v_mfma_f32_32x32x16_bf16 v[112:127], a[212:215], a[244:247], v[112:127]
  ds_read_b64_tr_b16 a[200:201], v10 offset:24576
  s_waitcnt lgkmcnt(7)
  v_mfma_f32_32x32x16_bf16 v[160:175], a[212:215], a[248:251], v[160:175]
  ds_read_b64_tr_b16 a[202:203], v10 offset:26112
  s_waitcnt lgkmcnt(7)
  v_mfma_f32_32x32x16_bf16 v[208:223], a[212:215], a[252:255], v[208:223]
  ds_read_b128 a[228:231], v8 offset:36864
  buffer_load_dwordx4 v5, s[28:31], s75 offen offset:2048 lds
  s_waitcnt lgkmcnt(6)
  v_mfma_f32_32x32x16_bf16 v[80:95], a[216:219], a[240:243], v[80:95]
  ds_read_b128 a[232:235], v8 offset:40960
  v_mfma_f32_32x32x16_bf16 v[128:143], a[216:219], a[244:247], v[128:143]
  ds_read_b128 a[236:239], v8 offset:45056
  v_mfma_f32_32x32x16_bf16 v[176:191], a[216:219], a[248:251], v[176:191]
  ds_read_b64_tr_b16 a[204:205], v12 offset:24576
  s_add_u32 s71, s71, 128
  s_cmp_ge_u32 s71, s72
  s_cselect_b32 s79, 1280, 0
  s_sub_u32 s71, s71, s79
  s_add_u32 m0, s74, 16384
  s_add_u32 s75, s71, 0
  buffer_load_dwordx4 v2, s[24:27], s75 offen lds
  v_mfma_f32_32x32x16_bf16 v[224:239], a[216:219], a[252:255], v[224:239]
  ds_read_b64_tr_b16 a[206:207], v12 offset:26112
  s_waitcnt lgkmcnt(8)
  v_mfma_f32_32x32x16_bf16 v[96:111], a[220:223], a[240:243], v[96:111]
  ds_read_b64_tr_b16 a[208:209], v14 offset:24576
  v_mfma_f32_32x32x16_bf16 v[144:159], a[220:223], a[244:247], v[144:159]
  ds_read_b64_tr_b16 a[210:211], v14 offset:26112
  s_add_u32 m0, s74, 20480
  s_add_u32 s75, s71, 40960
  buffer_load_dwordx4 v2, s[24:27], s75 offen lds
  v_mfma_f32_32x32x16_bf16 v[192:207], a[220:223], a[248:251], v[192:207]
  v_mfma_f32_32x32x16_bf16 v[240:255], a[220:223], a[252:255], v[240:255]
  s_waitcnt vmcnt(9)
  s_barrier
  s_waitcnt lgkmcnt(7)
  v_mfma_f32_32x32x16_bf16 v[64:79], a[200:203], a[224:227], v[64:79]
  ds_read_b128 a[240:243], v9 offset:32768
  s_add_u32 s69, s69, 221184
  s_cmp_ge_u32 s69, s70
  s_cselect_b32 s79, 2211840, 0
  s_sub_u32 s69, s69, s79
  s_add_u32 m0, s73, 49152
  s_add_u32 s75, s69, 0
  buffer_load_dwordx4 v3, s[28:31], s75 offen offset:0 lds
  s_waitcnt lgkmcnt(7)
  v_mfma_f32_32x32x16_bf16 v[112:127], a[200:203], a[228:231], v[112:127]
  ds_read_b64_tr_b16 a[212:213], v10 offset:36864
  ds_read_b64_tr_b16 a[132:133], v19 offset:0
  ds_read_b64_tr_b16 a[134:135], v19 offset:512
  s_waitcnt lgkmcnt(9)
  v_mfma_f32_32x32x16_bf16 v[160:175], a[200:203], a[232:235], v[160:175]
  ds_read_b64_tr_b16 a[214:215], v10 offset:38400
  ds_read_b64_tr_b16 a[136:137], v19 offset:32
  ds_read_b64_tr_b16 a[138:139], v19 offset:544
  s_waitcnt lgkmcnt(11)
  v_mfma_f32_32x32x16_bf16 v[208:223], a[200:203], a[236:239], v[208:223]
  ds_read_b128 a[244:247], v9 offset:36864
  buffer_load_dwordx4 v4, s[28:31], s75 offen offset:1024 lds
  s_waitcnt lgkmcnt(10)
  v_mfma_f32_32x32x16_bf16 v[80:95], a[204:207], a[224:227], v[80:95]
  ds_read_b128 a[248:251], v9 offset:40960
  ds_read_b64_tr_b16 a[140:141], v19 offset:64
  v_mfma_f32_32x32x16_bf16 v[128:143], a[204:207], a[228:231], v[128:143]
  ds_read_b128 a[252:255], v9 offset:45056
  ds_read_b64_tr_b16 a[142:143], v19 offset:576
  v_mfma_f32_32x32x16_bf16 v[176:191], a[204:207], a[232:235], v[176:191]
  ds_read_b64_tr_b16 a[216:217], v12 offset:36864
  buffer_load_dwordx4 v5, s[28:31], s75 offen offset:2048 lds
  ds_read_b64_tr_b16 a[144:145], v19 offset:96
  v_mfma_f32_32x32x16_bf16 v[224:239], a[204:207], a[236:239], v[224:239]
  ds_read_b64_tr_b16 a[218:219], v12 offset:38400
  ds_read_b64_tr_b16 a[146:147], v19 offset:608
  s_waitcnt lgkmcnt(15)
  v_mfma_f32_32x32x16_bf16 v[96:111], a[208:211], a[224:227], v[96:111]
  ds_read_b64_tr_b16 a[220:221], v14 offset:36864
  v_mfma_f32_32x32x16_bf16 v[144:159], a[208:211], a[228:231], v[144:159]
  ds_read_b64_tr_b16 a[222:223], v14 offset:38400
  s_add_u32 m0, s73, 61440
  s_add_u32 s75, s69, 55296
  buffer_load_dwordx4 v3, s[28:31], s75 offen offset:0 lds
  v_mfma_f32_32x32x16_bf16 v[192:207], a[208:211], a[232:235], v[192:207]
  s_waitcnt lgkmcnt(14)
  buffer_store_dwordx4 a[132:135], v20, s[40:43], s6 offen offset:0 sc1
  s_waitcnt lgkmcnt(11)
  buffer_store_dwordx4 a[136:139], v20, s[40:43], s7 offen offset:1024 sc1
  s_waitcnt lgkmcnt(6)
  buffer_store_dwordx4 a[140:143], v20, s[40:43], s10 offen offset:2048 sc1
  v_mfma_f32_32x32x16_bf16 v[240:255], a[208:211], a[236:239], v[240:255]
  s_waitcnt lgkmcnt(2)
  buffer_store_dwordx4 a[144:147], v20, s[40:43], s11 offen offset:3072 sc1
  v_lshlrev_b32 v62, 2, v1
  s_add_u32 s80, s68, s3
  s_lshl_b32 s80, s80, 7
  v_mfma_f32_32x32x16_bf16 v[64:79], a[212:215], a[240:243], v[64:79]
  ds_read_b128 a[224:227], v6 offset:0
  buffer_load_dwordx4 v4, s[28:31], s75 offen offset:1024 lds
  v_mfma_f32_32x32x16_bf16 v[112:127], a[212:215], a[244:247], v[112:127]
  ds_read_b64_tr_b16 a[200:201], v10 offset:49152
  buffer_store_dword a68, v62, s[36:39], s80 offen offset:0 sc1
  buffer_store_dword a72, v62, s[36:39], s80 offen offset:1280 sc1
  v_mfma_f32_32x32x16_bf16 v[160:175], a[212:215], a[248:251], v[160:175]
  ds_read_b64_tr_b16 a[202:203], v10 offset:50688
  buffer_store_dword a76, v62, s[36:39], s80 offen offset:2560 sc1
  v_accvgpr_write_b32 a148, 0
  v_accvgpr_write_b32 a149, 0
  v_mfma_f32_32x32x16_bf16 v[208:223], a[212:215], a[252:255], v[208:223]
  ds_read_b128 a[228:231], v6 offset:4096
  buffer_load_dwordx4 v5, s[28:31], s75 offen offset:2048 lds
  v_accvgpr_write_b32 a150, 0
  v_mfma_f32_32x32x16_bf16 v[80:95], a[216:219], a[240:243], v[80:95]
  ds_read_b128 a[232:235], v6 offset:8192
  v_accvgpr_write_b32 a151, 0
  s_mul_i32 s80, s2, 10240
  s_lshl_b32 s78, s64, 10
  v_mfma_f32_32x32x16_bf16 v[128:143], a[216:219], a[244:247], v[128:143]
  ds_read_b128 a[236:239], v6 offset:12288
  s_add_u32 s80, s80, s78
  buffer_store_dwordx4 a[148:151], v20, s[40:43], s80 offen sc1
  v_mfma_f32_32x32x16_bf16 v[176:191], a[216:219], a[248:251], v[176:191]
  ds_read_b64_tr_b16 a[204:205], v12 offset:49152
  s_add_u32 m0, s74, 24576
  s_add_u32 s75, s71, 81920
  buffer_load_dwordx4 v2, s[24:27], s75 offen lds
  v_mfma_f32_32x32x16_bf16 v[224:239], a[216:219], a[252:255], v[224:239]
  ds_read_b64_tr_b16 a[206:207], v12 offset:50688
  s_add_u32 s80, s80, 4096
  buffer_store_dwordx4 a[148:151], v20, s[40:43], s80 offen sc1
  s_waitcnt lgkmcnt(8)
  v_mfma_f32_32x32x16_bf16 v[96:111], a[220:223], a[240:243], v[96:111]
  ds_read_b64_tr_b16 a[208:209], v14 offset:49152
  s_add_u32 s80, s80, 4096
  s_cmp_ge_u32 s64, 2
  s_cselect_b32 s80, 1073741824, s80
  v_mfma_f32_32x32x16_bf16 v[144:159], a[220:223], a[244:247], v[144:159]
  ds_read_b64_tr_b16 a[210:211], v14 offset:50688
  s_add_u32 m0, s74, 28672
  s_add_u32 s75, s71, 122880
  buffer_load_dwordx4 v2, s[24:27], s75 offen lds
  v_mfma_f32_32x32x16_bf16 v[192:207], a[220:223], a[248:251], v[192:207]
  buffer_store_dwordx4 a[148:151], v20, s[40:43], s80 offen sc1
  s_mov_b32 s76, 0x3f803f80
  v_mov_b32 v62, 0
  v_mov_b32 v63, 0
  v_mov_b32 v36, 0
  v_mfma_f32_32x32x16_bf16 v[240:255], a[220:223], a[252:255], v[240:255]
  v_mov_b32 v37, 0
  v_dot2_f32_bf16 v62, v24, s76, v62
  v_dot2_f32_bf16 v63, v24, v24, v63
  v_dot2_f32_bf16 v36, v25, s76, v36
  v_dot2_f32_bf16 v37, v25, v25, v37
  v_dot2_f32_bf16 v62, v26, s76, v62
  s_waitcnt vmcnt(23)
  s_barrier
  s_waitcnt lgkmcnt(7)
  v_mfma_f32_32x32x16_bf16 v[64:79], a[200:203], a[224:227], v[64:79]
  ds_read_b128 a[240:243], v7 offset:0
  s_add_u32 m0, s73, 73728
  s_add_u32 s75, s69, 110592
  buffer_load_dwordx4 v3, s[28:31], s75 offen offset:0 lds
  s_waitcnt lgkmcnt(7)
  v_mfma_f32_32x32x16_bf16 v[112:127], a[200:203], a[228:231], v[112:127]
  ds_read_b64_tr_b16 a[212:213], v11 offset:0
  v_dot2_f32_bf16 v63, v26, v26, v63
  v_dot2_f32_bf16 v36, v27, s76, v36
  v_dot2_f32_bf16 v37, v27, v27, v37
  v_dot2_f32_bf16 v62, v28, s76, v62
  s_waitcnt lgkmcnt(7)
  v_mfma_f32_32x32x16_bf16 v[160:175], a[200:203], a[232:235], v[160:175]
  ds_read_b64_tr_b16 a[214:215], v11 offset:1536
  v_dot2_f32_bf16 v63, v28, v28, v63
  v_dot2_f32_bf16 v36, v29, s76, v36
  v_dot2_f32_bf16 v37, v29, v29, v37
  v_dot2_f32_bf16 v62, v30, s76, v62
  s_waitcnt lgkmcnt(7)
  v_mfma_f32_32x32x16_bf16 v[208:223], a[200:203], a[236:239], v[208:223]
  ds_read_b128 a[244:247], v7 offset:4096
  buffer_load_dwordx4 v4, s[28:31], s75 offen offset:1024 lds
  v_dot2_f32_bf16 v63, v30, v30, v63
  s_waitcnt lgkmcnt(6)
  v_mfma_f32_32x32x16_bf16 v[80:95], a[204:207], a[224:227], v[80:95]
  ds_read_b128 a[248:251], v7 offset:8192
  v_dot2_f32_bf16 v36, v31, s76, v36
  v_dot2_f32_bf16 v37, v31, v31, v37
  v_dot2_f32_bf16 v62, v32, s76, v62
  v_mfma_f32_32x32x16_bf16 v[128:143], a[204:207], a[228:231], v[128:143]
  ds_read_b128 a[252:255], v7 offset:12288
  v_dot2_f32_bf16 v63, v32, v32, v63
  v_dot2_f32_bf16 v36, v33, s76, v36
  v_dot2_f32_bf16 v37, v33, v33, v37
  v_mfma_f32_32x32x16_bf16 v[176:191], a[204:207], a[232:235], v[176:191]
  ds_read_b64_tr_b16 a[216:217], v13 offset:0
  buffer_load_dwordx4 v5, s[28:31], s75 offen offset:2048 lds
  v_dot2_f32_bf16 v62, v34, s76, v62
  v_dot2_f32_bf16 v63, v34, v34, v63
  v_mfma_f32_32x32x16_bf16 v[224:239], a[204:207], a[236:239], v[224:239]
  ds_read_b64_tr_b16 a[218:219], v13 offset:1536
  v_dot2_f32_bf16 v36, v35, s76, v36
  v_dot2_f32_bf16 v37, v35, v35, v37
  s_waitcnt lgkmcnt(8)
  v_mfma_f32_32x32x16_bf16 v[96:111], a[208:211], a[224:227], v[96:111]
  ds_read_b64_tr_b16 a[220:221], v15 offset:0
  v_mfma_f32_32x32x16_bf16 v[144:159], a[208:211], a[228:231], v[144:159]
  ds_read_b64_tr_b16 a[222:223], v15 offset:1536
  s_add_u32 m0, s73, 86016
  s_add_u32 s75, s69, 165888
  buffer_load_dwordx4 v3, s[28:31], s75 offen offset:0 lds
  v_mfma_f32_32x32x16_bf16 v[192:207], a[208:211], a[232:235], v[192:207]
  v_pk_add_f32 v[62:63], v[62:63], v[36:37]
  v_mfma_f32_32x32x16_bf16 v[240:255], a[208:211], a[236:239], v[240:255]
  s_waitcnt lgkmcnt(7)
  v_mfma_f32_32x32x16_bf16 v[64:79], a[212:215], a[240:243], v[64:79]
  ds_read_b128 a[224:227], v8 offset:0
  buffer_load_dwordx4 v4, s[28:31], s75 offen offset:1024 lds
  v_add_f32_dpp v62, v62, v62 row_ror:8 row_mask:0xf bank_mask:0xf
  s_waitcnt lgkmcnt(7)
  v_mfma_f32_32x32x16_bf16 v[112:127], a[212:215], a[244:247], v[112:127]
  ds_read_b64_tr_b16 a[200:201], v11 offset:12288
  v_add_f32_dpp v63, v63, v63 row_ror:8 row_mask:0xf bank_mask:0xf
  v_add_f32_dpp v62, v62, v62 row_ror:4 row_mask:0xf bank_mask:0xf
  s_waitcnt lgkmcnt(7)
  v_mfma_f32_32x32x16_bf16 v[160:175], a[212:215], a[248:251], v[160:175]
  ds_read_b64_tr_b16 a[202:203], v11 offset:13824
  v_add_f32_dpp v63, v63, v63 row_ror:4 row_mask:0xf bank_mask:0xf
  v_add_f32_dpp v62, v62, v62 row_ror:2 row_mask:0xf bank_mask:0xf
  s_waitcnt lgkmcnt(7)
  v_mfma_f32_32x32x16_bf16 v[208:223], a[212:215], a[252:255], v[208:223]
  ds_read_b128 a[228:231], v8 offset:4096
  buffer_load_dwordx4 v5, s[28:31], s75 offen offset:2048 lds
  v_add_f32_dpp v63, v63, v63 row_ror:2 row_mask:0xf bank_mask:0xf
  s_waitcnt lgkmcnt(6)
  v_mfma_f32_32x32x16_bf16 v[80:95], a[216:219], a[240:243], v[80:95]
  ds_read_b128 a[232:235], v8 offset:8192
  v_add_f32_dpp v62, v62, v62 row_ror:1 row_mask:0xf bank_mask:0xf
  v_add_f32_dpp v63, v63, v63 row_ror:1 row_mask:0xf bank_mask:0xf
  v_mov_b32 v36, v62
  v_mfma_f32_32x32x16_bf16 v[128:143], a[216:219], a[244:247], v[128:143]
  ds_read_b128 a[236:239], v8 offset:12288
  v_mov_b32 v37, v63
  v_permlane16_swap_b32 v62, v36
  v_mfma_f32_32x32x16_bf16 v[176:191], a[216:219], a[248:251], v[176:191]
  ds_read_b64_tr_b16 a[204:205], v13 offset:12288
  s_add_u32 s71, s71, 128
  s_cmp_ge_u32 s71, s72
  s_cselect_b32 s79, 1280, 0
  s_sub_u32 s71, s71, s79
  s_add_u32 m0, s74, 32768
  s_add_u32 s75, s71, 0
  buffer_load_dwordx4 v2, s[24:27], s75 offen lds
  v_mfma_f32_32x32x16_bf16 v[224:239], a[216:219], a[252:255], v[224:239]
  ds_read_b64_tr_b16 a[206:207], v13 offset:13824
  v_permlane16_swap_b32 v63, v37
  v_pk_add_f32 v[62:63], v[62:63], v[36:37]
  v_mul_f32 v62, 0x3acccccd, v62
  v_mul_f32 v63, 0x3acccccd, v63
  s_waitcnt lgkmcnt(8)
  v_mfma_f32_32x32x16_bf16 v[96:111], a[220:223], a[240:243], v[96:111]
  ds_read_b64_tr_b16 a[208:209], v15 offset:12288
  v_fma_f32 v63, -v62, v62, v63
  v_max_f32 v63, 0, v63
  v_add_f32 v63, 0x3727c5ac, v63
  v_mfma_f32_32x32x16_bf16 v[144:159], a[220:223], a[244:247], v[144:159]
  ds_read_b64_tr_b16 a[210:211], v15 offset:13824
  s_add_u32 m0, s74, 36864
  s_add_u32 s75, s71, 40960
  buffer_load_dwordx4 v2, s[24:27], s75 offen lds
  v_mfma_f32_32x32x16_bf16 v[192:207], a[220:223], a[248:251], v[192:207]
  v_rsq_f32 v63, v63
  v_lshlrev_b32 v24, 3, v60
  v_and_b32 v25, 31, v1
  v_cmp_eq_u32 vcc, 0, v25
  v_mov_b32 v25, 1073741824
  v_mfma_f32_32x32x16_bf16 v[240:255], a[220:223], a[252:255], v[240:255]
  v_cndmask_b32 v24, v25, v24, vcc
  buffer_store_dwordx2 v[62:63], v24, s[32:35], 0 offen sc1
  s_waitcnt vmcnt(10)
  s_barrier
  s_waitcnt lgkmcnt(7)
  v_mfma_f32_32x32x16_bf16 v[64:79], a[200:203], a[224:227], v[64:79]
  ds_read_b128 a[240:243], v9 offset:0
  s_add_u32 s69, s69, 221184
  s_cmp_ge_u32 s69, s70
  s_cselect_b32 s79, 2211840, 0
  s_sub_u32 s69, s69, s79
  s_add_u32 m0, s73, 98304
  s_add_u32 s75, s69, 0
  buffer_load_dwordx4 v3, s[28:31], s75 offen offset:0 lds
  s_waitcnt lgkmcnt(7)
  v_mfma_f32_32x32x16_bf16 v[112:127], a[200:203], a[228:231], v[112:127]
  ds_read_b64_tr_b16 a[212:213], v11 offset:24576
  s_waitcnt lgkmcnt(7)
  v_mfma_f32_32x32x16_bf16 v[160:175], a[200:203], a[232:235], v[160:175]
  ds_read_b64_tr_b16 a[214:215], v11 offset:26112
  s_waitcnt lgkmcnt(7)
  v_mfma_f32_32x32x16_bf16 v[208:223], a[200:203], a[236:239], v[208:223]
  ds_read_b128 a[244:247], v9 offset:4096
  buffer_load_dwordx4 v4, s[28:31], s75 offen offset:1024 lds
  s_waitcnt lgkmcnt(6)
  v_mfma_f32_32x32x16_bf16 v[80:95], a[204:207], a[224:227], v[80:95]
  ds_read_b128 a[248:251], v9 offset:8192
  v_mfma_f32_32x32x16_bf16 v[128:143], a[204:207], a[228:231], v[128:143]
  ds_read_b128 a[252:255], v9 offset:12288
  v_mfma_f32_32x32x16_bf16 v[176:191], a[204:207], a[232:235], v[176:191]
  ds_read_b64_tr_b16 a[216:217], v13 offset:24576
  buffer_load_dwordx4 v5, s[28:31], s75 offen offset:2048 lds
  v_mfma_f32_32x32x16_bf16 v[224:239], a[204:207], a[236:239], v[224:239]
  ds_read_b64_tr_b16 a[218:219], v13 offset:26112
  s_waitcnt lgkmcnt(8)
  v_mfma_f32_32x32x16_bf16 v[96:111], a[208:211], a[224:227], v[96:111]
  ds_read_b64_tr_b16 a[220:221], v15 offset:24576
  v_mfma_f32_32x32x16_bf16 v[144:159], a[208:211], a[228:231], v[144:159]
  ds_read_b64_tr_b16 a[222:223], v15 offset:26112
  s_add_u32 m0, s73, 110592
  s_add_u32 s75, s69, 55296
  buffer_load_dwordx4 v3, s[28:31], s75 offen offset:0 lds
  v_mfma_f32_32x32x16_bf16 v[192:207], a[208:211], a[232:235], v[192:207]
  v_mfma_f32_32x32x16_bf16 v[240:255], a[208:211], a[236:239], v[240:255]
  s_waitcnt lgkmcnt(7)
  v_mfma_f32_32x32x16_bf16 v[64:79], a[212:215], a[240:243], v[64:79]
  ds_read_b128 a[224:227], v6 offset:16384
  buffer_load_dwordx4 v4, s[28:31], s75 offen offset:1024 lds
  s_waitcnt lgkmcnt(7)
  v_mfma_f32_32x32x16_bf16 v[112:127], a[212:215], a[244:247], v[112:127]
  ds_read_b64_tr_b16 a[200:201], v10 offset:0
  s_waitcnt lgkmcnt(7)
  v_mfma_f32_32x32x16_bf16 v[160:175], a[212:215], a[248:251], v[160:175]
  ds_read_b64_tr_b16 a[202:203], v10 offset:1536
  s_waitcnt lgkmcnt(7)
  v_mfma_f32_32x32x16_bf16 v[208:223], a[212:215], a[252:255], v[208:223]
  ds_read_b128 a[228:231], v6 offset:20480
  buffer_load_dwordx4 v5, s[28:31], s75 offen offset:2048 lds
  s_waitcnt lgkmcnt(6)
  v_mfma_f32_32x32x16_bf16 v[80:95], a[216:219], a[240:243], v[80:95]
  ds_read_b128 a[232:235], v6 offset:24576
  v_mfma_f32_32x32x16_bf16 v[128:143], a[216:219], a[244:247], v[128:143]
  ds_read_b128 a[236:239], v6 offset:28672
  v_mfma_f32_32x32x16_bf16 v[176:191], a[216:219], a[248:251], v[176:191]
  ds_read_b64_tr_b16 a[204:205], v12 offset:0
  s_add_u32 m0, s74, 40960
  s_add_u32 s75, s71, 81920
  buffer_load_dwordx4 v2, s[24:27], s75 offen lds
  v_mfma_f32_32x32x16_bf16 v[224:239], a[216:219], a[252:255], v[224:239]
  ds_read_b64_tr_b16 a[206:207], v12 offset:1536
  s_waitcnt lgkmcnt(8)
  v_mfma_f32_32x32x16_bf16 v[96:111], a[220:223], a[240:243], v[96:111]
  ds_read_b64_tr_b16 a[208:209], v14 offset:0
  v_mfma_f32_32x32x16_bf16 v[144:159], a[220:223], a[244:247], v[144:159]
  ds_read_b64_tr_b16 a[210:211], v14 offset:1536
  s_add_u32 m0, s74, 45056
  s_add_u32 s75, s71, 122880
  buffer_load_dwordx4 v2, s[24:27], s75 offen lds
  v_mfma_f32_32x32x16_bf16 v[192:207], a[220:223], a[248:251], v[192:207]
  v_mfma_f32_32x32x16_bf16 v[240:255], a[220:223], a[252:255], v[240:255]
  s_waitcnt vmcnt(8)
  s_cmp_eq_u32 s64, 0
  s_cselect_b64 s[76:77], -1, 0
  v_cmp_ne_u32 vcc, 1, v59
  s_and_b64 vcc, vcc, s[76:77]
  s_cbranch_vccnz L_zspin_ffn
L_zspin_ffn_go:
  s_barrier
  s_waitcnt lgkmcnt(7)
  v_mfma_f32_32x32x16_bf16 v[64:79], a[200:203], a[224:227], v[64:79]
  ds_read_b128 a[240:243], v7 offset:16384
  s_add_u32 m0, s73, 122880
  s_add_u32 s75, s69, 110592
  buffer_load_dwordx4 v3, s[28:31], s75 offen offset:0 lds
  s_waitcnt lgkmcnt(7)
  v_mfma_f32_32x32x16_bf16 v[112:127], a[200:203], a[228:231], v[112:127]
  ds_read_b64_tr_b16 a[212:213], v10 offset:12288
  s_lshl_b32 s80, s2, 2
  s_add_u32 s80, s80, 4096
  v_cmp_eq_u32 vcc, 0, v1
  v_mov_b32 v62, 1073741824
  s_waitcnt lgkmcnt(7)
  v_mfma_f32_32x32x16_bf16 v[160:175], a[200:203], a[232:235], v[160:175]
  ds_read_b64_tr_b16 a[214:215], v10 offset:13824
  v_cndmask_b32 v62, v62, 0, vcc
  v_mov_b32 v63, 1
  s_waitcnt lgkmcnt(7)
  v_mfma_f32_32x32x16_bf16 v[208:223], a[200:203], a[236:239], v[208:223]
  ds_read_b128 a[244:247], v7 offset:20480
  buffer_load_dwordx4 v4, s[28:31], s75 offen offset:1024 lds
  s_waitcnt lgkmcnt(6)
  v_mfma_f32_32x32x16_bf16 v[80:95], a[204:207], a[224:227], v[80:95]
  ds_read_b128 a[248:251], v7 offset:24576
  s_cmp_eq_u32 s64, 0
  s_cselect_b32 s79, s80, 1073741824
  buffer_store_dword v63, v62, s[44:47], s79 offen sc1
  v_mfma_f32_32x32x16_bf16 v[128:143], a[204:207], a[228:231], v[128:143]
  ds_read_b128 a[252:255], v7 offset:28672
  v_mfma_f32_32x32x16_bf16 v[176:191], a[204:207], a[232:235], v[176:191]
  ds_read_b64_tr_b16 a[216:217], v12 offset:12288
  buffer_load_dwordx4 v5, s[28:31], s75 offen offset:2048 lds
  v_mfma_f32_32x32x16_bf16 v[224:239], a[204:207], a[236:239], v[224:239]
  ds_read_b64_tr_b16 a[218:219], v12 offset:13824
  s_waitcnt lgkmcnt(8)
  v_mfma_f32_32x32x16_bf16 v[96:111], a[208:211], a[224:227], v[96:111]
  ds_read_b64_tr_b16 a[220:221], v14 offset:12288
  v_mfma_f32_32x32x16_bf16 v[144:159], a[208:211], a[228:231], v[144:159]
  ds_read_b64_tr_b16 a[222:223], v14 offset:13824
  s_add_u32 m0, s73, 135168
  s_add_u32 s75, s69, 165888
  buffer_load_dwordx4 v3, s[28:31], s75 offen offset:0 lds
  v_mfma_f32_32x32x16_bf16 v[192:207], a[208:211], a[232:235], v[192:207]
  v_mfma_f32_32x32x16_bf16 v[240:255], a[208:211], a[236:239], v[240:255]
  s_waitcnt lgkmcnt(7)
  v_mfma_f32_32x32x16_bf16 v[64:79], a[212:215], a[240:243], v[64:79]
  ds_read_b128 a[224:227], v8 offset:16384
  buffer_load_dwordx4 v4, s[28:31], s75 offen offset:1024 lds
  s_waitcnt lgkmcnt(7)
  v_mfma_f32_32x32x16_bf16 v[112:127], a[212:215], a[244:247], v[112:127]
  ds_read_b64_tr_b16 a[200:201], v10 offset:24576
  s_waitcnt lgkmcnt(7)
  v_mfma_f32_32x32x16_bf16 v[160:175], a[212:215], a[248:251], v[160:175]
  ds_read_b64_tr_b16 a[202:203], v10 offset:26112
  s_waitcnt lgkmcnt(7)
  v_mfma_f32_32x32x16_bf16 v[208:223], a[212:215], a[252:255], v[208:223]
  ds_read_b128 a[228:231], v8 offset:20480
  buffer_load_dwordx4 v5, s[28:31], s75 offen offset:2048 lds
  s_waitcnt lgkmcnt(6)
  v_mfma_f32_32x32x16_bf16 v[80:95], a[216:219], a[240:243], v[80:95]
  ds_read_b128 a[232:235], v8 offset:24576
  v_mfma_f32_32x32x16_bf16 v[128:143], a[216:219], a[244:247], v[128:143]
  ds_read_b128 a[236:239], v8 offset:28672
  v_mfma_f32_32x32x16_bf16 v[176:191], a[216:219], a[248:251], v[176:191]
  ds_read_b64_tr_b16 a[204:205], v12 offset:24576
  s_add_u32 s71, s71, 128
  s_cmp_ge_u32 s71, s72
  s_cselect_b32 s79, 1280, 0
  s_sub_u32 s71, s71, s79
  s_add_u32 m0, s74, 0
  s_add_u32 s75, s71, 0
  buffer_load_dwordx4 v2, s[24:27], s75 offen lds
  v_mfma_f32_32x32x16_bf16 v[224:239], a[216:219], a[252:255], v[224:239]
  ds_read_b64_tr_b16 a[206:207], v12 offset:26112
  s_waitcnt lgkmcnt(8)
  v_mfma_f32_32x32x16_bf16 v[96:111], a[220:223], a[240:243], v[96:111]
  ds_read_b64_tr_b16 a[208:209], v14 offset:24576
  v_mfma_f32_32x32x16_bf16 v[144:159], a[220:223], a[244:247], v[144:159]
  ds_read_b64_tr_b16 a[210:211], v14 offset:26112
  s_add_u32 m0, s74, 4096
  s_add_u32 s75, s71, 40960
  buffer_load_dwordx4 v2, s[24:27], s75 offen lds
  v_mfma_f32_32x32x16_bf16 v[192:207], a[220:223], a[248:251], v[192:207]
  v_mfma_f32_32x32x16_bf16 v[240:255], a[220:223], a[252:255], v[240:255]
  s_waitcnt vmcnt(9)
  s_barrier
  s_waitcnt lgkmcnt(7)
  v_mfma_f32_32x32x16_bf16 v[64:79], a[200:203], a[224:227], v[64:79]
  ds_read_b128 a[240:243], v9 offset:16384
  s_add_u32 s69, s69, 221184
  s_cmp_ge_u32 s69, s70
  s_cselect_b32 s79, 2211840, 0
  s_sub_u32 s69, s69, s79
  s_add_u32 m0, s73, 49152
  s_add_u32 s75, s69, 0
  buffer_load_dwordx4 v3, s[28:31], s75 offen offset:0 lds
  s_waitcnt lgkmcnt(7)
  v_mfma_f32_32x32x16_bf16 v[112:127], a[200:203], a[228:231], v[112:127]
  ds_read_b64_tr_b16 a[212:213], v10 offset:36864
  s_waitcnt lgkmcnt(7)
  v_mfma_f32_32x32x16_bf16 v[160:175], a[200:203], a[232:235], v[160:175]
  ds_read_b64_tr_b16 a[214:215], v10 offset:38400
  s_waitcnt lgkmcnt(7)
  v_mfma_f32_32x32x16_bf16 v[208:223], a[200:203], a[236:239], v[208:223]
  ds_read_b128 a[244:247], v9 offset:20480
  buffer_load_dwordx4 v4, s[28:31], s75 offen offset:1024 lds
  s_waitcnt lgkmcnt(6)
  v_mfma_f32_32x32x16_bf16 v[80:95], a[204:207], a[224:227], v[80:95]
  ds_read_b128 a[248:251], v9 offset:24576
  v_mfma_f32_32x32x16_bf16 v[128:143], a[204:207], a[228:231], v[128:143]
  ds_read_b128 a[252:255], v9 offset:28672
  v_mfma_f32_32x32x16_bf16 v[176:191], a[204:207], a[232:235], v[176:191]
  ds_read_b64_tr_b16 a[216:217], v12 offset:36864
  buffer_load_dwordx4 v5, s[28:31], s75 offen offset:2048 lds
  v_mfma_f32_32x32x16_bf16 v[224:239], a[204:207], a[236:239], v[224:239]
  ds_read_b64_tr_b16 a[218:219], v12 offset:38400
  s_waitcnt lgkmcnt(8)
  v_mfma_f32_32x32x16_bf16 v[96:111], a[208:211], a[224:227], v[96:111]
  ds_read_b64_tr_b16 a[220:221], v14 offset:36864
  v_mfma_f32_32x32x16_bf16 v[144:159], a[208:211], a[228:231], v[144:159]
  ds_read_b64_tr_b16 a[222:223], v14 offset:38400
  s_add_u32 m0, s73, 61440
  s_add_u32 s75, s69, 55296
  buffer_load_dwordx4 v3, s[28:31], s75 offen offset:0 lds
  v_mfma_f32_32x32x16_bf16 v[192:207], a[208:211], a[232:235], v[192:207]
  v_mfma_f32_32x32x16_bf16 v[240:255], a[208:211], a[236:239], v[240:255]
  s_waitcnt lgkmcnt(7)
  v_mfma_f32_32x32x16_bf16 v[64:79], a[212:215], a[240:243], v[64:79]
  ds_read_b128 a[224:227], v6 offset:32768
  buffer_load_dwordx4 v4, s[28:31], s75 offen offset:1024 lds
  s_waitcnt lgkmcnt(7)
  v_mfma_f32_32x32x16_bf16 v[112:127], a[212:215], a[244:247], v[112:127]
  ds_read_b64_tr_b16 a[200:201], v10 offset:49152
  s_waitcnt lgkmcnt(7)
  v_mfma_f32_32x32x16_bf16 v[160:175], a[212:215], a[248:251], v[160:175]
  ds_read_b64_tr_b16 a[202:203], v10 offset:50688
  s_waitcnt lgkmcnt(7)
  v_mfma_f32_32x32x16_bf16 v[208:223], a[212:215], a[252:255], v[208:223]
  ds_read_b128 a[228:231], v6 offset:36864
  buffer_load_dwordx4 v5, s[28:31], s75 offen offset:2048 lds
  s_waitcnt lgkmcnt(6)
  v_mfma_f32_32x32x16_bf16 v[80:95], a[216:219], a[240:243], v[80:95]
  ds_read_b128 a[232:235], v6 offset:40960
  v_mfma_f32_32x32x16_bf16 v[128:143], a[216:219], a[244:247], v[128:143]
  ds_read_b128 a[236:239], v6 offset:45056
  v_mfma_f32_32x32x16_bf16 v[176:191], a[216:219], a[248:251], v[176:191]
  ds_read_b64_tr_b16 a[204:205], v12 offset:49152
  s_add_u32 m0, s74, 8192
  s_add_u32 s75, s71, 81920
  buffer_load_dwordx4 v2, s[24:27], s75 offen lds
  v_mfma_f32_32x32x16_bf16 v[224:239], a[216:219], a[252:255], v[224:239]
  ds_read_b64_tr_b16 a[206:207], v12 offset:50688
  s_waitcnt lgkmcnt(8)
  v_mfma_f32_32x32x16_bf16 v[96:111], a[220:223], a[240:243], v[96:111]
  ds_read_b64_tr_b16 a[208:209], v14 offset:49152
  v_mfma_f32_32x32x16_bf16 v[144:159], a[220:223], a[244:247], v[144:159]
  ds_read_b64_tr_b16 a[210:211], v14 offset:50688
  s_add_u32 m0, s74, 12288
  s_add_u32 s75, s71, 122880
  buffer_load_dwordx4 v2, s[24:27], s75 offen lds
  v_mfma_f32_32x32x16_bf16 v[192:207], a[220:223], a[248:251], v[192:207]
  v_mfma_f32_32x32x16_bf16 v[240:255], a[220:223], a[252:255], v[240:255]
  s_waitcnt vmcnt(13)
  s_barrier
  s_waitcnt lgkmcnt(7)
  v_mfma_f32_32x32x16_bf16 v[64:79], a[200:203], a[224:227], v[64:79]
  ds_read_b128 a[240:243], v7 offset:32768
  s_add_u32 m0, s73, 73728
  s_add_u32 s75, s69, 110592
  buffer_load_dwordx4 v3, s[28:31], s75 offen offset:0 lds
  s_waitcnt lgkmcnt(7)
  v_mfma_f32_32x32x16_bf16 v[112:127], a[200:203], a[228:231], v[112:127]
  ds_read_b64_tr_b16 a[212:213], v11 offset:0
  s_waitcnt lgkmcnt(7)
  v_mfma_f32_32x32x16_bf16 v[160:175], a[200:203], a[232:235], v[160:175]
  ds_read_b64_tr_b16 a[214:215], v11 offset:1536
  s_waitcnt lgkmcnt(7)
  v_mfma_f32_32x32x16_bf16 v[208:223], a[200:203], a[236:239], v[208:223]
  ds_read_b128 a[244:247], v7 offset:36864
  buffer_load_dwordx4 v4, s[28:31], s75 offen offset:1024 lds
  s_waitcnt lgkmcnt(6)
  v_mfma_f32_32x32x16_bf16 v[80:95], a[204:207], a[224:227], v[80:95]
  ds_read_b128 a[248:251], v7 offset:40960
  v_mfma_f32_32x32x16_bf16 v[128:143], a[204:207], a[228:231], v[128:143]
  ds_read_b128 a[252:255], v7 offset:45056
  v_mfma_f32_32x32x16_bf16 v[176:191], a[204:207], a[232:235], v[176:191]
  ds_read_b64_tr_b16 a[216:217], v13 offset:0
  buffer_load_dwordx4 v5, s[28:31], s75 offen offset:2048 lds
  v_mfma_f32_32x32x16_bf16 v[224:239], a[204:207], a[236:239], v[224:239]
  ds_read_b64_tr_b16 a[218:219], v13 offset:1536
  s_waitcnt lgkmcnt(8)
  v_mfma_f32_32x32x16_bf16 v[96:111], a[208:211], a[224:227], v[96:111]
  ds_read_b64_tr_b16 a[220:221], v15 offset:0
  v_mfma_f32_32x32x16_bf16 v[144:159], a[208:211], a[228:231], v[144:159]
  ds_read_b64_tr_b16 a[222:223], v15 offset:1536
  s_add_u32 m0, s73, 86016
  s_add_u32 s75, s69, 165888
  buffer_load_dwordx4 v3, s[28:31], s75 offen offset:0 lds
  v_mfma_f32_32x32x16_bf16 v[192:207], a[208:211], a[232:235], v[192:207]
  v_mfma_f32_32x32x16_bf16 v[240:255], a[208:211], a[236:239], v[240:255]
  s_waitcnt lgkmcnt(7)
  v_mfma_f32_32x32x16_bf16 v[64:79], a[212:215], a[240:243], v[64:79]
  ds_read_b128 a[224:227], v8 offset:32768
  buffer_load_dwordx4 v4, s[28:31], s75 offen offset:1024 lds
  s_waitcnt lgkmcnt(7)
  v_mfma_f32_32x32x16_bf16 v[112:127], a[212:215], a[244:247], v[112:127]
  ds_read_b64_tr_b16 a[200:201], v11 offset:12288
  s_waitcnt lgkmcnt(7)
  v_mfma_f32_32x32x16_bf16 v[160:175], a[212:215], a[248:251], v[160:175]
  ds_read_b64_tr_b16 a[202:203], v11 offset:13824
  s_waitcnt lgkmcnt(7)
  v_mfma_f32_32x32x16_bf16 v[208:223], a[212:215], a[252:255], v[208:223]
  ds_read_b128 a[228:231], v8 offset:36864
  buffer_load_dwordx4 v5, s[28:31], s75 offen offset:2048 lds
  s_waitcnt lgkmcnt(6)
  v_mfma_f32_32x32x16_bf16 v[80:95], a[216:219], a[240:243], v[80:95]
  ds_read_b128 a[232:235], v8 offset:40960
  v_mfma_f32_32x32x16_bf16 v[128:143], a[216:219], a[244:247], v[128:143]
  ds_read_b128 a[236:239], v8 offset:45056
  v_mfma_f32_32x32x16_bf16 v[176:191], a[216:219], a[248:251], v[176:191]
  ds_read_b64_tr_b16 a[204:205], v13 offset:12288
  s_add_u32 s71, s71, 128
  s_cmp_ge_u32 s71, s72
  s_cselect_b32 s79, 1280, 0
  s_sub_u32 s71, s71, s79
  s_add_u32 m0, s74, 16384
  s_add_u32 s75, s71, 0
  buffer_load_dwordx4 v2, s[24:27], s75 offen lds
  v_mfma_f32_32x32x16_bf16 v[224:239], a[216:219], a[252:255], v[224:239]
  ds_read_b64_tr_b16 a[206:207], v13 offset:13824
  s_waitcnt lgkmcnt(8)
  v_mfma_f32_32x32x16_bf16 v[96:111], a[220:223], a[240:243], v[96:111]
  ds_read_b64_tr_b16 a[208:209], v15 offset:12288
  v_mfma_f32_32x32x16_bf16 v[144:159], a[220:223], a[244:247], v[144:159]
  ds_read_b64_tr_b16 a[210:211], v15 offset:13824
  s_add_u32 m0, s74, 20480
  s_add_u32 s75, s71, 40960
  buffer_load_dwordx4 v2, s[24:27], s75 offen lds
  v_mfma_f32_32x32x16_bf16 v[192:207], a[220:223], a[248:251], v[192:207]
  v_mfma_f32_32x32x16_bf16 v[240:255], a[220:223], a[252:255], v[240:255]
  s_waitcnt vmcnt(8)
  s_barrier
  s_waitcnt lgkmcnt(7)
  v_mfma_f32_32x32x16_bf16 v[64:79], a[200:203], a[224:227], v[64:79]
  ds_read_b128 a[240:243], v9 offset:32768
  s_add_u32 s69, s69, 221184
  s_cmp_ge_u32 s69, s70
  s_cselect_b32 s79, 2211840, 0
  s_sub_u32 s69, s69, s79
  s_add_u32 m0, s73, 98304
  s_add_u32 s75, s69, 0
  buffer_load_dwordx4 v3, s[28:31], s75 offen offset:0 lds
  s_waitcnt lgkmcnt(7)
  v_mfma_f32_32x32x16_bf16 v[112:127], a[200:203], a[228:231], v[112:127]
  ds_read_b64_tr_b16 a[212:213], v11 offset:24576
  s_waitcnt lgkmcnt(7)
  v_mfma_f32_32x32x16_bf16 v[160:175], a[200:203], a[232:235], v[160:175]
  ds_read_b64_tr_b16 a[214:215], v11 offset:26112
  s_waitcnt lgkmcnt(7)
  v_mfma_f32_32x32x16_bf16 v[208:223], a[200:203], a[236:239], v[208:223]
  ds_read_b128 a[244:247], v9 offset:36864
  buffer_load_dwordx4 v4, s[28:31], s75 offen offset:1024 lds
  s_waitcnt lgkmcnt(6)
  v_mfma_f32_32x32x16_bf16 v[80:95], a[204:207], a[224:227], v[80:95]
  ds_read_b128 a[248:251], v9 offset:40960
  v_mfma_f32_32x32x16_bf16 v[128:143], a[204:207], a[228:231], v[128:143]
  ds_read_b128 a[252:255], v9 offset:45056
  v_mfma_f32_32x32x16_bf16 v[176:191], a[204:207], a[232:235], v[176:191]
  ds_read_b64_tr_b16 a[216:217], v13 offset:24576
  buffer_load_dwordx4 v5, s[28:31], s75 offen offset:2048 lds
  v_mfma_f32_32x32x16_bf16 v[224:239], a[204:207], a[236:239], v[224:239]
  ds_read_b64_tr_b16 a[218:219], v13 offset:26112
  s_waitcnt lgkmcnt(8)
  v_mfma_f32_32x32x16_bf16 v[96:111], a[208:211], a[224:227], v[96:111]
  ds_read_b64_tr_b16 a[220:221], v15 offset:24576
  v_mfma_f32_32x32x16_bf16 v[144:159], a[208:211], a[228:231], v[144:159]
  ds_read_b64_tr_b16 a[222:223], v15 offset:26112
  s_add_u32 m0, s73, 110592
  s_add_u32 s75, s69, 55296
  buffer_load_dwordx4 v3, s[28:31], s75 offen offset:0 lds
  v_mfma_f32_32x32x16_bf16 v[192:207], a[208:211], a[232:235], v[192:207]
  v_mfma_f32_32x32x16_bf16 v[240:255], a[208:211], a[236:239], v[240:255]
  s_waitcnt lgkmcnt(7)
  v_mfma_f32_32x32x16_bf16 v[64:79], a[212:215], a[240:243], v[64:79]
  ds_read_b128 a[224:227], v6 offset:0
  buffer_load_dwordx4 v4, s[28:31], s75 offen offset:1024 lds
  s_waitcnt lgkmcnt(7)
  v_mfma_f32_32x32x16_bf16 v[112:127], a[212:215], a[244:247], v[112:127]
  ds_read_b64_tr_b16 a[200:201], v10 offset:0
  s_waitcnt lgkmcnt(7)
  v_mfma_f32_32x32x16_bf16 v[160:175], a[212:215], a[248:251], v[160:175]
  ds_read_b64_tr_b16 a[202:203], v10 offset:1536
  s_waitcnt lgkmcnt(7)
  v_mfma_f32_32x32x16_bf16 v[208:223], a[212:215], a[252:255], v[208:223]
  ds_read_b128 a[228:231], v6 offset:4096
  buffer_load_dwordx4 v5, s[28:31], s75 offen offset:2048 lds
  s_waitcnt lgkmcnt(6)
  v_mfma_f32_32x32x16_bf16 v[80:95], a[216:219], a[240:243], v[80:95]
  ds_read_b128 a[232:235], v6 offset:8192
  v_mfma_f32_32x32x16_bf16 v[128:143], a[216:219], a[244:247], v[128:143]
  ds_read_b128 a[236:239], v6 offset:12288
  v_mfma_f32_32x32x16_bf16 v[176:191], a[216:219], a[248:251], v[176:191]
  ds_read_b64_tr_b16 a[204:205], v12 offset:0
  s_add_u32 m0, s74, 24576
  s_add_u32 s75, s71, 81920
  buffer_load_dwordx4 v2, s[24:27], s75 offen lds
  v_mfma_f32_32x32x16_bf16 v[224:239], a[216:219], a[252:255], v[224:239]
  ds_read_b64_tr_b16 a[206:207], v12 offset:1536
  s_waitcnt lgkmcnt(8)
  v_mfma_f32_32x32x16_bf16 v[96:111], a[220:223], a[240:243], v[96:111]
  ds_read_b64_tr_b16 a[208:209], v14 offset:0
  v_mfma_f32_32x32x16_bf16 v[144:159], a[220:223], a[244:247], v[144:159]
  ds_read_b64_tr_b16 a[210:211], v14 offset:1536
  s_add_u32 m0, s74, 28672
  s_add_u32 s75, s71, 122880
  buffer_load_dwordx4 v2, s[24:27], s75 offen lds
  v_mfma_f32_32x32x16_bf16 v[192:207], a[220:223], a[248:251], v[192:207]
  v_mfma_f32_32x32x16_bf16 v[240:255], a[220:223], a[252:255], v[240:255]
  s_waitcnt vmcnt(13)
  s_barrier
  s_waitcnt lgkmcnt(7)
  v_mfma_f32_32x32x16_bf16 v[64:79], a[200:203], a[224:227], v[64:79]
  ds_read_b128 a[240:243], v7 offset:0
  s_add_u32 m0, s73, 122880
  s_add_u32 s75, s69, 110592
  buffer_load_dwordx4 v3, s[28:31], s75 offen offset:0 lds
  s_waitcnt lgkmcnt(7)
  v_mfma_f32_32x32x16_bf16 v[112:127], a[200:203], a[228:231], v[112:127]
  ds_read_b64_tr_b16 a[212:213], v10 offset:12288
  s_mul_i32 s80, s12, 378880
  s_add_u32 s80, s80, 9752576
  s_add_u32 s60, s22, s80
  s_addc_u32 s61, s23, 0
  s_and_b32 s62, s84, 378880
  s_mov_b32 s63, 0x20000
  s_waitcnt lgkmcnt(7)
  v_mfma_f32_32x32x16_bf16 v[160:175], a[200:203], a[232:235], v[160:175]
  ds_read_b64_tr_b16 a[214:215], v10 offset:13824
  s_waitcnt lgkmcnt(7)
  v_mfma_f32_32x32x16_bf16 v[208:223], a[200:203], a[236:239], v[208:223]
  ds_read_b128 a[244:247], v7 offset:4096
  buffer_load_dwordx4 v4, s[28:31], s75 offen offset:1024 lds
  s_waitcnt lgkmcnt(6)
  v_mfma_f32_32x32x16_bf16 v[80:95], a[204:207], a[224:227], v[80:95]
  ds_read_b128 a[248:251], v7 offset:8192
  v_mfma_f32_32x32x16_bf16 v[128:143], a[204:207], a[228:231], v[128:143]
  ds_read_b128 a[252:255], v7 offset:12288
  v_mfma_f32_32x32x16_bf16 v[176:191], a[204:207], a[232:235], v[176:191]
  ds_read_b64_tr_b16 a[216:217], v12 offset:12288
  buffer_load_dwordx4 v5, s[28:31], s75 offen offset:2048 lds
  v_mfma_f32_32x32x16_bf16 v[224:239], a[204:207], a[236:239], v[224:239]
  ds_read_b64_tr_b16 a[218:219], v12 offset:13824
  s_waitcnt lgkmcnt(8)
  v_mfma_f32_32x32x16_bf16 v[96:111], a[208:211], a[224:227], v[96:111]
  ds_read_b64_tr_b16 a[220:221], v14 offset:12288
  v_mfma_f32_32x32x16_bf16 v[144:159], a[208:211], a[228:231], v[144:159]
  ds_read_b64_tr_b16 a[222:223], v14 offset:13824
  s_add_u32 m0, s73, 135168
  s_add_u32 s75, s69, 165888
  buffer_load_dwordx4 v3, s[28:31], s75 offen offset:0 lds
  v_mfma_f32_32x32x16_bf16 v[192:207], a[208:211], a[232:235], v[192:207]
  v_mfma_f32_32x32x16_bf16 v[240:255], a[208:211], a[236:239], v[240:255]
  s_waitcnt lgkmcnt(7)
  v_mfma_f32_32x32x16_bf16 v[64:79], a[212:215], a[240:243], v[64:79]
  ds_read_b128 a[224:227], v8 offset:0
  buffer_load_dwordx4 v4, s[28:31], s75 offen offset:1024 lds
  s_waitcnt lgkmcnt(7)
  v_mfma_f32_32x32x16_bf16 v[112:127], a[212:215], a[244:247], v[112:127]
  ds_read_b64_tr_b16 a[200:201], v10 offset:24576
  s_waitcnt lgkmcnt(7)
  v_mfma_f32_32x32x16_bf16 v[160:175], a[212:215], a[248:251], v[160:175]
  ds_read_b64_tr_b16 a[202:203], v10 offset:26112
  s_waitcnt lgkmcnt(7)
  v_mfma_f32_32x32x16_bf16 v[208:223], a[212:215], a[252:255], v[208:223]
  ds_read_b128 a[228:231], v8 offset:4096
  buffer_load_dwordx4 v5, s[28:31], s75 offen offset:2048 lds
  s_waitcnt lgkmcnt(6)
  v_mfma_f32_32x32x16_bf16 v[80:95], a[216:219], a[240:243], v[80:95]
  ds_read_b128 a[232:235], v8 offset:8192
  v_mfma_f32_32x32x16_bf16 v[128:143], a[216:219], a[244:247], v[128:143]
  ds_read_b128 a[236:239], v8 offset:12288
  v_mfma_f32_32x32x16_bf16 v[176:191], a[216:219], a[248:251], v[176:191]
  ds_read_b64_tr_b16 a[204:205], v12 offset:24576
  s_add_u32 s71, s71, 128
  s_cmp_ge_u32 s71, s72
  s_cselect_b32 s79, 1280, 0
  s_sub_u32 s71, s71, s79
  s_add_u32 m0, s74, 32768
  s_add_u32 s75, s71, 0
  buffer_load_dwordx4 v2, s[24:27], s75 offen lds
  v_mfma_f32_32x32x16_bf16 v[224:239], a[216:219], a[252:255], v[224:239]
  ds_read_b64_tr_b16 a[206:207], v12 offset:26112
  s_waitcnt lgkmcnt(8)
  v_mfma_f32_32x32x16_bf16 v[96:111], a[220:223], a[240:243], v[96:111]
  ds_read_b64_tr_b16 a[208:209], v14 offset:24576
  v_mfma_f32_32x32x16_bf16 v[144:159], a[220:223], a[244:247], v[144:159]
  ds_read_b64_tr_b16 a[210:211], v14 offset:26112
  s_add_u32 m0, s74, 36864
  s_add_u32 s75, s71, 40960
  buffer_load_dwordx4 v2, s[24:27], s75 offen lds
  v_mfma_f32_32x32x16_bf16 v[192:207], a[220:223], a[248:251], v[192:207]
  v_mfma_f32_32x32x16_bf16 v[240:255], a[220:223], a[252:255], v[240:255]
  s_waitcnt vmcnt(8)
  s_barrier
  s_waitcnt lgkmcnt(7)
  v_mfma_f32_32x32x16_bf16 v[64:79], a[200:203], a[224:227], v[64:79]
  ds_read_b128 a[240:243], v9 offset:0
  s_add_u32 s69, s69, 221184
  s_cmp_ge_u32 s69, s70
  s_cselect_b32 s79, 2211840, 0
  s_sub_u32 s69, s69, s79
  s_add_u32 m0, s73, 49152
  s_add_u32 s75, s69, 0
  buffer_load_dwordx4 v3, s[28:31], s75 offen offset:0 lds
  s_waitcnt lgkmcnt(7)
  v_mfma_f32_32x32x16_bf16 v[112:127], a[200:203], a[228:231], v[112:127]
  ds_read_b64_tr_b16 a[212:213], v10 offset:36864
  v_lshlrev_b32 v24, 2, v1
  v_lshlrev_b32 v25, 4, v1
  s_waitcnt lgkmcnt(7)
  v_mfma_f32_32x32x16_bf16 v[160:175], a[200:203], a[232:235], v[160:175]
  ds_read_b64_tr_b16 a[214:215], v10 offset:38400
  s_cmp_eq_u32 s64, 0
  s_cselect_b32 s80, 4096, 1073741824
  buffer_load_dwordx4 v[52:55], v25, s[44:47], s80 offen sc1
  s_waitcnt lgkmcnt(7)
  v_mfma_f32_32x32x16_bf16 v[208:223], a[200:203], a[236:239], v[208:223]
  ds_read_b128 a[244:247], v9 offset:4096
  buffer_load_dwordx4 v4, s[28:31], s75 offen offset:1024 lds
  s_waitcnt lgkmcnt(6)
  v_mfma_f32_32x32x16_bf16 v[80:95], a[204:207], a[224:227], v[80:95]
  ds_read_b128 a[248:251], v9 offset:8192
  v_mfma_f32_32x32x16_bf16 v[128:143], a[204:207], a[228:231], v[128:143]
  ds_read_b128 a[252:255], v9 offset:12288
  v_mfma_f32_32x32x16_bf16 v[176:191], a[204:207], a[232:235], v[176:191]
  ds_read_b64_tr_b16 a[216:217], v12 offset:36864
  buffer_load_dwordx4 v5, s[28:31], s75 offen offset:2048 lds
  v_mfma_f32_32x32x16_bf16 v[224:239], a[204:207], a[236:239], v[224:239]
  ds_read_b64_tr_b16 a[218:219], v12 offset:38400
  s_waitcnt lgkmcnt(8)
  v_mfma_f32_32x32x16_bf16 v[96:111], a[208:211], a[224:227], v[96:111]
  ds_read_b64_tr_b16 a[220:221], v14 offset:36864
  v_mfma_f32_32x32x16_bf16 v[144:159], a[208:211], a[228:231], v[144:159]
  ds_read_b64_tr_b16 a[222:223], v14 offset:38400
  s_add_u32 m0, s73, 61440
  s_add_u32 s75, s69, 55296
  buffer_load_dwordx4 v3, s[28:31], s75 offen offset:0 lds
  v_mfma_f32_32x32x16_bf16 v[192:207], a[208:211], a[232:235], v[192:207]
  v_mfma_f32_32x32x16_bf16 v[240:255], a[208:211], a[236:239], v[240:255]
  s_waitcnt lgkmcnt(7)
  v_mfma_f32_32x32x16_bf16 v[64:79], a[212:215], a[240:243], v[64:79]
  ds_read_b128 a[224:227], v6 offset:16384
  buffer_load_dwordx4 v4, s[28:31], s75 offen offset:1024 lds
  s_waitcnt lgkmcnt(7)
  v_mfma_f32_32x32x16_bf16 v[112:127], a[212:215], a[244:247], v[112:127]
  ds_read_b64_tr_b16 a[200:201], v10 offset:49152
  s_waitcnt lgkmcnt(7)
  v_mfma_f32_32x32x16_bf16 v[160:175], a[212:215], a[248:251], v[160:175]
  ds_read_b64_tr_b16 a[202:203], v10 offset:50688
  s_waitcnt lgkmcnt(7)
  v_mfma_f32_32x32x16_bf16 v[208:223], a[212:215], a[252:255], v[208:223]
  ds_read_b128 a[228:231], v6 offset:20480
  buffer_load_dwordx4 v5, s[28:31], s75 offen offset:2048 lds
  s_waitcnt lgkmcnt(6)
  v_mfma_f32_32x32x16_bf16 v[80:95], a[216:219], a[240:243], v[80:95]
  ds_read_b128 a[232:235], v6 offset:24576
  v_mfma_f32_32x32x16_bf16 v[128:143], a[216:219], a[244:247], v[128:143]
  ds_read_b128 a[236:239], v6 offset:28672
  v_mfma_f32_32x32x16_bf16 v[176:191], a[216:219], a[248:251], v[176:191]
  ds_read_b64_tr_b16 a[204:205], v12 offset:49152
  s_add_u32 m0, s74, 40960
  s_add_u32 s75, s71, 81920
  buffer_load_dwordx4 v2, s[24:27], s75 offen lds
  v_mfma_f32_32x32x16_bf16 v[224:239], a[216:219], a[252:255], v[224:239]
  ds_read_b64_tr_b16 a[206:207], v12 offset:50688
  s_waitcnt lgkmcnt(8)
  v_mfma_f32_32x32x16_bf16 v[96:111], a[220:223], a[240:243], v[96:111]
  ds_read_b64_tr_b16 a[208:209], v14 offset:49152
  v_mfma_f32_32x32x16_bf16 v[144:159], a[220:223], a[244:247], v[144:159]
  ds_read_b64_tr_b16 a[210:211], v14 offset:50688
  s_add_u32 m0, s74, 45056
  s_add_u32 s75, s71, 122880
  buffer_load_dwordx4 v2, s[24:27], s75 offen lds
  v_mfma_f32_32x32x16_bf16 v[192:207], a[220:223], a[248:251], v[192:207]
  v_mfma_f32_32x32x16_bf16 v[240:255], a[220:223], a[252:255], v[240:255]
  s_waitcnt vmcnt(14)
  s_barrier
  s_waitcnt lgkmcnt(7)
  v_mfma_f32_32x32x16_bf16 v[64:79], a[200:203], a[224:227], v[64:79]
  ds_read_b128 a[240:243], v7 offset:16384
  s_add_u32 m0, s73, 73728
  s_add_u32 s75, s69, 110592
  buffer_load_dwordx4 v3, s[28:31], s75 offen offset:0 lds
  s_waitcnt lgkmcnt(7)
  v_mfma_f32_32x32x16_bf16 v[112:127], a[200:203], a[228:231], v[112:127]
  ds_read_b64_tr_b16 a[212:213], v11 offset:0
  s_waitcnt lgkmcnt(7)
  v_mfma_f32_32x32x16_bf16 v[160:175], a[200:203], a[232:235], v[160:175]
  ds_read_b64_tr_b16 a[214:215], v11 offset:1536
  s_waitcnt lgkmcnt(7)
  v_mfma_f32_32x32x16_bf16 v[208:223], a[200:203], a[236:239], v[208:223]
  ds_read_b128 a[244:247], v7 offset:20480
  buffer_load_dwordx4 v4, s[28:31], s75 offen offset:1024 lds
  s_waitcnt lgkmcnt(6)
  v_mfma_f32_32x32x16_bf16 v[80:95], a[204:207], a[224:227], v[80:95]
  ds_read_b128 a[248:251], v7 offset:24576
  v_mfma_f32_32x32x16_bf16 v[128:143], a[204:207], a[228:231], v[128:143]
  ds_read_b128 a[252:255], v7 offset:28672
  v_mfma_f32_32x32x16_bf16 v[176:191], a[204:207], a[232:235], v[176:191]
  ds_read_b64_tr_b16 a[216:217], v13 offset:0
  buffer_load_dwordx4 v5, s[28:31], s75 offen offset:2048 lds
  v_mfma_f32_32x32x16_bf16 v[224:239], a[204:207], a[236:239], v[224:239]
  ds_read_b64_tr_b16 a[218:219], v13 offset:1536
  s_waitcnt lgkmcnt(8)
  v_mfma_f32_32x32x16_bf16 v[96:111], a[208:211], a[224:227], v[96:111]
  ds_read_b64_tr_b16 a[220:221], v15 offset:0
  v_mfma_f32_32x32x16_bf16 v[144:159], a[208:211], a[228:231], v[144:159]
  ds_read_b64_tr_b16 a[222:223], v15 offset:1536
  s_add_u32 m0, s73, 86016
  s_add_u32 s75, s69, 165888
  buffer_load_dwordx4 v3, s[28:31], s75 offen offset:0 lds
  v_mfma_f32_32x32x16_bf16 v[192:207], a[208:211], a[232:235], v[192:207]
  v_mfma_f32_32x32x16_bf16 v[240:255], a[208:211], a[236:239], v[240:255]
  s_waitcnt lgkmcnt(7)
  v_mfma_f32_32x32x16_bf16 v[64:79], a[212:215], a[240:243], v[64:79]
  ds_read_b128 a[224:227], v8 offset:16384
  buffer_load_dwordx4 v4, s[28:31], s75 offen offset:1024 lds
  s_waitcnt lgkmcnt(7)
  v_mfma_f32_32x32x16_bf16 v[112:127], a[212:215], a[244:247], v[112:127]
  ds_read_b64_tr_b16 a[200:201], v11 offset:12288
  s_waitcnt lgkmcnt(7)
  v_mfma_f32_32x32x16_bf16 v[160:175], a[212:215], a[248:251], v[160:175]
  ds_read_b64_tr_b16 a[202:203], v11 offset:13824
  s_waitcnt lgkmcnt(7)
  v_mfma_f32_32x32x16_bf16 v[208:223], a[212:215], a[252:255], v[208:223]
  ds_read_b128 a[228:231], v8 offset:20480
  buffer_load_dwordx4 v5, s[28:31], s75 offen offset:2048 lds
  s_waitcnt lgkmcnt(6)
  v_mfma_f32_32x32x16_bf16 v[80:95], a[216:219], a[240:243], v[80:95]
  ds_read_b128 a[232:235], v8 offset:24576
  v_mfma_f32_32x32x16_bf16 v[128:143], a[216:219], a[244:247], v[128:143]
  ds_read_b128 a[236:239], v8 offset:28672
  v_mfma_f32_32x32x16_bf16 v[176:191], a[216:219], a[248:251], v[176:191]
  ds_read_b64_tr_b16 a[204:205], v13 offset:12288
  s_add_u32 s71, s71, 128
  s_cmp_ge_u32 s71, s72
  s_cselect_b32 s79, 1280, 0
  s_sub_u32 s71, s71, s79
  s_add_u32 m0, s74, 0
  s_add_u32 s75, s71, 0
  buffer_load_dwordx4 v2, s[24:27], s75 offen lds
  v_mfma_f32_32x32x16_bf16 v[224:239], a[216:219], a[252:255], v[224:239]
  ds_read_b64_tr_b16 a[206:207], v13 offset:13824
  s_waitcnt lgkmcnt(8)
  v_mfma_f32_32x32x16_bf16 v[96:111], a[220:223], a[240:243], v[96:111]
  ds_read_b64_tr_b16 a[208:209], v15 offset:12288
  v_mfma_f32_32x32x16_bf16 v[144:159], a[220:223], a[244:247], v[144:159]
  ds_read_b64_tr_b16 a[210:211], v15 offset:13824
  s_add_u32 m0, s74, 4096
  s_add_u32 s75, s71, 40960
  buffer_load_dwordx4 v2, s[24:27], s75 offen lds
  v_mfma_f32_32x32x16_bf16 v[192:207], a[220:223], a[248:251], v[192:207]
  v_mfma_f32_32x32x16_bf16 v[240:255], a[220:223], a[252:255], v[240:255]
  s_waitcnt vmcnt(8)
  s_barrier
  s_waitcnt lgkmcnt(7)
  v_mfma_f32_32x32x16_bf16 v[64:79], a[200:203], a[224:227], v[64:79]
  ds_read_b128 a[240:243], v9 offset:16384
  s_add_u32 s69, s69, 221184
  s_cmp_ge_u32 s69, s70
  s_cselect_b32 s79, 2211840, 0
  s_sub_u32 s69, s69, s79
  s_add_u32 m0, s73, 98304
  s_add_u32 s75, s69, 0
  buffer_load_dwordx4 v3, s[28:31], s75 offen offset:0 lds
  s_waitcnt lgkmcnt(7)
  v_mfma_f32_32x32x16_bf16 v[112:127], a[200:203], a[228:231], v[112:127]
  ds_read_b64_tr_b16 a[212:213], v11 offset:24576
  s_waitcnt lgkmcnt(7)
  v_mfma_f32_32x32x16_bf16 v[160:175], a[200:203], a[232:235], v[160:175]
  ds_read_b64_tr_b16 a[214:215], v11 offset:26112
  s_waitcnt lgkmcnt(7)
  v_mfma_f32_32x32x16_bf16 v[208:223], a[200:203], a[236:239], v[208:223]
  ds_read_b128 a[244:247], v9 offset:20480
  buffer_load_dwordx4 v4, s[28:31], s75 offen offset:1024 lds
  s_waitcnt lgkmcnt(6)
  v_mfma_f32_32x32x16_bf16 v[80:95], a[204:207], a[224:227], v[80:95]
  ds_read_b128 a[248:251], v9 offset:24576
  v_mfma_f32_32x32x16_bf16 v[128:143], a[204:207], a[228:231], v[128:143]
  ds_read_b128 a[252:255], v9 offset:28672
  v_mfma_f32_32x32x16_bf16 v[176:191], a[204:207], a[232:235], v[176:191]
  ds_read_b64_tr_b16 a[216:217], v13 offset:24576
  buffer_load_dwordx4 v5, s[28:31], s75 offen offset:2048 lds
  v_mfma_f32_32x32x16_bf16 v[224:239], a[204:207], a[236:239], v[224:239]
  ds_read_b64_tr_b16 a[218:219], v13 offset:26112
  s_waitcnt lgkmcnt(8)
  v_mfma_f32_32x32x16_bf16 v[96:111], a[208:211], a[224:227], v[96:111]
  ds_read_b64_tr_b16 a[220:221], v15 offset:24576
  v_mfma_f32_32x32x16_bf16 v[144:159], a[208:211], a[228:231], v[144:159]
  ds_read_b64_tr_b16 a[222:223], v15 offset:26112
  s_add_u32 m0, s73, 110592
  s_add_u32 s75, s69, 55296
  buffer_load_dwordx4 v3, s[28:31], s75 offen offset:0 lds
  v_mfma_f32_32x32x16_bf16 v[192:207], a[208:211], a[232:235], v[192:207]
  v_mfma_f32_32x32x16_bf16 v[240:255], a[208:211], a[236:239], v[240:255]
  s_waitcnt lgkmcnt(7)
  v_mfma_f32_32x32x16_bf16 v[64:79], a[212:215], a[240:243], v[64:79]
  ds_read_b128 a[224:227], v6 offset:32768
  buffer_load_dwordx4 v4, s[28:31], s75 offen offset:1024 lds
  s_waitcnt lgkmcnt(7)
  v_mfma_f32_32x32x16_bf16 v[112:127], a[212:215], a[244:247], v[112:127]
  ds_read_b64_tr_b16 a[200:201], v10 offset:0
  s_waitcnt lgkmcnt(7)
  v_mfma_f32_32x32x16_bf16 v[160:175], a[212:215], a[248:251], v[160:175]
  ds_read_b64_tr_b16 a[202:203], v10 offset:1536
  s_waitcnt lgkmcnt(7)
  v_mfma_f32_32x32x16_bf16 v[208:223], a[212:215], a[252:255], v[208:223]
  ds_read_b128 a[228:231], v6 offset:36864
  buffer_load_dwordx4 v5, s[28:31], s75 offen offset:2048 lds
  s_waitcnt lgkmcnt(6)
  v_mfma_f32_32x32x16_bf16 v[80:95], a[216:219], a[240:243], v[80:95]
  ds_read_b128 a[232:235], v6 offset:40960
  v_mfma_f32_32x32x16_bf16 v[128:143], a[216:219], a[244:247], v[128:143]
  ds_read_b128 a[236:239], v6 offset:45056
  v_mfma_f32_32x32x16_bf16 v[176:191], a[216:219], a[248:251], v[176:191]
  ds_read_b64_tr_b16 a[204:205], v12 offset:0
  s_add_u32 m0, s74, 8192
  s_add_u32 s75, s71, 81920
  buffer_load_dwordx4 v2, s[24:27], s75 offen lds
  v_mfma_f32_32x32x16_bf16 v[224:239], a[216:219], a[252:255], v[224:239]
  ds_read_b64_tr_b16 a[206:207], v12 offset:1536
  s_waitcnt lgkmcnt(8)
  v_mfma_f32_32x32x16_bf16 v[96:111], a[220:223], a[240:243], v[96:111]
  ds_read_b64_tr_b16 a[208:209], v14 offset:0
  v_mfma_f32_32x32x16_bf16 v[144:159], a[220:223], a[244:247], v[144:159]
  ds_read_b64_tr_b16 a[210:211], v14 offset:1536
  s_add_u32 m0, s74, 12288
  s_add_u32 s75, s71, 122880
  buffer_load_dwordx4 v2, s[24:27], s75 offen lds
  v_mfma_f32_32x32x16_bf16 v[192:207], a[220:223], a[248:251], v[192:207]
  v_mfma_f32_32x32x16_bf16 v[240:255], a[220:223], a[252:255], v[240:255]
  s_waitcnt vmcnt(13)
  s_cmp_eq_u32 s64, 0
  s_cselect_b64 s[76:77], -1, 0
  v_and_b32 v52, v52, v53
  v_and_b32 v54, v54, v55
  v_and_b32 v52, v52, v54
  v_cmp_ne_u32 vcc, 1, v52
  s_and_b64 vcc, vcc, s[76:77]
  s_cbranch_vccnz L_spin_ffn
L_spin_ffn_go:
  s_barrier
  s_waitcnt lgkmcnt(7)
  v_mfma_f32_32x32x16_bf16 v[64:79], a[200:203], a[224:227], v[64:79]
  ds_read_b128 a[240:243], v7 offset:32768
  s_add_u32 m0, s73, 122880
  s_add_u32 s75, s69, 110592
  buffer_load_dwordx4 v3, s[28:31], s75 offen offset:0 lds
  s_waitcnt lgkmcnt(7)
  v_mfma_f32_32x32x16_bf16 v[112:127], a[200:203], a[228:231], v[112:127]
  ds_read_b64_tr_b16 a[212:213], v10 offset:12288
  s_add_u32 s80, s67, 0
  s_lshl_b32 s80, s80, 8
  buffer_load_dwordx2 v[48:49], v18, s[32:35], s80 offen sc1
  s_waitcnt lgkmcnt(7)
  v_mfma_f32_32x32x16_bf16 v[160:175], a[200:203], a[232:235], v[160:175]
  ds_read_b64_tr_b16 a[214:215], v10 offset:13824
  s_add_u32 s80, s67, 1
  s_lshl_b32 s80, s80, 8
  buffer_load_dwordx2 v[50:51], v18, s[32:35], s80 offen sc1
  s_waitcnt lgkmcnt(7)
  v_mfma_f32_32x32x16_bf16 v[208:223], a[200:203], a[236:239], v[208:223]
  ds_read_b128 a[244:247], v7 offset:36864
  s_add_u32 s80, s67, 2
  s_lshl_b32 s80, s80, 8
  buffer_load_dwordx2 v[52:53], v18, s[32:35], s80 offen sc1
  s_waitcnt lgkmcnt(6)
  v_mfma_f32_32x32x16_bf16 v[80:95], a[204:207], a[224:227], v[80:95]
  ds_read_b128 a[248:251], v7 offset:40960
  buffer_load_dwordx4 v4, s[28:31], s75 offen offset:1024 lds
  v_mfma_f32_32x32x16_bf16 v[128:143], a[204:207], a[228:231], v[128:143]
  ds_read_b128 a[252:255], v7 offset:45056
  s_add_u32 s80, s67, 3
  s_lshl_b32 s80, s80, 8
  buffer_load_dwordx2 v[54:55], v18, s[32:35], s80 offen sc1
  v_mfma_f32_32x32x16_bf16 v[176:191], a[204:207], a[232:235], v[176:191]
  ds_read_b64_tr_b16 a[216:217], v12 offset:12288
  buffer_load_dword v28, v24, s[36:39], 0 offen offset:0 sc1
  v_mfma_f32_32x32x16_bf16 v[224:239], a[204:207], a[236:239], v[224:239]
  ds_read_b64_tr_b16 a[218:219], v12 offset:13824
  buffer_load_dword v29, v24, s[36:39], 0 offen offset:256 sc1
  buffer_load_dword v30, v24, s[36:39], 0 offen offset:512 sc1
  s_waitcnt lgkmcnt(8)
  v_mfma_f32_32x32x16_bf16 v[96:111], a[208:211], a[224:227], v[96:111]
  ds_read_b64_tr_b16 a[220:221], v14 offset:12288
  buffer_load_dwordx4 v5, s[28:31], s75 offen offset:2048 lds
  buffer_load_dword v31, v24, s[36:39], 0 offen offset:768 sc1
  v_mfma_f32_32x32x16_bf16 v[144:159], a[208:211], a[228:231], v[144:159]
  ds_read_b64_tr_b16 a[222:223], v14 offset:13824
  buffer_load_dword v32, v24, s[36:39], 0 offen offset:1024 sc1
  buffer_load_dword v34, v24, s[36:39], 0 offen offset:1280 sc1
  v_mfma_f32_32x32x16_bf16 v[192:207], a[208:211], a[232:235], v[192:207]
  buffer_load_dword v35, v24, s[36:39], 0 offen offset:1536 sc1
  buffer_load_dword v36, v24, s[36:39], 0 offen offset:1792 sc1
  buffer_load_dword v37, v24, s[36:39], 0 offen offset:2048 sc1
  v_mfma_f32_32x32x16_bf16 v[240:255], a[208:211], a[236:239], v[240:255]
  buffer_load_dword v38, v24, s[36:39], 0 offen offset:2304 sc1
  buffer_load_dword v40, v24, s[36:39], 0 offen offset:2560 sc1
  buffer_load_dword v41, v24, s[36:39], 0 offen offset:2816 sc1
  s_waitcnt lgkmcnt(7)
  v_mfma_f32_32x32x16_bf16 v[64:79], a[212:215], a[240:243], v[64:79]
  ds_read_b128 a[224:227], v8 offset:32768
  s_add_u32 m0, s73, 135168
  s_add_u32 s75, s69, 165888
  buffer_load_dwordx4 v3, s[28:31], s75 offen offset:0 lds
  s_waitcnt lgkmcnt(7)
  v_mfma_f32_32x32x16_bf16 v[112:127], a[212:215], a[244:247], v[112:127]
  ds_read_b64_tr_b16 a[200:201], v10 offset:24576
  buffer_load_dword v42, v24, s[36:39], 0 offen offset:3072 sc1
  buffer_load_dword v43, v24, s[36:39], 0 offen offset:3328 sc1
  s_waitcnt lgkmcnt(7)
  v_mfma_f32_32x32x16_bf16 v[160:175], a[212:215], a[248:251], v[160:175]
  ds_read_b64_tr_b16 a[202:203], v10 offset:26112
  buffer_load_dword v44, v24, s[36:39], 0 offen offset:3584 sc1
  v_accvgpr_write_b32 a162, 0
  v_accvgpr_write_b32 a163, 0
  s_waitcnt lgkmcnt(7)
  v_mfma_f32_32x32x16_bf16 v[208:223], a[212:215], a[252:255], v[208:223]
  ds_read_b128 a[228:231], v8 offset:36864
  v_accvgpr_write_b32 a166, 0
  v_accvgpr_write_b32 a167, 0
  v_accvgpr_write_b32 a170, 0
  s_waitcnt lgkmcnt(6)
  v_mfma_f32_32x32x16_bf16 v[80:95], a[216:219], a[240:243], v[80:95]
  ds_read_b128 a[232:235], v8 offset:40960
  buffer_load_dwordx4 v4, s[28:31], s75 offen offset:1024 lds
  v_accvgpr_write_b32 a171, 0
  v_mfma_f32_32x32x16_bf16 v[128:143], a[216:219], a[244:247], v[128:143]
  ds_read_b128 a[236:239], v8 offset:45056
  v_accvgpr_write_b32 a174, 0
  v_accvgpr_write_b32 a175, 0
  v_mfma_f32_32x32x16_bf16 v[176:191], a[216:219], a[248:251], v[176:191]
  ds_read_b64_tr_b16 a[204:205], v12 offset:24576
  v_mfma_f32_32x32x16_bf16 v[224:239], a[216:219], a[252:255], v[224:239]
  ds_read_b64_tr_b16 a[206:207], v12 offset:26112
  s_waitcnt lgkmcnt(8)
  v_mfma_f32_32x32x16_bf16 v[96:111], a[220:223], a[240:243], v[96:111]
  ds_read_b64_tr_b16 a[208:209], v14 offset:24576
  buffer_load_dwordx4 v5, s[28:31], s75 offen offset:2048 lds
  v_mfma_f32_32x32x16_bf16 v[144:159], a[220:223], a[244:247], v[144:159]
  ds_read_b64_tr_b16 a[210:211], v14 offset:26112
  v_mfma_f32_32x32x16_bf16 v[192:207], a[220:223], a[248:251], v[192:207]
  v_mfma_f32_32x32x16_bf16 v[240:255], a[220:223], a[252:255], v[240:255]
  s_waitcnt vmcnt(25)
  s_barrier
  s_waitcnt lgkmcnt(7)
  v_mfma_f32_32x32x16_bf16 v[64:79], a[200:203], a[224:227], v[64:79]
  ds_read_b128 a[240:243], v9 offset:32768
  s_add_u32 s20, s14, 0
  s_cmp_ge_u32 s20, 266240
  s_cselect_b32 s21, 266240, 0
  s_sub_u32 s20, s20, s21
  s_add_u32 s20, s20, s13
  buffer_load_dwordx4 a[0:3], v20, s[60:63], s20 offen offset:0 sc1
  s_waitcnt lgkmcnt(7)
  v_mfma_f32_32x32x16_bf16 v[112:127], a[200:203], a[228:231], v[112:127]
  ds_read_b64_tr_b16 a[212:213], v10 offset:36864
  s_waitcnt lgkmcnt(7)
  v_mfma_f32_32x32x16_bf16 v[160:175], a[200:203], a[232:235], v[160:175]
  ds_read_b64_tr_b16 a[214:215], v10 offset:38400
  buffer_load_dwordx4 a[4:7], v20, s[60:63], s20 offen offset:1024 sc1
  s_waitcnt lgkmcnt(7)
  v_mfma_f32_32x32x16_bf16 v[208:223], a[200:203], a[236:239], v[208:223]
  ds_read_b128 a[244:247], v9 offset:36864
  s_waitcnt lgkmcnt(6)
  v_mfma_f32_32x32x16_bf16 v[80:95], a[204:207], a[224:227], v[80:95]
  ds_read_b128 a[248:251], v9 offset:40960
  buffer_load_dwordx4 a[8:11], v20, s[60:63], s20 offen offset:2048 sc1
  v_mfma_f32_32x32x16_bf16 v[128:143], a[204:207], a[228:231], v[128:143]
  ds_read_b128 a[252:255], v9 offset:45056
  v_mfma_f32_32x32x16_bf16 v[176:191], a[204:207], a[232:235], v[176:191]
  ds_read_b64_tr_b16 a[216:217], v12 offset:36864
  v_mfma_f32_32x32x16_bf16 v[224:239], a[204:207], a[236:239], v[224:239]
  ds_read_b64_tr_b16 a[218:219], v12 offset:38400
  buffer_load_dwordx4 a[12:15], v20, s[60:63], s20 offen offset:3072 sc1
  s_waitcnt lgkmcnt(8)
  v_mfma_f32_32x32x16_bf16 v[96:111], a[208:211], a[224:227], v[96:111]
  ds_read_b64_tr_b16 a[220:221], v14 offset:36864
  v_mfma_f32_32x32x16_bf16 v[144:159], a[208:211], a[228:231], v[144:159]
  ds_read_b64_tr_b16 a[222:223], v14 offset:38400
  s_add_u32 s20, s20, 4096
  buffer_load_dwordx4 a[16:19], v20, s[60:63], s20 offen sc1
  v_mfma_f32_32x32x16_bf16 v[192:207], a[208:211], a[232:235], v[192:207]
  v_mfma_f32_32x32x16_bf16 v[240:255], a[208:211], a[236:239], v[240:255]
  s_waitcnt lgkmcnt(7)
  v_mfma_f32_32x32x16_bf16 v[64:79], a[212:215], a[240:243], v[64:79]
  ds_read_b128 a[224:227], v6 offset:0
  s_add_u32 s20, s14, 20480
  s_cmp_ge_u32 s20, 266240
  s_cselect_b32 s21, 266240, 0
  s_sub_u32 s20, s20, s21
  s_add_u32 s20, s20, s13
  buffer_load_dwordx4 a[20:23], v20, s[60:63], s20 offen offset:0 sc1
  s_waitcnt lgkmcnt(7)
  v_mfma_f32_32x32x16_bf16 v[112:127], a[212:215], a[244:247], v[112:127]
  ds_read_b64_tr_b16 a[200:201], v10 offset:49152
  s_waitcnt lgkmcnt(7)
  v_mfma_f32_32x32x16_bf16 v[160:175], a[212:215], a[248:251], v[160:175]
  ds_read_b64_tr_b16 a[202:203], v10 offset:50688
  buffer_load_dwordx4 a[24:27], v20, s[60:63], s20 offen offset:1024 sc1
  s_waitcnt lgkmcnt(7)
  v_mfma_f32_32x32x16_bf16 v[208:223], a[212:215], a[252:255], v[208:223]
  ds_read_b128 a[228:231], v6 offset:4096
  s_waitcnt lgkmcnt(6)
  v_mfma_f32_32x32x16_bf16 v[80:95], a[216:219], a[240:243], v[80:95]
  ds_read_b128 a[232:235], v6 offset:8192
  buffer_load_dwordx4 a[28:31], v20, s[60:63], s20 offen offset:2048 sc1
  v_mfma_f32_32x32x16_bf16 v[128:143], a[216:219], a[244:247], v[128:143]
  ds_read_b128 a[236:239], v6 offset:12288
  s_waitcnt vmcnt(25)
  v_add_f32 v28, v28, v29
  s_waitcnt vmcnt(22)
  v_add_f32 v30, v30, v31
  s_waitcnt vmcnt(21)
  v_add_f32 v28, v28, v32
  v_mfma_f32_32x32x16_bf16 v[176:191], a[216:219], a[248:251], v[176:191]
  ds_read_b64_tr_b16 a[204:205], v12 offset:49152
  v_add_f32 v33, v28, v30
  v_mov_b32 v32, v33
  v_mfma_f32_32x32x16_bf16 v[224:239], a[216:219], a[252:255], v[224:239]
  ds_read_b64_tr_b16 a[206:207], v12 offset:50688
  buffer_load_dwordx4 a[32:35], v20, s[60:63], s20 offen offset:3072 sc1
  v_permlane32_swap_b32 v33, v32
  v_add_f32 v33, v33, v32
  s_waitcnt lgkmcnt(8)
  v_mfma_f32_32x32x16_bf16 v[96:111], a[220:223], a[240:243], v[96:111]
  ds_read_b64_tr_b16 a[208:209], v14 offset:49152
  v_cmp_gt_u32 vcc, 32, v1
  v_mfma_f32_32x32x16_bf16 v[144:159], a[220:223], a[244:247], v[144:159]
  ds_read_b64_tr_b16 a[210:211], v14 offset:50688
  s_add_u32 s20, s20, 4096
  buffer_load_dwordx4 a[36:39], v20, s[60:63], s20 offen sc1
  v_cndmask_b32 v33, 0, v33, vcc
  v_mfma_f32_32x32x16_bf16 v[192:207], a[220:223], a[248:251], v[192:207]
  v_cvt_pk_bf16_f32 v29, v33, 0
  v_lshlrev_b32 v28, 16, v29
  v_sub_f32 v28, v33, v28
  v_cvt_pk_bf16_f32 v28, v33, v28
  v_mov_b32 v30, 0
  v_mov_b32 v31, 0
  v_mfma_f32_32x32x16_bf16 v[240:255], a[220:223], a[252:255], v[240:255]
  s_waitcnt vmcnt(21)
  v_add_f32 v34, v34, v35
  s_waitcnt vmcnt(19)
  v_add_f32 v36, v36, v37
  s_waitcnt vmcnt(18)
  v_add_f32 v34, v34, v38
  v_add_f32 v39, v34, v36
  v_mov_b32 v38, v39
  s_barrier
  s_waitcnt lgkmcnt(7)
  v_mfma_f32_32x32x16_bf16 v[64:79], a[200:203], a[224:227], v[64:79]
  ds_read_b128 a[240:243], v7 offset:0
  s_add_u32 s20, s14, 40960
  s_cmp_ge_u32 s20, 266240
  s_cselect_b32 s21, 266240, 0
  s_sub_u32 s20, s20, s21
  s_add_u32 s20, s20, s13
  buffer_load_dwordx4 a[40:43], v20, s[60:63], s20 offen offset:0 sc1
  s_waitcnt lgkmcnt(7)
  v_mfma_f32_32x32x16_bf16 v[112:127], a[200:203], a[228:231], v[112:127]
  ds_read_b64_tr_b16 a[212:213], v11 offset:0
  v_permlane32_swap_b32 v39, v38
  v_add_f32 v39, v39, v38
  v_cmp_gt_u32 vcc, 32, v1
  s_waitcnt lgkmcnt(7)
  v_mfma_f32_32x32x16_bf16 v[160:175], a[200:203], a[232:235], v[160:175]
  ds_read_b64_tr_b16 a[214:215], v11 offset:1536
  buffer_load_dwordx4 a[44:47], v20, s[60:63], s20 offen offset:1024 sc1
  v_cndmask_b32 v39, 0, v39, vcc
  v_cvt_pk_bf16_f32 v35, v39, 0
  s_waitcnt lgkmcnt(7)
  v_mfma_f32_32x32x16_bf16 v[208:223], a[200:203], a[236:239], v[208:223]
  ds_read_b128 a[244:247], v7 offset:4096
  v_lshlrev_b32 v34, 16, v35
  v_sub_f32 v34, v39, v34
  v_cvt_pk_bf16_f32 v34, v39, v34
  s_waitcnt lgkmcnt(6)
  v_mfma_f32_32x32x16_bf16 v[80:95], a[204:207], a[224:227], v[80:95]
  ds_read_b128 a[248:251], v7 offset:8192
  buffer_load_dwordx4 a[48:51], v20, s[60:63], s20 offen offset:2048 sc1
  v_mov_b32 v36, 0
  v_mfma_f32_32x32x16_bf16 v[128:143], a[204:207], a[228:231], v[128:143]
  ds_read_b128 a[252:255], v7 offset:12288
  v_mov_b32 v37, 0
  s_waitcnt vmcnt(19)
  v_add_f32 v40, v40, v41
  s_waitcnt vmcnt(16)
  v_add_f32 v42, v42, v43
  v_mfma_f32_32x32x16_bf16 v[176:191], a[204:207], a[232:235], v[176:191]
  ds_read_b64_tr_b16 a[216:217], v13 offset:0
  s_waitcnt vmcnt(15)
  v_add_f32 v40, v40, v44
  v_add_f32 v45, v40, v42
  v_mov_b32 v44, v45
  v_mfma_f32_32x32x16_bf16 v[224:239], a[204:207], a[236:239], v[224:239]
  ds_read_b64_tr_b16 a[218:219], v13 offset:1536
  buffer_load_dwordx4 a[52:55], v20, s[60:63], s20 offen offset:3072 sc1
  v_permlane32_swap_b32 v45, v44
  v_add_f32 v45, v45, v44
  s_waitcnt lgkmcnt(8)
  v_mfma_f32_32x32x16_bf16 v[96:111], a[208:211], a[224:227], v[96:111]
  ds_read_b64_tr_b16 a[220:221], v15 offset:0
  v_cmp_gt_u32 vcc, 32, v1
  v_mfma_f32_32x32x16_bf16 v[144:159], a[208:211], a[228:231], v[144:159]
  ds_read_b64_tr_b16 a[222:223], v15 offset:1536
  s_add_u32 s20, s20, 4096
  buffer_load_dwordx4 a[56:59], v20, s[60:63], s20 offen sc1
  v_cndmask_b32 v45, 0, v45, vcc
  v_mfma_f32_32x32x16_bf16 v[192:207], a[208:211], a[232:235], v[192:207]
  v_cvt_pk_bf16_f32 v41, v45, 0
  v_lshlrev_b32 v40, 16, v41
  v_sub_f32 v40, v45, v40
  v_cvt_pk_bf16_f32 v40, v45, v40
  v_mov_b32 v42, 0
  v_mov_b32 v43, 0
  v_mfma_f32_32x32x16_bf16 v[240:255], a[208:211], a[236:239], v[240:255]
  v_cvt_pk_bf16_f32 v26, -v48, -v48
  v_lshlrev_b32 v27, 16, v26
  v_sub_f32_e64 v27, -v48, v27
  v_cvt_pk_bf16_f32 v27, v27, 0
  v_accvgpr_write_b32 a160, v26
  v_accvgpr_write_b32 a161, v27
  s_waitcnt lgkmcnt(7)
  v_mfma_f32_32x32x16_bf16 v[64:79], a[212:215], a[240:243], v[64:79]
  ds_read_b128 a[224:227], v8 offset:0
  s_add_u32 s20, s14, 61440
  s_cmp_ge_u32 s20, 266240
  s_cselect_b32 s21, 266240, 0
  s_sub_u32 s20, s20, s21
  s_add_u32 s20, s20, s13
  buffer_load_dwordx4 a[60:63], v20, s[60:63], s20 offen offset:0 sc1
  s_waitcnt lgkmcnt(7)
  v_mfma_f32_32x32x16_bf16 v[112:127], a[212:215], a[244:247], v[112:127]
  ds_read_b64_tr_b16 a[200:201], v11 offset:12288
  v_cvt_pk_bf16_f32 v26, -v50, -v50
  v_lshlrev_b32 v27, 16, v26
  v_sub_f32_e64 v27, -v50, v27
  v_cvt_pk_bf16_f32 v27, v27, 0
  s_waitcnt lgkmcnt(7)
  v_mfma_f32_32x32x16_bf16 v[160:175], a[212:215], a[248:251], v[160:175]
  ds_read_b64_tr_b16 a[202:203], v11 offset:13824
  buffer_load_dwordx4 a[64:67], v20, s[60:63], s20 offen offset:1024 sc1
  v_accvgpr_write_b32 a164, v26
  v_accvgpr_write_b32 a165, v27
  s_waitcnt lgkmcnt(7)
  v_mfma_f32_32x32x16_bf16 v[208:223], a[212:215], a[252:255], v[208:223]
  ds_read_b128 a[228:231], v8 offset:4096
  v_cvt_pk_bf16_f32 v26, -v52, -v52
  v_lshlrev_b32 v27, 16, v26
  v_sub_f32_e64 v27, -v52, v27
  s_waitcnt lgkmcnt(6)
  v_mfma_f32_32x32x16_bf16 v[80:95], a[216:219], a[240:243], v[80:95]
  ds_read_b128 a[232:235], v8 offset:8192
  buffer_load_dwordx4 a[68:71], v20, s[60:63], s20 offen offset:2048 sc1
  v_cvt_pk_bf16_f32 v27, v27, 0
  v_mfma_f32_32x32x16_bf16 v[128:143], a[216:219], a[244:247], v[128:143]
  ds_read_b128 a[236:239], v8 offset:12288
  v_accvgpr_write_b32 a168, v26
  v_accvgpr_write_b32 a169, v27
  v_cvt_pk_bf16_f32 v26, -v54, -v54
  v_mfma_f32_32x32x16_bf16 v[176:191], a[216:219], a[248:251], v[176:191]
  ds_read_b64_tr_b16 a[204:205], v13 offset:12288
  v_lshlrev_b32 v27, 16, v26
  v_sub_f32_e64 v27, -v54, v27
  v_cvt_pk_bf16_f32 v27, v27, 0
  v_accvgpr_write_b32 a172, v26
  v_mfma_f32_32x32x16_bf16 v[224:239], a[216:219], a[252:255], v[224:239]
  ds_read_b64_tr_b16 a[206:207], v13 offset:13824
  buffer_load_dwordx4 a[72:75], v20, s[60:63], s20 offen offset:3072 sc1
  v_accvgpr_write_b32 a173, v27
  s_waitcnt lgkmcnt(8)
  v_mfma_f32_32x32x16_bf16 v[96:111], a[220:223], a[240:243], v[96:111]
  ds_read_b64_tr_b16 a[208:209], v15 offset:12288
  v_mfma_f32_32x32x16_bf16 v[144:159], a[220:223], a[244:247], v[144:159]
  ds_read_b64_tr_b16 a[210:211], v15 offset:13824
  s_add_u32 s20, s20, 4096
  buffer_load_dwordx4 a[76:79], v20, s[60:63], s20 offen sc1
  v_mfma_f32_32x32x16_bf16 v[192:207], a[220:223], a[248:251], v[192:207]
  v_mfma_f32_32x32x16_bf16 v[240:255], a[220:223], a[252:255], v[240:255]
  s_waitcnt vmcnt(20)
  s_barrier
  s_waitcnt lgkmcnt(7)
  v_mfma_f32_32x32x16_bf16 v[64:79], a[200:203], a[224:227], v[64:79]
  ds_read_b128 a[240:243], v9 offset:0
  s_add_u32 s20, s14, 81920
  s_cmp_ge_u32 s20, 266240
  s_cselect_b32 s21, 266240, 0
  s_sub_u32 s20, s20, s21
  s_add_u32 s20, s20, s13
  buffer_load_dwordx4 a[80:83], v20, s[60:63], s20 offen offset:0 sc1
  s_waitcnt lgkmcnt(7)
  v_mfma_f32_32x32x16_bf16 v[112:127], a[200:203], a[228:231], v[112:127]
  ds_read_b64_tr_b16 a[212:213], v11 offset:24576
  s_waitcnt lgkmcnt(7)
  v_mfma_f32_32x32x16_bf16 v[160:175], a[200:203], a[232:235], v[160:175]
  ds_read_b64_tr_b16 a[214:215], v11 offset:26112
  buffer_load_dwordx4 a[84:87], v20, s[60:63], s20 offen offset:1024 sc1
  s_waitcnt lgkmcnt(7)
  v_mfma_f32_32x32x16_bf16 v[208:223], a[200:203], a[236:239], v[208:223]
  ds_read_b128 a[244:247], v9 offset:4096
  s_waitcnt lgkmcnt(6)
  v_mfma_f32_32x32x16_bf16 v[80:95], a[204:207], a[224:227], v[80:95]
  ds_read_b128 a[248:251], v9 offset:8192
  buffer_load_dwordx4 a[88:91], v20, s[60:63], s20 offen offset:2048 sc1
  v_mfma_f32_32x32x16_bf16 v[128:143], a[204:207], a[228:231], v[128:143]
  ds_read_b128 a[252:255], v9 offset:12288
  v_mfma_f32_32x32x16_bf16 v[176:191], a[204:207], a[232:235], v[176:191]
  ds_read_b64_tr_b16 a[216:217], v13 offset:24576
  v_mfma_f32_32x32x16_bf16 v[224:239], a[204:207], a[236:239], v[224:239]
  ds_read_b64_tr_b16 a[218:219], v13 offset:26112
  buffer_load_dwordx4 a[92:95], v20, s[60:63], s20 offen offset:3072 sc1
  s_waitcnt lgkmcnt(8)
  v_mfma_f32_32x32x16_bf16 v[96:111], a[208:211], a[224:227], v[96:111]
  ds_read_b64_tr_b16 a[220:221], v15 offset:24576
  v_mfma_f32_32x32x16_bf16 v[144:159], a[208:211], a[228:231], v[144:159]
  ds_read_b64_tr_b16 a[222:223], v15 offset:26112
  s_add_u32 s20, s20, 4096
  buffer_load_dwordx4 a[96:99], v20, s[60:63], s20 offen sc1
  v_mfma_f32_32x32x16_bf16 v[192:207], a[208:211], a[232:235], v[192:207]
  v_mfma_f32_32x32x16_bf16 v[240:255], a[208:211], a[236:239], v[240:255]
  s_waitcnt lgkmcnt(7)
  v_mfma_f32_32x32x16_bf16 v[64:79], a[212:215], a[240:243], v[64:79]
  s_add_u32 s20, s14, 102400
  s_cmp_ge_u32 s20, 266240
  s_cselect_b32 s21, 266240, 0
  s_sub_u32 s20, s20, s21
  s_add_u32 s20, s20, s13
  buffer_load_dwordx4 a[100:103], v20, s[60:63], s20 offen offset:0 sc1
  s_waitcnt lgkmcnt(6)
  v_mfma_f32_32x32x16_bf16 v[112:127], a[212:215], a[244:247], v[112:127]
  s_waitcnt lgkmcnt(5)
  v_mfma_f32_32x32x16_bf16 v[160:175], a[212:215], a[248:251], v[160:175]
  buffer_load_dwordx4 a[104:107], v20, s[60:63], s20 offen offset:1024 sc1
  s_waitcnt lgkmcnt(4)
  v_mfma_f32_32x32x16_bf16 v[208:223], a[212:215], a[252:255], v[208:223]
  s_waitcnt lgkmcnt(2)
  v_mfma_f32_32x32x16_bf16 v[80:95], a[216:219], a[240:243], v[80:95]
  buffer_load_dwordx4 a[108:111], v20, s[60:63], s20 offen offset:2048 sc1
  v_mfma_f32_32x32x16_bf16 v[128:143], a[216:219], a[244:247], v[128:143]
  v_mfma_f32_32x32x16_bf16 v[176:191], a[216:219], a[248:251], v[176:191]
  v_mfma_f32_32x32x16_bf16 v[224:239], a[216:219], a[252:255], v[224:239]
  buffer_load_dwordx4 a[112:115], v20, s[60:63], s20 offen offset:3072 sc1
  s_waitcnt lgkmcnt(0)
  v_mfma_f32_32x32x16_bf16 v[96:111], a[220:223], a[240:243], v[96:111]
  v_mfma_f32_32x32x16_bf16 v[144:159], a[220:223], a[244:247], v[144:159]
  s_add_u32 s20, s20, 4096
  buffer_load_dwordx4 a[116:119], v20, s[60:63], s20 offen sc1
  v_mfma_f32_32x32x16_bf16 v[192:207], a[220:223], a[248:251], v[192:207]
  v_mfma_f32_32x32x16_bf16 v[240:255], a[220:223], a[252:255], v[240:255]
L_epi_ffn:
  s_add_u32 s52, s22, 53248
  s_addc_u32 s53, s23, 0
  s_and_b32 s54, s84, 7077888
  s_mov_b32 s55, 0x20000
  s_cbranch_execz L_nb1
  s_barrier
L_nb1:
  v_mfma_f32_32x32x16_bf16 v[64:79], v[28:31], a[160:163], v[64:79]
  v_mul_f32 v56, v49, v49
  v_mul_f32 v58, v51, v51
  s_add_u32 s76, s67, 0
  s_mul_i32 s76, s76, 110592
  s_add_u32 s76, s76, s81
  s_add_u32 s80, s67, 1
  s_mul_i32 s80, s80, 110592
  s_add_u32 s80, s80, s81
  v_mfma_f32_32x32x16_bf16 v[80:95], v[34:37], a[160:163], v[80:95]
  v_mul_f32 v60, v53, v53
  v_mul_f32 v62, v55, v55
  s_nop 0
  v_max_f32 v64, 0, v64
  v_max_f32 v65, 0, v65
  v_max_f32 v66, 0, v66
  v_max_f32 v67, 0, v67
  v_mfma_f32_32x32x16_bf16 v[96:111], v[40:43], a[160:163], v[96:111]
  v_max_f32 v68, 0, v68
  v_max_f32 v69, 0, v69
  v_max_f32 v70, 0, v70
  v_max_f32 v71, 0, v71
  v_max_f32 v80, 0, v80
  v_max_f32 v81, 0, v81
  v_max_f32 v82, 0, v82
  v_mfma_f32_32x32x16_bf16 v[112:127], v[28:31], a[164:167], v[112:127]
  v_max_f32 v83, 0, v83
  v_max_f32 v84, 0, v84
  v_max_f32 v85, 0, v85
  v_max_f32 v86, 0, v86
  v_max_f32 v87, 0, v87
  v_max_f32 v96, 0, v96
  v_max_f32 v97, 0, v97
  v_mfma_f32_32x32x16_bf16 v[128:143], v[34:37], a[164:167], v[128:143]
  v_max_f32 v98, 0, v98
  v_max_f32 v99, 0, v99
  v_max_f32 v100, 0, v100
  v_max_f32 v101, 0, v101
  v_max_f32 v102, 0, v102
  v_max_f32 v103, 0, v103
  v_max_f32 v112, 0, v112
  v_mfma_f32_32x32x16_bf16 v[144:159], v[40:43], a[164:167], v[144:159]
  v_max_f32 v113, 0, v113
  v_max_f32 v114, 0, v114
  v_max_f32 v115, 0, v115
  v_max_f32 v116, 0, v116
  v_max_f32 v117, 0, v117
  v_max_f32 v118, 0, v118
  v_max_f32 v119, 0, v119
  v_mfma_f32_32x32x16_bf16 v[160:175], v[28:31], a[168:171], v[160:175]
  v_max_f32 v128, 0, v128
  v_max_f32 v129, 0, v129
  v_max_f32 v130, 0, v130
  v_max_f32 v131, 0, v131
  v_max_f32 v132, 0, v132
  v_max_f32 v133, 0, v133
  v_max_f32 v134, 0, v134
  v_mfma_f32_32x32x16_bf16 v[176:191], v[34:37], a[168:171], v[176:191]
  v_max_f32 v135, 0, v135
  v_max_f32 v144, 0, v144
  v_max_f32 v145, 0, v145
  v_max_f32 v146, 0, v146
  v_max_f32 v147, 0, v147
  s_add_u32 s20, s14, 122880
  s_cmp_ge_u32 s20, 266240
  s_cselect_b32 s21, 266240, 0
  s_sub_u32 s20, s20, s21
  s_add_u32 s20, s20, s13
  buffer_load_dwordx4 a[120:123], v20, s[60:63], s20 offen offset:0 sc1
  v_max_f32 v148, 0, v148
  v_max_f32 v149, 0, v149
  v_mfma_f32_32x32x16_bf16 v[192:207], v[40:43], a[168:171], v[192:207]
  v_max_f32 v150, 0, v150
  v_max_f32 v151, 0, v151
  v_max_f32 v160, 0, v160
  buffer_load_dwordx4 a[124:127], v20, s[60:63], s20 offen offset:1024 sc1
  v_max_f32 v161, 0, v161
  v_max_f32 v162, 0, v162
  v_max_f32 v163, 0, v163
  v_max_f32 v164, 0, v164
  v_mfma_f32_32x32x16_bf16 v[208:223], v[28:31], a[172:175], v[208:223]
  v_max_f32 v165, 0, v165
  buffer_load_dwordx4 a[128:131], v20, s[60:63], s20 offen offset:2048 sc1
  v_max_f32 v166, 0, v166
  v_max_f32 v167, 0, v167
  v_max_f32 v176, 0, v176
  v_max_f32 v177, 0, v177
  v_max_f32 v178, 0, v178
  v_max_f32 v179, 0, v179
  buffer_load_dwordx4 a[132:135], v20, s[60:63], s20 offen offset:3072 sc1
  v_mfma_f32_32x32x16_bf16 v[224:239], v[34:37], a[172:175], v[224:239]
  v_max_f32 v180, 0, v180
  v_max_f32 v181, 0, v181
  v_max_f32 v182, 0, v182
  v_max_f32 v183, 0, v183
  v_max_f32 v192, 0, v192
  s_add_u32 s20, s20, 4096
  buffer_load_dwordx4 a[136:139], v20, s[60:63], s20 offen sc1
  v_max_f32 v193, 0, v193
  v_max_f32 v194, 0, v194
  v_mfma_f32_32x32x16_bf16 v[240:255], v[40:43], a[172:175], v[240:255]
  v_max_f32 v195, 0, v195
  v_max_f32 v196, 0, v196
  v_max_f32 v197, 0, v197
  s_add_u32 s20, s14, 143360
  s_cmp_ge_u32 s20, 266240
  s_cselect_b32 s21, 266240, 0
  s_sub_u32 s20, s20, s21
  s_add_u32 s20, s20, s13
  buffer_load_dwordx4 a[140:143], v20, s[60:63], s20 offen offset:0 sc1
  v_max_f32 v198, 0, v198
  v_max_f32 v199, 0, v199
  v_max_f32 v208, 0, v208
  v_max_f32 v209, 0, v209
  v_max_f32 v210, 0, v210
  v_max_f32 v211, 0, v211
  buffer_load_dwordx4 a[144:147], v20, s[60:63], s20 offen offset:1024 sc1
  v_max_f32 v212, 0, v212
  v_pk_mul_f32 v[72:73], v[72:73], v[56:57] op_sel_hi:[1,0]
  v_pk_mul_f32 v[74:75], v[74:75], v[56:57] op_sel_hi:[1,0]
  v_pk_mul_f32 v[76:77], v[76:77], v[56:57] op_sel_hi:[1,0]
  v_pk_mul_f32 v[78:79], v[78:79], v[56:57] op_sel_hi:[1,0]
  v_pk_mul_f32 v[88:89], v[88:89], v[56:57] op_sel_hi:[1,0]
  buffer_load_dwordx4 a[148:151], v20, s[60:63], s20 offen offset:2048 sc1
  v_pk_mul_f32 v[90:91], v[90:91], v[56:57] op_sel_hi:[1,0]
  v_pk_mul_f32 v[92:93], v[92:93], v[56:57] op_sel_hi:[1,0]
  v_pk_mul_f32 v[94:95], v[94:95], v[56:57] op_sel_hi:[1,0]
  v_pk_mul_f32 v[104:105], v[104:105], v[56:57] op_sel_hi:[1,0]
  v_pk_mul_f32 v[106:107], v[106:107], v[56:57] op_sel_hi:[1,0]
  v_pk_mul_f32 v[108:109], v[108:109], v[56:57] op_sel_hi:[1,0]
  buffer_load_dwordx4 a[152:155], v20, s[60:63], s20 offen offset:3072 sc1
  v_pk_mul_f32 v[110:111], v[110:111], v[56:57] op_sel_hi:[1,0]
  v_pk_mul_f32 v[64:65], v[64:65], v[72:73]
  v_pk_mul_f32 v[66:67], v[66:67], v[74:75]
  v_pk_mul_f32 v[68:69], v[68:69], v[76:77]
  v_pk_mul_f32 v[70:71], v[70:71], v[78:79]
  v_pk_mul_f32 v[80:81], v[80:81], v[88:89]
  s_add_u32 s20, s20, 4096
  buffer_load_dwordx4 a[156:159], v20, s[60:63], s20 offen sc1
  v_pk_mul_f32 v[82:83], v[82:83], v[90:91]
  v_pk_mul_f32 v[84:85], v[84:85], v[92:93]
  v_pk_mul_f32 v[86:87], v[86:87], v[94:95]
  v_pk_mul_f32 v[96:97], v[96:97], v[104:105]
  v_pk_mul_f32 v[98:99], v[98:99], v[106:107]
  v_pk_mul_f32 v[100:101], v[100:101], v[108:109]
  s_add_u32 s20, s14, 163840
  s_cmp_ge_u32 s20, 266240
  s_cselect_b32 s21, 266240, 0
  s_sub_u32 s20, s20, s21
  s_add_u32 s20, s20, s13
  buffer_load_dwordx4 a[160:163], v20, s[60:63], s20 offen offset:0 sc1
  v_pk_mul_f32 v[102:103], v[102:103], v[110:111]
  v_pk_mul_f32 v[120:121], v[120:121], v[58:59] op_sel_hi:[1,0]
  v_pk_mul_f32 v[122:123], v[122:123], v[58:59] op_sel_hi:[1,0]
  v_pk_mul_f32 v[124:125], v[124:125], v[58:59] op_sel_hi:[1,0]
  v_pk_mul_f32 v[126:127], v[126:127], v[58:59] op_sel_hi:[1,0]
  v_pk_mul_f32 v[136:137], v[136:137], v[58:59] op_sel_hi:[1,0]
  buffer_load_dwordx4 a[164:167], v20, s[60:63], s20 offen offset:1024 sc1
  v_pk_mul_f32 v[138:139], v[138:139], v[58:59] op_sel_hi:[1,0]
  v_pk_mul_f32 v[140:141], v[140:141], v[58:59] op_sel_hi:[1,0]
  v_pk_mul_f32 v[142:143], v[142:143], v[58:59] op_sel_hi:[1,0]
  v_pk_mul_f32 v[152:153], v[152:153], v[58:59] op_sel_hi:[1,0]
  v_pk_mul_f32 v[154:155], v[154:155], v[58:59] op_sel_hi:[1,0]
  v_pk_mul_f32 v[156:157], v[156:157], v[58:59] op_sel_hi:[1,0]
  buffer_load_dwordx4 a[168:171], v20, s[60:63], s20 offen offset:2048 sc1
  v_pk_mul_f32 v[158:159], v[158:159], v[58:59] op_sel_hi:[1,0]
  v_cvt_pk_bf16_f32 v72, v64, v65
  v_cvt_pk_bf16_f32 v73, v66, v67
  v_cvt_pk_bf16_f32 v74, v68, v69
  v_cvt_pk_bf16_f32 v75, v70, v71
  v_cvt_pk_bf16_f32 v88, v80, v81
  buffer_load_dwordx4 a[172:175], v20, s[60:63], s20 offen offset:3072 sc1
  v_cvt_pk_bf16_f32 v89, v82, v83
  v_cvt_pk_bf16_f32 v90, v84, v85
  v_cvt_pk_bf16_f32 v91, v86, v87
  v_cvt_pk_bf16_f32 v104, v96, v97
  v_cvt_pk_bf16_f32 v105, v98, v99
  v_cvt_pk_bf16_f32 v106, v100, v101
  s_add_u32 s20, s20, 4096
  buffer_load_dwordx4 a[176:179], v20, s[60:63], s20 offen sc1
  v_cvt_pk_bf16_f32 v107, v102, v103
  v_pk_mul_f32 v[112:113], v[112:113], v[120:121]
  v_pk_mul_f32 v[114:115], v[114:115], v[122:123]
  v_pk_mul_f32 v[116:117], v[116:117], v[124:125]
  v_pk_mul_f32 v[118:119], v[118:119], v[126:127]
  v_pk_mul_f32 v[128:129], v[128:129], v[136:137]
  s_add_u32 s20, s14, 184320
  s_cmp_ge_u32 s20, 266240
  s_cselect_b32 s21, 266240, 0
  s_sub_u32 s20, s20, s21
  s_add_u32 s20, s20, s13
  buffer_load_dwordx4 a[224:227], v20, s[60:63], s20 offen offset:0 sc1
  v_pk_mul_f32 v[130:131], v[130:131], v[138:139]
  v_pk_mul_f32 v[132:133], v[132:133], v[140:141]
  v_pk_mul_f32 v[134:135], v[134:135], v[142:143]
  v_pk_mul_f32 v[144:145], v[144:145], v[152:153]
  v_pk_mul_f32 v[146:147], v[146:147], v[154:155]
  v_pk_mul_f32 v[148:149], v[148:149], v[156:157]
  buffer_load_dwordx4 a[228:231], v20, s[60:63], s20 offen offset:1024 sc1
  v_pk_mul_f32 v[150:151], v[150:151], v[158:159]
  buffer_store_dwordx4 v[72:75], v16, s[52:55], s76 offen offset:0 sc1
  v_cvt_pk_bf16_f32 v120, v112, v113
  v_cvt_pk_bf16_f32 v121, v114, v115
  v_cvt_pk_bf16_f32 v122, v116, v117
  v_cvt_pk_bf16_f32 v123, v118, v119
  buffer_load_dwordx4 a[232:235], v20, s[60:63], s20 offen offset:2048 sc1
  v_cvt_pk_bf16_f32 v136, v128, v129
  v_cvt_pk_bf16_f32 v137, v130, v131
  v_cvt_pk_bf16_f32 v138, v132, v133
  v_cvt_pk_bf16_f32 v139, v134, v135
  v_cvt_pk_bf16_f32 v152, v144, v145
  v_cvt_pk_bf16_f32 v153, v146, v147
  buffer_load_dwordx4 a[236:239], v20, s[60:63], s20 offen offset:3072 sc1
  v_cvt_pk_bf16_f32 v154, v148, v149
  v_cvt_pk_bf16_f32 v155, v150, v151
  v_pk_mul_f32 v[168:169], v[168:169], v[60:61] op_sel_hi:[1,0]
  buffer_store_dwordx4 v[88:91], v16, s[52:55], s76 offen offset:512 sc1
  v_pk_mul_f32 v[170:171], v[170:171], v[60:61] op_sel_hi:[1,0]
  v_pk_mul_f32 v[172:173], v[172:173], v[60:61] op_sel_hi:[1,0]
  s_add_u32 s20, s20, 4096
  buffer_load_dwordx4 a[240:243], v20, s[60:63], s20 offen sc1
  v_pk_mul_f32 v[174:175], v[174:175], v[60:61] op_sel_hi:[1,0]
  v_pk_mul_f32 v[184:185], v[184:185], v[60:61] op_sel_hi:[1,0]
  v_pk_mul_f32 v[186:187], v[186:187], v[60:61] op_sel_hi:[1,0]
  v_pk_mul_f32 v[188:189], v[188:189], v[60:61] op_sel_hi:[1,0]
  v_pk_mul_f32 v[190:191], v[190:191], v[60:61] op_sel_hi:[1,0]
  v_pk_mul_f32 v[200:201], v[200:201], v[60:61] op_sel_hi:[1,0]
  v_pk_mul_f32 v[202:203], v[202:203], v[60:61] op_sel_hi:[1,0]
  v_pk_mul_f32 v[204:205], v[204:205], v[60:61] op_sel_hi:[1,0]
  v_pk_mul_f32 v[206:207], v[206:207], v[60:61] op_sel_hi:[1,0]
  v_max_f32 v213, 0, v213
  v_max_f32 v214, 0, v214
  buffer_store_dwordx4 v[104:107], v16, s[52:55], s76 offen offset:1024 sc1
  v_max_f32 v215, 0, v215
  v_pk_mul_f32 v[216:217], v[216:217], v[62:63] op_sel_hi:[1,0]
  v_pk_mul_f32 v[218:219], v[218:219], v[62:63] op_sel_hi:[1,0]
  v_pk_mul_f32 v[220:221], v[220:221], v[62:63] op_sel_hi:[1,0]
  v_pk_mul_f32 v[222:223], v[222:223], v[62:63] op_sel_hi:[1,0]
  v_max_f32 v224, 0, v224
  v_max_f32 v225, 0, v225
  v_max_f32 v226, 0, v226
  v_max_f32 v227, 0, v227
  v_max_f32 v228, 0, v228
  v_max_f32 v229, 0, v229
  v_max_f32 v230, 0, v230
  v_max_f32 v231, 0, v231
  buffer_store_dwordx4 v[120:123], v16, s[52:55], s80 offen offset:0 sc1
  v_pk_mul_f32 v[232:233], v[232:233], v[62:63] op_sel_hi:[1,0]
  v_pk_mul_f32 v[234:235], v[234:235], v[62:63] op_sel_hi:[1,0]
  v_pk_mul_f32 v[236:237], v[236:237], v[62:63] op_sel_hi:[1,0]
  v_pk_mul_f32 v[238:239], v[238:239], v[62:63] op_sel_hi:[1,0]
  v_max_f32 v240, 0, v240
  v_max_f32 v241, 0, v241
  v_max_f32 v242, 0, v242
  v_max_f32 v243, 0, v243
  v_max_f32 v244, 0, v244
  v_max_f32 v245, 0, v245
  v_max_f32 v246, 0, v246
  v_max_f32 v247, 0, v247
  v_pk_mul_f32 v[248:249], v[248:249], v[62:63] op_sel_hi:[1,0]
  buffer_store_dwordx4 v[136:139], v16, s[52:55], s80 offen offset:512 sc1
  v_pk_mul_f32 v[250:251], v[250:251], v[62:63] op_sel_hi:[1,0]
  v_pk_mul_f32 v[252:253], v[252:253], v[62:63] op_sel_hi:[1,0]
  v_pk_mul_f32 v[254:255], v[254:255], v[62:63] op_sel_hi:[1,0]
  s_add_u32 s76, s67, 2
  s_mul_i32 s76, s76, 110592
  s_add_u32 s76, s76, s81
  v_pk_mul_f32 v[160:161], v[160:161], v[168:169]
  v_pk_mul_f32 v[162:163], v[162:163], v[170:171]
  v_pk_mul_f32 v[164:165], v[164:165], v[172:173]
  v_pk_mul_f32 v[166:167], v[166:167], v[174:175]
  v_pk_mul_f32 v[176:177], v[176:177], v[184:185]
  v_pk_mul_f32 v[178:179], v[178:179], v[186:187]
  v_pk_mul_f32 v[180:181], v[180:181], v[188:189]
  buffer_store_dwordx4 v[152:155], v16, s[52:55], s80 offen offset:1024 sc1
  v_pk_mul_f32 v[182:183], v[182:183], v[190:191]
  v_pk_mul_f32 v[192:193], v[192:193], v[200:201]
  v_pk_mul_f32 v[194:195], v[194:195], v[202:203]
  v_pk_mul_f32 v[196:197], v[196:197], v[204:205]
  v_pk_mul_f32 v[198:199], v[198:199], v[206:207]
  v_pk_mul_f32 v[208:209], v[208:209], v[216:217]
  v_pk_mul_f32 v[210:211], v[210:211], v[218:219]
  v_pk_mul_f32 v[212:213], v[212:213], v[220:221]
  v_pk_mul_f32 v[214:215], v[214:215], v[222:223]
  v_pk_mul_f32 v[224:225], v[224:225], v[232:233]
  v_pk_mul_f32 v[226:227], v[226:227], v[234:235]
  v_pk_mul_f32 v[228:229], v[228:229], v[236:237]
  v_pk_mul_f32 v[230:231], v[230:231], v[238:239]
  v_pk_mul_f32 v[240:241], v[240:241], v[248:249]
  v_pk_mul_f32 v[242:243], v[242:243], v[250:251]
  v_pk_mul_f32 v[244:245], v[244:245], v[252:253]
  v_pk_mul_f32 v[246:247], v[246:247], v[254:255]
  v_cvt_pk_bf16_f32 v168, v160, v161
  v_cvt_pk_bf16_f32 v169, v162, v163
  v_cvt_pk_bf16_f32 v170, v164, v165
  v_cvt_pk_bf16_f32 v171, v166, v167
  v_cvt_pk_bf16_f32 v184, v176, v177
  v_cvt_pk_bf16_f32 v185, v178, v179
  v_cvt_pk_bf16_f32 v186, v180, v181
  v_cvt_pk_bf16_f32 v187, v182, v183
  v_cvt_pk_bf16_f32 v200, v192, v193
  v_cvt_pk_bf16_f32 v201, v194, v195
  v_cvt_pk_bf16_f32 v202, v196, v197
  v_cvt_pk_bf16_f32 v203, v198, v199
  s_add_u32 s80, s67, 3
  s_mul_i32 s80, s80, 110592
  s_add_u32 s80, s80, s81
  v_cvt_pk_bf16_f32 v216, v208, v209
  v_cvt_pk_bf16_f32 v217, v210, v211
  v_cvt_pk_bf16_f32 v218, v212, v213
  v_cvt_pk_bf16_f32 v219, v214, v215
  v_cvt_pk_bf16_f32 v232, v224, v225
  v_cvt_pk_bf16_f32 v233, v226, v227
  v_cvt_pk_bf16_f32 v234, v228, v229
  v_cvt_pk_bf16_f32 v235, v230, v231
  v_cvt_pk_bf16_f32 v248, v240, v241
  v_cvt_pk_bf16_f32 v249, v242, v243
  v_cvt_pk_bf16_f32 v250, v244, v245
  v_cvt_pk_bf16_f32 v251, v246, v247
  buffer_store_dwordx4 v[168:171], v16, s[52:55], s76 offen offset:0 sc1
  buffer_store_dwordx4 v[184:187], v16, s[52:55], s76 offen offset:512 sc1
  buffer_store_dwordx4 v[200:203], v16, s[52:55], s76 offen offset:1024 sc1
  buffer_store_dwordx4 v[216:219], v16, s[52:55], s80 offen offset:0 sc1
  buffer_store_dwordx4 v[232:235], v16, s[52:55], s80 offen offset:512 sc1
  buffer_store_dwordx4 v[248:251], v16, s[52:55], s80 offen offset:1024 sc1
  s_lshl_b32 s81, s66, 4
  s_add_u32 s81, s81, s65
  s_lshl_b32 s81, s81, 2
  s_add_u32 s81, s81, 5120
  s_and_b32 s78, s84, s81
  s_andn2_b32 s81, 1073741824, s84
  s_or_b32 s81, s81, s78
  s_mov_b32 s80, 0
  s_nop 1
  s_cmp_eq_u32 s84, 0
  s_cbranch_scc1 L_epi_att
  s_branch L_Bpre
L_km_zero:
  s_waitcnt lgkmcnt(0)
  s_add_u32 s44, s22, 40960
  s_addc_u32 s45, s23, 0
  s_mov_b32 s46, 12288
  s_mov_b32 s47, 0x20000
  s_mov_b32 s48, s20
  s_mov_b32 s49, s21
  s_mov_b32 s50, 256
  s_mov_b32 s51, 0x20000
  v_mov_b32 v4, 0
  v_mov_b32 v5, 0
  v_mov_b32 v6, 0
  v_mov_b32 v7, 0
  v_lshlrev_b32 v8, 4, v0
  buffer_store_dwordx4 v[4:7], v8, s[44:47], 0 offen sc1
  v_add_u32 v9, 4096, v8
  buffer_store_dwordx4 v[4:7], v9, s[44:47], 0 offen sc1
  v_add_u32 v10, 8192, v8
  buffer_store_dwordx4 v[4:7], v10, s[44:47], 0 offen sc1
  s_waitcnt vmcnt(0)
  s_barrier
  v_mov_b32 v4, 1
  v_cmp_eq_u32 vcc, 0, v0
  v_mov_b32 v8, 1073741824
  s_nop 0
  v_cndmask_b32 v8, v8, 0, vcc
  buffer_store_dword v4, v8, s[48:51], 0 offen sc1
  s_waitcnt vmcnt(0)
  s_branch L_km_nozero
L_spin_ffn:
  s_mov_b32 s79, 0x40000
L_spin_ffn_loop:
  s_sleep 2
  s_mov_b32 s80, 4096
  buffer_load_dwordx4 v[52:55], v25, s[44:47], s80 offen sc1
  s_waitcnt vmcnt(0)
  v_and_b32 v52, v52, v53
  v_and_b32 v54, v54, v55
  v_and_b32 v52, v52, v54
  v_cmp_ne_u32 vcc, 1, v52
  s_nop 3
  s_cbranch_vccz L_spin_ffn_go
  s_sub_u32 s79, s79, 1
  s_cmp_lg_u32 s79, 0
  s_cbranch_scc1 L_spin_ffn_loop
  s_branch L_spin_ffn_go
L_zspin_ffn:
  s_mov_b32 s79, 0x40000
L_zspin_ffn_loop:
  s_sleep 2
  buffer_load_dword v59, v58, s[48:51], 0 offen sc1
  s_waitcnt vmcnt(0)
  v_cmp_ne_u32 vcc, 1, v59
  s_nop 3
  s_cbranch_vccz L_zspin_ffn_go
  s_sub_u32 s79, s79, 1
  s_cmp_lg_u32 s79, 0
  s_cbranch_scc1 L_zspin_ffn_loop
  s_branch L_zspin_ffn_go
L_spin_att:
  s_mov_b32 s79, 0x40000
L_spin_att_loop:
  s_sleep 2
  s_mov_b32 s80, 4096
  buffer_load_dwordx4 v[60:63], v33, s[44:47], s80 offen sc1
  s_waitcnt vmcnt(0)
  v_and_b32 v60, v60, v61
  v_and_b32 v62, v62, v63
  v_and_b32 v60, v60, v62
  v_cmp_ne_u32 vcc, 1, v60
  s_nop 3
  s_cbranch_vccz L_spin_att_go
  s_sub_u32 s79, s79, 1
  s_cmp_lg_u32 s79, 0
  s_cbranch_scc1 L_spin_att_loop
  s_branch L_spin_att_go
L_zspin_att:
  s_mov_b32 s79, 0x40000
L_zspin_att_loop:
  s_sleep 2
  buffer_load_dword v67, v66, s[48:51], 0 offen sc1
  s_waitcnt vmcnt(0)
  v_cmp_ne_u32 vcc, 1, v67
  s_nop 3
  s_cbranch_vccz L_zspin_att_go
  s_sub_u32 s79, s79, 1
  s_cmp_lg_u32 s79, 0
  s_cbranch_scc1 L_zspin_att_loop
  s_branch L_zspin_att_go
L_spin_spare:
  s_mov_b32 s79, 0x40000
L_spin_spare_loop:
  s_sleep 2
  s_mov_b32 s80, 4096
  buffer_load_dwordx4 v[60:63], v33, s[44:47], s80 offen sc1
  s_waitcnt vmcnt(0)
  v_and_b32 v60, v60, v61
  v_and_b32 v62, v62, v63
  v_and_b32 v60, v60, v62
  v_cmp_ne_u32 vcc, 1, v60
  s_nop 3
  s_cbranch_vccz L_spin_spare_go
  s_sub_u32 s79, s79, 1
  s_cmp_lg_u32 s79, 0
  s_cbranch_scc1 L_spin_spare_loop
  s_branch L_spin_spare_go
L_zspin_satt:
  s_mov_b32 s79, 0x40000
L_zspin_satt_loop:
  s_sleep 2
  buffer_load_dword v67, v66, s[48:51], 0 offen sc1
  s_waitcnt vmcnt(0)
  v_cmp_ne_u32 vcc, 1, v67
  s_nop 3
  s_cbranch_vccz L_zspin_satt_go
  s_sub_u32 s79, s79, 1
  s_cmp_lg_u32 s79, 0
  s_cbranch_scc1 L_zspin_satt_loop
  s_branch L_zspin_satt_go
L_AL_spin:
  s_mov_b32 s3, 0x40000
L_AL_loop:
  buffer_load_dword v3, v12, s[44:47], s11 offen sc1
  s_waitcnt vmcnt(0)
  v_cmp_ne_u32 vcc, 1, v3
  s_nop 3
  s_and_b64 vcc, vcc, s[8:9]
  s_cbranch_vccz L_AL_go
  s_sleep 1
  s_sub_u32 s3, s3, 1
  s_cmp_lg_u32 s3, 0
  s_cbranch_scc1 L_AL_loop
  s_branch L_AL_go
L_spare_att:
  s_waitcnt vmcnt(0) lgkmcnt(0)
  buffer_load_dwordx4 v[32:35], v45, s[52:55], 0 offen
  buffer_load_dwordx4 v[36:39], v45, s[52:55], 0 offen offset:512
  buffer_load_dwordx4 v[40:43], v46, s[52:55], 0 offen
  v_accvgpr_read_b32 v54, a128
  s_lshl_b32 s75, s64, 12
  s_add_u32 m0, s75, 126976
  s_nop 0
  buffer_load_dwordx4 v54, s[56:59], 0 offen nt lds
  v_accvgpr_read_b32 v55, a129
  s_lshl_b32 s75, s64, 12
  s_add_u32 m0, s75, 128000
  s_nop 0
  buffer_load_dwordx4 v55, s[56:59], 0 offen nt lds
  v_accvgpr_read_b32 v54, a130
  s_lshl_b32 s75, s64, 12
  s_add_u32 m0, s75, 129024
  s_nop 0
  buffer_load_dwordx4 v54, s[56:59], 0 offen nt lds
  v_accvgpr_read_b32 v55, a131
  s_lshl_b32 s75, s64, 12
  s_add_u32 m0, s75, 130048
  s_nop 0
  buffer_load_dwordx4 v55, s[56:59], 0 offen nt lds
  s_lshl_b32 s76, s83, 2
  s_mul_hi_u32 s77, s76, 0x33333334
  s_mul_i32 s78, s77, 5
  s_sub_u32 s78, s76, s78
  s_mul_i32 s77, s77, 74
  s_add_u32 s77, s77, s82
  s_mul_i32 s77, s77, 5120
  s_lshl_b32 s76, s78, 10
  s_add_u32 s77, s77, s76
  s_add_u32 s6, s77, 2621440
  s_cmp_ge_u32 s82, 74
  s_cselect_b32 s6, 1073741824, s6
  s_cmp_eq_u32 s78, 4
  s_cselect_b32 s76, 373760, 0
  s_add_u32 s7, s6, s76
  s_cmp_eq_u32 s78, 3
  s_cselect_b32 s76, 373760, 0
  s_add_u32 s10, s7, s76
  s_cmp_eq_u32 s78, 2
  s_cselect_b32 s76, 373760, 0
  s_add_u32 s11, s10, s76
  s_mov_b32 s76, 0x3f803f80
  v_mov_b32 v70, 0
  v_mov_b32 v71, 0
  v_mov_b32 v44, 0
  v_mov_b32 v45, 0
  s_waitcnt vmcnt(6)
  v_dot2_f32_bf16 v70, v32, s76, v70
  v_dot2_f32_bf16 v71, v32, v32, v71
  v_dot2_f32_bf16 v44, v33, s76, v44
  v_dot2_f32_bf16 v45, v33, v33, v45
  v_dot2_f32_bf16 v70, v34, s76, v70
  v_dot2_f32_bf16 v71, v34, v34, v71
  v_dot2_f32_bf16 v44, v35, s76, v44
  v_dot2_f32_bf16 v45, v35, v35, v45
  s_waitcnt vmcnt(5)
  v_dot2_f32_bf16 v70, v36, s76, v70
  v_dot2_f32_bf16 v71, v36, v36, v71
  v_dot2_f32_bf16 v44, v37, s76, v44
  v_dot2_f32_bf16 v45, v37, v37, v45
  v_dot2_f32_bf16 v70, v38, s76, v70
  v_dot2_f32_bf16 v71, v38, v38, v71
  v_dot2_f32_bf16 v44, v39, s76, v44
  v_dot2_f32_bf16 v45, v39, v39, v45
  s_waitcnt vmcnt(4)
  v_dot2_f32_bf16 v70, v40, s76, v70
  v_dot2_f32_bf16 v71, v40, v40, v71
  v_dot2_f32_bf16 v44, v41, s76, v44
  v_dot2_f32_bf16 v45, v41, v41, v45
  v_dot2_f32_bf16 v70, v42, s76, v70
  v_dot2_f32_bf16 v71, v42, v42, v71
  v_dot2_f32_bf16 v44, v43, s76, v44
  v_dot2_f32_bf16 v45, v43, v43, v45
  s_nop 2
  v_pk_add_f32 v[70:71], v[70:71], v[44:45]
  s_nop 1
  v_add_f32_dpp v70, v70, v70 row_ror:8 row_mask:0xf bank_mask:0xf
  v_add_f32_dpp v71, v71, v71 row_ror:8 row_mask:0xf bank_mask:0xf
  s_nop 0
  v_add_f32_dpp v70, v70, v70 row_ror:4 row_mask:0xf bank_mask:0xf
  v_add_f32_dpp v71, v71, v71 row_ror:4 row_mask:0xf bank_mask:0xf
  s_nop 0
  v_add_f32_dpp v70, v70, v70 row_ror:2 row_mask:0xf bank_mask:0xf
  v_add_f32_dpp v71, v71, v71 row_ror:2 row_mask:0xf bank_mask:0xf
  s_nop 0
  v_add_f32_dpp v70, v70, v70 row_ror:1 row_mask:0xf bank_mask:0xf
  v_add_f32_dpp v71, v71, v71 row_ror:1 row_mask:0xf bank_mask:0xf
  v_mov_b32 v44, v70
  v_mov_b32 v45, v71
  s_nop 0
  v_permlane16_swap_b32 v70, v44
  v_permlane16_swap_b32 v71, v45
  v_pk_add_f32 v[70:71], v[70:71], v[44:45]
  v_mul_f32 v70, 0x3acccccd, v70
  v_mul_f32 v71, 0x3acccccd, v71
  v_fma_f32 v71, -v70, v70, v71
  v_max_f32 v71, 0, v71
  v_add_f32 v71, 0x3727c5ac, v71
  v_rsq_f32 v71, v71
  v_lshlrev_b32 v32, 3, v68
  v_and_b32 v33, 31, v1
  v_cmp_eq_u32 vcc, 0, v33
  v_mov_b32 v33, 1073741824
  s_nop 0
  v_cndmask_b32 v32, v33, v32, vcc
  buffer_store_dwordx2 v[70:71], v32, s[32:35], 0 offen sc1
  s_waitcnt vmcnt(1)
  ds_read_b64_tr_b16 a[132:133], v14 offset:0
  ds_read_b64_tr_b16 a[134:135], v14 offset:512
  ds_read_b64_tr_b16 a[136:137], v14 offset:32
  ds_read_b64_tr_b16 a[138:139], v14 offset:544
  ds_read_b64_tr_b16 a[140:141], v14 offset:64
  ds_read_b64_tr_b16 a[142:143], v14 offset:576
  ds_read_b64_tr_b16 a[144:145], v14 offset:96
  ds_read_b64_tr_b16 a[146:147], v14 offset:608
  s_waitcnt lgkmcnt(6)
  buffer_store_dwordx4 a[132:135], v15, s[40:43], s6 offen offset:0 sc1
  s_waitcnt lgkmcnt(4)
  buffer_store_dwordx4 a[136:139], v15, s[40:43], s7 offen offset:1024 sc1
  s_waitcnt lgkmcnt(2)
  buffer_store_dwordx4 a[140:143], v15, s[40:43], s10 offen offset:2048 sc1
  s_waitcnt lgkmcnt(0)
  buffer_store_dwordx4 a[144:147], v15, s[40:43], s11 offen offset:3072 sc1
  v_accvgpr_write_b32 a148, 0
  v_accvgpr_write_b32 a149, 0
  v_accvgpr_write_b32 a150, 0
  v_accvgpr_write_b32 a151, 0
  s_mul_i32 s80, s2, 10240
  s_lshl_b32 s78, s64, 10
  s_add_u32 s80, s80, s78
  buffer_store_dwordx4 a[148:151], v15, s[40:43], s80 offen sc1
  s_add_u32 s80, s80, 4096
  buffer_store_dwordx4 a[148:151], v15, s[40:43], s80 offen sc1
  s_add_u32 s80, s80, 4096
  s_cmp_ge_u32 s64, 2
  s_cselect_b32 s80, 1073741824, s80
  buffer_store_dwordx4 a[148:151], v15, s[40:43], s80 offen sc1
  s_lshl_b32 s80, s65, 4
  s_add_u32 s80, s80, s66
  s_lshl_b32 s80, s80, 2
  s_add_u32 s80, s80, s64
  s_lshl_b32 s80, s80, 12
  s_add_u32 s80, s80, 8273920
  buffer_store_dwordx4 a[148:151], v15, s[40:43], s80 offen offset:0 sc1
  buffer_store_dwordx4 a[148:151], v15, s[40:43], s80 offen offset:1024 sc1
  buffer_store_dwordx4 a[148:151], v15, s[40:43], s80 offen offset:2048 sc1
  buffer_store_dwordx4 a[148:151], v15, s[40:43], s80 offen offset:3072 sc1
  v_mov_b32 v66, 0
  s_cmp_eq_u32 s64, 0
  s_cselect_b32 s80, 0, 1073741824
  buffer_load_dword v67, v66, s[48:51], s80 offen sc1
  s_waitcnt vmcnt(0)
  s_cmp_eq_u32 s64, 0
  s_cselect_b64 s[76:77], -1, 0
  v_cmp_ne_u32 vcc, 1, v67
  s_and_b64 vcc, vcc, s[76:77]
  s_cbranch_vccnz L_zspin_satt
L_zspin_satt_go:
  s_barrier
  s_lshl_b32 s80, s2, 2
  s_add_u32 s80, s80, 4096
  v_cmp_eq_u32 vcc, 0, v1
  v_mov_b32 v70, 1073741824
  s_nop 0
  v_cndmask_b32 v70, v70, 0, vcc
  v_mov_b32 v71, 1
  s_cmp_eq_u32 s64, 0
  s_cselect_b32 s79, s80, 1073741824
  buffer_store_dword v71, v70, s[44:47], s79 offen sc1
  s_mul_i32 s80, s12, 378880
  s_add_u32 s80, s80, 9752576
  s_add_u32 s60, s22, s80
  s_addc_u32 s61, s23, 0
  s_and_b32 s62, s84, 378880
  s_mov_b32 s63, 0x20000
  s_waitcnt vmcnt(0) lgkmcnt(0)
  s_mov_b32 s34, 0
  s_mov_b32 s42, 0
  s_mov_b32 s46, 0
  s_mov_b32 s50, 0
  s_mov_b32 s54, 0
  s_mov_b32 s58, 0
  v_mov_b32 v2, 0
  v_mov_b32 v3, 0
  v_mov_b32 v4, 0
  v_mov_b32 v5, 0
  v_mov_b32 v6, 0
  v_mov_b32 v7, 0
  v_mov_b32 v8, 0
  v_mov_b32 v9, 0
  v_mov_b32 v10, 0
  v_mov_b32 v11, 0
  v_mov_b32 v12, 0
  v_mov_b32 v13, 0
  v_mov_b32 v14, 0
  v_mov_b32 v15, 0
  v_mov_b32 v16, 0
  v_mov_b32 v17, 0
  v_mov_b32 v18, 0
  v_mov_b32 v19, 0
  v_mov_b32 v20, 0
  v_mov_b32 v21, 0
  v_mov_b32 v22, 0
  v_mov_b32 v23, 0
  v_mov_b32 v100, 0
  v_mov_b32 v101, 0
  v_mov_b32 v102, 0
  v_mov_b32 v103, 0
  s_mov_b32 s81, 0
  s_mov_b32 s80, 0
  s_mov_b64 exec, 0
  s_cmp_eq_u32 s64, 0
  s_cbranch_scc1 L_epi_ffn
  s_cmp_eq_u32 s64, 1
  s_cbranch_scc1 L_dry1
  s_cmp_eq_u32 s64, 2
  s_cbranch_scc1 L_dry2
  s_mov_b32 s80, 1
  s_branch L_dry3
L_BLF_spin:
  s_mov_b32 s3, 0x40000
L_BLF_loop:
  buffer_load_dword v48, v5, s[48:51], s73 offen sc1
  s_waitcnt vmcnt(0)
  v_cmp_ne_u32 vcc, 1, v48
  s_nop 3
  s_and_b64 vcc, vcc, s[82:83]
  s_cbranch_vccz L_BLF_go
  s_sleep 1
  s_sub_u32 s3, s3, 1
  s_cmp_lg_u32 s3, 0
  s_cbranch_scc1 L_BLF_loop
  s_branch L_BLF_go
L_BL_spin:
  s_mov_b32 s3, 0x40000
L_BL_loop:
  buffer_load_dword v48, v5, s[48:51], s73 offen sc1
  s_waitcnt vmcnt(0)
  v_cmp_ne_u32 vcc, 1, v48
  s_nop 3
  s_and_b64 vcc, vcc, s[82:83]
  s_cbranch_vccz L_BL_go
  s_sleep 1
  s_sub_u32 s3, s3, 1
  s_cmp_lg_u32 s3, 0
  s_cbranch_scc1 L_BL_loop
  s_branch L_BL_go
L_BK_spin:
  s_mov_b32 s3, 0x40000
L_BK_loop:
  buffer_load_dword v111, v3, s[36:39], s17 offen sc1
  s_waitcnt vmcnt(0)
  v_cmp_eq_u32 vcc, 0, v111
  s_nop 3
  s_and_b64 vcc, vcc, s[10:11]
  s_cbranch_vccz L_BK_go
  s_sleep 1
  s_sub_u32 s3, s3, 1
  s_cmp_lg_u32 s3, 0
  s_cbranch_scc1 L_BK_loop
  s_branch L_BK_go
L_BH_spin:
  s_mov_b32 s3, 0x40000
L_BH_loop:
  buffer_load_dword v108, v5, s[48:51], s16 offen sc1
  s_waitcnt vmcnt(0)
  v_cmp_ne_u32 vcc, 1, v108
  s_nop 3
  s_and_b64 vcc, vcc, s[8:9]
  s_cbranch_vccz L_BH_go
  s_sleep 1
  s_sub_u32 s3, s3, 1
  s_cmp_lg_u32 s3, 0
  s_cbranch_scc1 L_BH_loop
  s_branch L_BH_go
L_BV_retry:
  s_mov_b32 s3, 0x20000
L_BV_loop:
  s_mov_b32 s75, 0
  buffer_load_dwordx4 v[48:51], v4, s[36:39], s75 offen sc1
  s_mov_b32 s75, 16384
  buffer_load_dwordx4 v[52:55], v4, s[36:39], s75 offen sc1
  s_mov_b32 s75, 32768
  buffer_load_dwordx4 v[56:59], v4, s[36:39], s75 offen sc1
  s_mov_b32 s75, 49152
  buffer_load_dwordx4 v[60:63], v4, s[36:39], s75 offen sc1
  s_mov_b32 s75, 65536
  buffer_load_dwordx4 v[64:67], v4, s[36:39], s75 offen sc1
  s_mov_b32 s75, 81920
  buffer_load_dwordx4 v[68:71], v4, s[36:39], s75 offen sc1
  s_mov_b32 s75, 98304
  buffer_load_dwordx4 v[72:75], v4, s[36:39], s75 offen sc1
  s_mov_b32 s75, 114688
  buffer_load_dwordx4 v[76:79], v4, s[36:39], s75 offen sc1
  s_mov_b32 s75, 131072
  buffer_load_dwordx4 v[80:83], v4, s[36:39], s75 offen sc1
  s_mov_b32 s75, 147456
  buffer_load_dwordx4 v[84:87], v4, s[36:39], s75 offen sc1
  s_mov_b32 s75, 163840
  buffer_load_dwordx4 v[88:91], v4, s[36:39], s75 offen sc1
  s_mov_b32 s75, 180224
  buffer_load_dwordx4 v[92:95], v4, s[36:39], s75 offen sc1
  s_mov_b32 s75, 196608
  buffer_load_dwordx4 v[96:99], v4, s[36:39], s75 offen sc1
  s_waitcnt vmcnt(0)
  v_min3_u32 v104, v48, v49, v50
  v_min3_u32 v104, v104, v51, v52
  v_min3_u32 v104, v104, v53, v54
  v_min3_u32 v104, v104, v55, v56
  v_min3_u32 v104, v104, v57, v58
  v_min3_u32 v104, v104, v59, v60
  v_min3_u32 v104, v104, v61, v62
  v_min3_u32 v104, v104, v63, v64
  v_min3_u32 v104, v104, v65, v66
  v_min3_u32 v104, v104, v67, v68
  v_min3_u32 v104, v104, v69, v70
  v_min3_u32 v104, v104, v71, v72
  v_min3_u32 v104, v104, v73, v74
  v_min3_u32 v104, v104, v75, v76
  v_min3_u32 v104, v104, v77, v78
  v_min3_u32 v104, v104, v79, v80
  v_min3_u32 v104, v104, v81, v82
  v_min3_u32 v104, v104, v83, v84
  v_min3_u32 v104, v104, v85, v86
  v_min3_u32 v104, v104, v87, v88
  v_min3_u32 v104, v104, v89, v90
  v_min3_u32 v104, v104, v91, v92
  v_min3_u32 v104, v104, v93, v94
  v_min3_u32 v104, v104, v95, v96
  v_min3_u32 v104, v104, v97, v98
  v_min_u32 v104, v104, v99
  v_cmp_eq_u32 vcc, 0, v104
  s_nop 3
  s_and_b64 vcc, vcc, s[6:7]
  s_cbranch_vccz L_BV_ok
  s_sub_u32 s3, s3, 1
  s_cmp_lg_u32 s3, 0
  s_cbranch_scc1 L_BV_loop
  s_branch L_BV_ok
L_Bo14_retry:
  s_mov_b32 s3, 0x20000
L_Bo14_loop:
  s_lshl_b32 s75, s64, 10
  s_add_u32 s75, s75, 0
  buffer_load_dwordx4 v[84:87], v10, s[28:31], s75 offen sc1
  buffer_load_dwordx4 v[88:91], v11, s[28:31], s75 offen sc1
  buffer_load_dwordx4 v[92:95], v12, s[28:31], s75 offen sc1
  buffer_load_dwordx4 v[96:99], v13, s[28:31], s75 offen sc1
  s_waitcnt vmcnt(0)
  v_min3_u32 v48, v84, v85, v86
  v_min3_u32 v48, v48, v87, v88
  v_min3_u32 v48, v48, v89, v90
  v_min3_u32 v48, v48, v91, v92
  v_min3_u32 v48, v48, v93, v94
  v_min3_u32 v48, v48, v95, v96
  v_min3_u32 v48, v48, v97, v98
  v_min_u32 v48, v48, v99
  v_cmp_eq_u32 vcc, 0, v48
  s_nop 4
  s_cbranch_vccz L_Bo14_ok
  s_sub_u32 s3, s3, 1
  s_cmp_lg_u32 s3, 0
  s_cbranch_scc1 L_Bo14_loop
  s_branch L_Bo14_ok
L_Bo15_retry:
  s_mov_b32 s3, 0x20000
L_Bo15_loop:
  s_lshl_b32 s75, s64, 10
  s_add_u32 s75, s75, 4096
  buffer_load_dwordx4 v[128:131], v10, s[28:31], s75 offen sc1
  buffer_load_dwordx4 v[132:135], v11, s[28:31], s75 offen sc1
  buffer_load_dwordx4 v[136:139], v12, s[28:31], s75 offen sc1
  buffer_load_dwordx4 v[140:143], v13, s[28:31], s75 offen sc1
  s_waitcnt vmcnt(0)
  v_min3_u32 v48, v128, v129, v130
  v_min3_u32 v48, v48, v131, v132
  v_min3_u32 v48, v48, v133, v134
  v_min3_u32 v48, v48, v135, v136
  v_min3_u32 v48, v48, v137, v138
  v_min3_u32 v48, v48, v139, v140
  v_min3_u32 v48, v48, v141, v142
  v_min_u32 v48, v48, v143
  v_cmp_eq_u32 vcc, 0, v48
  s_nop 4
  s_cbranch_vccz L_Bo15_ok
  s_sub_u32 s3, s3, 1
  s_cmp_lg_u32 s3, 0
  s_cbranch_scc1 L_Bo15_loop
  s_branch L_Bo15_ok
L_Bo16_retry:
  s_mov_b32 s3, 0x20000
L_Bo16_loop:
  s_lshl_b32 s75, s64, 10
  s_add_u32 s75, s75, 8192
  buffer_load_dwordx4 v[144:147], v10, s[28:31], s75 offen sc1
  buffer_load_dwordx4 v[148:151], v11, s[28:31], s75 offen sc1
  buffer_load_dwordx4 v[152:155], v12, s[28:31], s75 offen sc1
  buffer_load_dwordx4 v[156:159], v13, s[28:31], s75 offen sc1
  s_waitcnt vmcnt(0)
  v_min3_u32 v48, v144, v145, v146
  v_min3_u32 v48, v48, v147, v148
  v_min3_u32 v48, v48, v149, v150
  v_min3_u32 v48, v48, v151, v152
  v_min3_u32 v48, v48, v153, v154
  v_min3_u32 v48, v48, v155, v156
  v_min3_u32 v48, v48, v157, v158
  v_min_u32 v48, v48, v159
  v_cmp_eq_u32 vcc, 0, v48
  s_nop 4
  s_cbranch_vccz L_Bo16_ok
  s_sub_u32 s3, s3, 1
  s_cmp_lg_u32 s3, 0
  s_cbranch_scc1 L_Bo16_loop
  s_branch L_Bo16_ok
L_Bo17_retry:
  s_mov_b32 s3, 0x20000
L_Bo17_loop:
  s_lshl_b32 s75, s64, 10
  s_add_u32 s75, s75, 12288
  buffer_load_dwordx4 v[160:163], v10, s[28:31], s75 offen sc1
  buffer_load_dwordx4 v[164:167], v11, s[28:31], s75 offen sc1
  buffer_load_dwordx4 v[168:171], v12, s[28:31], s75 offen sc1
  buffer_load_dwordx4 v[172:175], v13, s[28:31], s75 offen sc1
  s_waitcnt vmcnt(0)
  v_min3_u32 v48, v160, v161, v162
  v_min3_u32 v48, v48, v163, v164
  v_min3_u32 v48, v48, v165, v166
  v_min3_u32 v48, v48, v167, v168
  v_min3_u32 v48, v48, v169, v170
  v_min3_u32 v48, v48, v171, v172
  v_min3_u32 v48, v48, v173, v174
  v_min_u32 v48, v48, v175
  v_cmp_eq_u32 vcc, 0, v48
  s_nop 4
  s_cbranch_vccz L_Bo17_ok
  s_sub_u32 s3, s3, 1
  s_cmp_lg_u32 s3, 0
  s_cbranch_scc1 L_Bo17_loop
  s_branch L_Bo17_ok
L_Bo18_retry:
  s_mov_b32 s3, 0x20000
L_Bo18_loop:
  s_lshl_b32 s75, s64, 10
  s_add_u32 s75, s75, 16384
  buffer_load_dwordx4 v[112:115], v10, s[28:31], s75 offen sc1
  buffer_load_dwordx4 v[116:119], v11, s[28:31], s75 offen sc1
  buffer_load_dwordx4 v[120:123], v12, s[28:31], s75 offen sc1
  buffer_load_dwordx4 v[124:127], v13, s[28:31], s75 offen sc1
  s_waitcnt vmcnt(0)
  v_min3_u32 v48, v112, v113, v114
  v_min3_u32 v48, v48, v115, v116
  v_min3_u32 v48, v48, v117, v118
  v_min3_u32 v48, v48, v119, v120
  v_min3_u32 v48, v48, v121, v122
  v_min3_u32 v48, v48, v123, v124
  v_min3_u32 v48, v48, v125, v126
  v_min_u32 v48, v48, v127
  v_cmp_eq_u32 vcc, 0, v48
  s_nop 4
  s_cbranch_vccz L_Bo18_ok
  s_sub_u32 s3, s3, 1
  s_cmp_lg_u32 s3, 0
  s_cbranch_scc1 L_Bo18_loop
  s_branch L_Bo18_ok
.section .rodata,"a"
.p2align 6
.amdhsa_kernel parallel_sum__linear_kernel_hedgehog__glu_gated_reglu__prompt_kernel
  .amdhsa_next_free_vgpr 512
  .amdhsa_next_free_sgpr 102
  .amdhsa_accum_offset 256
  .amdhsa_group_segment_fixed_size 0
  .amdhsa_kernarg_size 88
  .amdhsa_user_sgpr_count 2
  .amdhsa_user_sgpr_kernarg_segment_ptr 1
  .amdhsa_system_sgpr_workgroup_id_x 1
  .amdhsa_float_denorm_mode_32 3
.end_amdhsa_kernel
```
